```python
import torch

def _softmax(x, axis=-1):
    return torch.softmax(x, dim=axis)
def _gelu(x):
    return torch.nn.functional.gelu(x, approximate="tanh")
def _silu(x):
    return torch.nn.functional.silu(x)
def _sigmoid(x):
    return torch.sigmoid(x)
def _layernorm(x, axis=-1, eps=1e-5):
    m = x.mean(dim=axis, keepdim=True)
    v = x.var(dim=axis, keepdim=True, unbiased=False)
    return (x - m) / torch.sqrt(v + eps)
def _scatter_add(tgt, idx, src, axis=0):
    return tgt.clone().index_add_(axis, idx, src)
def _segment_sum(src, seg, n):
    out = torch.zeros((n,) + src.shape[1:], dtype=src.dtype)
    return out.index_add_(0, seg, src)
def _pad(x, pw):
    flat = tuple(v for pair in reversed(pw) for v in pair)
    return torch.nn.functional.pad(x, flat)

kernel_name = 'parallel_sum__sliding_block__dense_activation_gelu__prompt'

def setup_inputs():

    _w = (lambda a: (lambda t: t.to(torch.bfloat16) if t.is_floating_point() else t)(torch.as_tensor(a)))
    def _A_setup():
        B, S, D = 1, 2048, 640
        return {
            "x": _w((lambda *s: torch.randn(*s, dtype=torch.bfloat16) * 0.05)(B, S, D)),
            "wqkv": _w((lambda *s: torch.randn(*s, dtype=torch.bfloat16) * 0.05)(D, 3 * D)),
            "wo": _w((lambda *s: torch.randn(*s, dtype=torch.bfloat16) * 0.05)(D, D)),
        }
    _A_in = _A_setup()

    def _B_setup():
        B, S, D, F = 1, 2048, 640, 1536
        return {
            "x": _w((lambda *s: torch.randn(*s, dtype=torch.bfloat16) * 0.05)(B, S, D)),
            "w1": _w((lambda *s: torch.randn(*s, dtype=torch.bfloat16) * 0.8)(D, F) * (D ** -0.5)),
            "b1": _w((lambda *s: torch.randn(*s, dtype=torch.bfloat16) * 0.8)(F) * 0.01),
            "w2": _w((lambda *s: torch.randn(*s, dtype=torch.bfloat16) * 0.8)(F, D) * (F ** -0.5)),
            "b2": _w((lambda *s: torch.randn(*s, dtype=torch.bfloat16) * 0.8)(D) * 0.01),
        }
    _B_in = _B_setup()

    return {
        "A_x": _A_in["x"],
        "A_wqkv": _A_in["wqkv"],
        "A_wo": _A_in["wo"],
        "B_x": _B_in["x"],
        "B_w1": _B_in["w1"],
        "B_b1": _B_in["b1"],
        "B_w2": _B_in["w2"],
        "B_b2": _B_in["b2"],
    }

def reference(A_x, A_wqkv, A_wo, B_x, B_w1, B_b1, B_w2, B_b2):
    def _A_ref(x, wqkv, wo):
        B, S, D = x.shape
        H = 32; Dh = D // H; W = 256
        qkv = (lambda x, *d: x.permute(*d))((x @ wqkv).reshape(B, S, 3, H, Dh), 2, 0, 3, 1, 4)
        q, k, v = qkv[0], qkv[1], qkv[2]
        scores = torch.einsum("bhqd,bhkd->bhqk", q, k) * (Dh ** -0.5)
        idx = torch.arange(S)
        mask = (idx[:, None] - idx[None, :] >= 0) & (idx[:, None] - idx[None, :] < W)
        scores = torch.where(mask[None, None], scores, -1e9)
        p = _softmax(scores, axis=-1)
        o = torch.einsum("bhqk,bhkd->bhqd", p, v)
        return (lambda x, *d: x.permute(*d))(o, 0, 2, 1, 3).reshape(B, S, D) @ wo

    def _B_ref(x, w1, b1, w2, b2):
        h = torch.einsum("bsd,df->bsf", x, w1) + b1
        h = _gelu(h)
        return torch.einsum("bsf,fd->bsd", h, w2) + b2

    x = A_x
    xn = _layernorm(x, axis=-1)
    return x + _A_ref(xn, A_wqkv, A_wo) + _B_ref(xn, B_w1, B_b1, B_w2, B_b2)
```

```asm
; @launch kernel=g1_kernel grid=(256,1,1) block=(512,1,1) lds=152064
; @launch kernel=k2_kernel grid=(256,1,1) block=(512,1,1) lds=72768
.amdgcn_target "amdgcn-amd-amdhsa--gfx950"
.text
.globl g1_kernel
.p2align 8
.type g1_kernel,@function
g1_kernel:
s_load_dwordx4 s[32:35], s[0:1], 0
s_load_dwordx2 s[38:39], s[0:1], 32
s_cmp_ge_u32 s2, 256
s_cbranch_scc1 L_g1_done
s_load_dwordx2 s[36:37], s[0:1], 16
s_load_dwordx2 s[40:41], s[0:1], 40
s_load_dwordx2 s[42:43], s[0:1], 48
s_load_dwordx2 s[44:45], s[0:1], 80
v_lshrrev_b32 v40, 6, v0
v_and_b32 v1, 63, v0
v_readfirstlane_b32 s46, v40
s_getpc_b64 s[74:75]
L_pf_g1_e:
v_lshlrev_b32 v44, 7, v1
v_mov_b32 v45, s46
v_lshl_add_u32 v44, v45, 13, v44
v_min_u32 v44, L_code_end-g1_kernel-4, v44
s_sub_u32 s74, s74, L_pf_g1_e-g1_kernel
s_subb_u32 s75, s75, 0
v_mov_b32 v45, s75
v_add_co_u32 v44, vcc, s74, v44
s_nop 1
v_addc_co_u32 v45, vcc, 0, v45, vcc
global_load_dword v248, v[44:45], off
s_and_b32 s59, s2, 7
s_lshr_b32 s60, s2, 3
s_and_b32 s49, s59, 1
s_lshl_b32 s49, s49, 3
s_lshr_b32 s61, s60, 2
s_add_u32 s49, s49, s61
s_lshr_b32 s50, s59, 1
s_lshl_b32 s50, s50, 2
s_and_b32 s61, s60, 3
s_add_u32 s50, s50, s61
v_lshrrev_b32 v40, 3, v1
v_mul_u32_u24 v40, 1280, v40
v_lshrrev_b32 v41, 4, v1
v_and_b32 v42, 7, v1
v_xor_b32 v42, v42, v41
v_lshl_add_u32 v2, v42, 4, v40
v_xor_b32 v42, 4, v42
v_lshl_add_u32 v3, v42, 4, v40
v_add_u32 v3, 10240, v3
s_and_b32 s47, s46, 3
s_lshr_b32 s48, s46, 2
v_mul_u32_u24 v40, 3840, v41
v_and_b32 v42, 15, v1
v_lshlrev_b32 v43, 2, v41
v_xor_b32 v42, v42, v43
v_lshl_add_u32 v4, v42, 4, v40
v_add_u32 v5, 15360, v4
s_lshl_b32 s59, s47, 1
s_add_u32 s59, s59, 4
s_cmp_eq_u32 s48, 0
s_cselect_b32 s59, s47, s59
s_lshl_b32 s60, s59, 6
v_add_u32 v40, s60, v1
v_mul_u32_u24 v41, 43691, v40
v_lshrrev_b32 v41, 19, v41
v_mul_u32_u24 v42, 12, v41
v_sub_u32 v42, v40, v42
v_mul_u32_u24 v41, 3072, v41
v_lshl_add_u32 v6, v42, 4, v41
v_add_u32 v40, s60, v1
v_add_u32 v40, 64, v40
v_mul_u32_u24 v41, 43691, v40
v_lshrrev_b32 v41, 19, v41
v_mul_u32_u24 v42, 12, v41
v_sub_u32 v42, v40, v42
v_mul_u32_u24 v41, 3072, v41
v_lshl_add_u32 v7, v42, 4, v41
s_lshl_b32 s56, s46, 11
s_add_u32 s57, s56, 49152
s_lshl_b32 s58, s59, 10
s_add_u32 s58, s58, 98304
s_lshl_b32 s53, s49, 7
s_lshl_b32 s60, s46, 4
s_add_u32 s53, s53, s60
s_mul_i32 s53, s53, 1280
s_lshl_b32 s54, s46, 3
s_mul_i32 s54, s54, 3840
s_lshl_b32 s60, s50, 8
s_add_u32 s54, s54, s60
s_mul_i32 s55, s50, 192
s_waitcnt lgkmcnt(0)
s_mov_b32 s8, s32
s_and_b32 s9, s33, 0xffff
s_mov_b32 s10, 2621440
s_mov_b32 s11, 0x20000
s_mov_b32 s12, s34
s_and_b32 s13, s35, 0xffff
s_mov_b32 s14, 2457600
s_mov_b32 s15, 0x20000
s_mov_b32 s16, s38
s_and_b32 s17, s39, 0xffff
s_mov_b32 s18, 1966080
s_mov_b32 s19, 0x20000
s_add_u32 m0, s56, 0
s_nop 0
buffer_load_dwordx4 v2, s[8:11], s53 offen lds
s_add_u32 m0, s57, 0
s_nop 0
buffer_load_dwordx4 v4, s[12:15], s54 offen lds
s_add_u32 m0, s56, 1024
s_nop 0
buffer_load_dwordx4 v3, s[8:11], s53 offen lds
s_add_u32 m0, s57, 1024
s_nop 0
buffer_load_dwordx4 v5, s[12:15], s54 offen lds
s_add_u32 m0, s58, 0
s_nop 0
buffer_load_dwordx4 v6, s[16:19], s55 offen lds
s_cmp_eq_u32 s48, 0
s_cbranch_scc1 L_g1_cd0
s_add_u32 m0, s58, 1024
s_nop 0
buffer_load_dwordx4 v7, s[16:19], s55 offen lds
L_g1_cd0:
s_add_u32 s53, s53, 128
s_add_u32 s54, s54, 245760
s_add_u32 s55, s55, 196608
s_add_u32 m0, s56, 16384
s_nop 0
buffer_load_dwordx4 v2, s[8:11], s53 offen lds
s_add_u32 m0, s57, 16384
s_nop 0
buffer_load_dwordx4 v4, s[12:15], s54 offen lds
s_add_u32 m0, s56, 17408
s_nop 0
buffer_load_dwordx4 v3, s[8:11], s53 offen lds
s_add_u32 m0, s57, 17408
s_nop 0
buffer_load_dwordx4 v5, s[12:15], s54 offen lds
s_add_u32 m0, s58, 12288
s_nop 0
buffer_load_dwordx4 v6, s[16:19], s55 offen lds
s_cmp_eq_u32 s48, 0
s_cbranch_scc1 L_g1_cd1
s_add_u32 m0, s58, 13312
s_nop 0
buffer_load_dwordx4 v7, s[16:19], s55 offen lds
L_g1_cd1:
s_add_u32 s53, s53, 128
s_add_u32 s54, s54, 245760
s_add_u32 s55, s55, 196608
s_cmp_eq_u32 s48, 0
s_cbranch_scc0 L_g1_ch1
s_mov_b32 s20, s44
s_and_b32 s21, s45, 0xffff
s_mov_b32 s22, 20611072
s_mov_b32 s23, 0x20000
s_mul_i32 s52, s50, 52
s_lshr_b32 s52, s52, 8
s_mul_i32 s61, s52, 5
s_sub_u32 s51, s50, s61
s_mov_b32 s63, 0xffff0000
v_mov_b32 v22, 0
v_mov_b32 v23, 0
v_and_b32 v40, 15, v1
v_bfe_u32 v41, v1, 4, 1
v_cmp_eq_u32 vcc, v40, v41
v_mov_b32 v42, 0x3f803f80
s_nop 0
v_cndmask_b32_e64 v28, 0, v42, vcc
v_cndmask_b32_e64 v29, 0, v42, vcc
v_cndmask_b32_e64 v30, 0, v42, vcc
v_cndmask_b32_e64 v31, 0, v42, vcc
s_mov_b32 s64, s2
s_add_u32 s59, s49, 256
s_cmp_eq_u32 s52, 3
s_cselect_b32 s64, s59, s2
s_lshr_b32 s59, s64, 2
s_cmp_lt_u32 s59, 48
s_cselect_b32 s24, s42, s36
s_cselect_b32 s25, s43, s37
s_mov_b32 s26, 819200
s_cselect_b32 s26, 1966080, s26
s_cselect_b32 s60, 0, 48
s_cselect_b32 s61, 4, 8
s_mov_b32 s62, 1280
s_cselect_b32 s62, 2560, s62
s_and_b32 s25, s25, 0xffff
s_mov_b32 s27, 0x20000
s_sub_u32 s69, s59, s60
s_mul_i32 s69, s69, 40960
s_and_b32 s60, s64, 3
s_mul_i32 s60, s60, 320
s_add_u32 s69, s69, s60
s_lshl_b32 s70, s47, 10
s_add_u32 s70, s70, 135168
v_lshrrev_b32 v40, 5, v1
v_lshlrev_b32 v40, 4, v40
v_bfe_u32 v41, v1, 4, 1
v_mul_u32_u24 v41, s61, v41
v_add_u32 v40, v40, v41
v_bfe_u32 v41, v1, 2, 2
v_add_u32 v40, v40, v41
v_mul_u32_u24 v40, 320, v40
v_and_b32 v41, 3, v1
v_lshl_add_u32 v40, v41, 3, v40
s_lshl_b32 s60, s47, 5
s_add_u32 s60, s60, 135168
v_add_u32 v19, s60, v40
v_add_u32 v20, s62, v19
v_lshlrev_b32 v21, 4, v1
s_lshl_b32 s60, s47, 6
v_add_u32 v40, s60, v1
v_mul_u32_u24 v41, 52429, v40
v_lshrrev_b32 v41, 20, v41
v_mul_u32_u24 v42, 20, v41
v_sub_u32 v42, v40, v42
v_mul_u32_u24 v41, 1280, v41
v_lshl_add_u32 v16, v42, 4, v41
v_add_u32 v40, s60, v1
v_add_u32 v40, 256, v40
v_mul_u32_u24 v41, 52429, v40
v_lshrrev_b32 v41, 20, v41
v_mul_u32_u24 v42, 20, v41
v_sub_u32 v42, v40, v42
v_mul_u32_u24 v41, 1280, v41
v_lshl_add_u32 v17, v42, 4, v41
v_add_u32 v40, s60, v1
v_add_u32 v40, 512, v40
v_mul_u32_u24 v41, 52429, v40
v_lshrrev_b32 v41, 20, v41
v_mul_u32_u24 v42, 20, v41
v_sub_u32 v42, v40, v42
v_mul_u32_u24 v41, 1280, v41
v_lshl_add_u32 v18, v42, 4, v41
s_add_u32 s60, s47, 0
s_cmp_ge_u32 s60, 5
s_cselect_b32 s61, 1, 0
s_cselect_b32 s62, 5, 0
s_sub_u32 s60, s60, s62
s_and_b32 s62, s64, 3
s_lshl_b32 s62, s62, 1
s_add_u32 s62, s62, s61
s_mul_i32 s62, s62, 68
s_add_u32 s62, s62, s59
s_mul_i32 s62, s62, 5
s_add_u32 s62, s62, s60
s_lshl_b32 s62, s62, 10
s_add_u32 s71, s62, 16777216
s_add_u32 s60, s47, 4
s_cmp_ge_u32 s60, 5
s_cselect_b32 s61, 1, 0
s_cselect_b32 s62, 5, 0
s_sub_u32 s60, s60, s62
s_and_b32 s62, s64, 3
s_lshl_b32 s62, s62, 1
s_add_u32 s62, s62, s61
s_mul_i32 s62, s62, 68
s_add_u32 s62, s62, s59
s_mul_i32 s62, s62, 5
s_add_u32 s62, s62, s60
s_lshl_b32 s62, s62, 10
s_add_u32 s72, s62, 16777216
s_add_u32 s60, s47, 8
s_cmp_ge_u32 s60, 5
s_cselect_b32 s61, 1, 0
s_cselect_b32 s62, 5, 0
s_sub_u32 s60, s60, s62
s_and_b32 s62, s64, 3
s_lshl_b32 s62, s62, 1
s_add_u32 s62, s62, s61
s_mul_i32 s62, s62, 68
s_add_u32 s62, s62, s59
s_mul_i32 s62, s62, 5
s_add_u32 s62, s62, s60
s_lshl_b32 s62, s62, 10
s_add_u32 s73, s62, 16777216
v_and_b32 v40, 31, v1
v_lshrrev_b32 v41, 5, v1
v_bfe_u32 v42, v1, 1, 3
v_xor_b32 v41, v41, v42
v_lshlrev_b32 v41, 4, v41
v_lshl_add_u32 v41, v40, 7, v41
s_lshl_b32 s59, s47, 12
v_add_u32 v8, s59, v41
v_xor_b32 v9, 32, v8
v_xor_b32 v10, 64, v8
v_xor_b32 v11, 96, v8
v_lshrrev_b32 v40, 5, v1
v_lshlrev_b32 v40, 3, v40
v_bfe_u32 v41, v1, 2, 2
v_add_u32 v40, v40, v41
v_bfe_u32 v42, v1, 4, 1
v_lshlrev_b32 v42, 5, v42
v_and_b32 v43, 3, v1
v_lshl_add_u32 v42, v43, 3, v42
v_lshl_add_u32 v42, v40, 8, v42
v_add_u32 v42, 49152, v42
s_add_u32 s65, s47, 0
s_and_b32 s65, s65, 3
v_xor_b32 v43, s65, v41
v_lshl_add_u32 v12, v43, 6, v42
s_add_u32 s66, s47, 1
s_and_b32 s66, s66, 3
v_xor_b32 v43, s66, v41
v_lshl_add_u32 v13, v43, 6, v42
s_add_u32 s67, s47, 2
s_and_b32 s67, s67, 3
v_xor_b32 v43, s67, v41
v_lshl_add_u32 v14, v43, 6, v42
s_add_u32 s68, s47, 3
s_and_b32 s68, s68, 3
v_xor_b32 v43, s68, v41
v_lshl_add_u32 v15, v43, 6, v42
s_cmp_eq_u32 s52, 2
s_cbranch_scc1 L_g1_vtype
s_waitcnt vmcnt(5)
s_barrier
ds_read_b128 v[48:51], v8 offset:0
ds_read_b64_tr_b16 v[56:57], v12 offset:0
ds_read_b64_tr_b16 v[58:59], v12 offset:1024
ds_read_b64_tr_b16 v[60:61], v13 offset:0
ds_read_b64_tr_b16 v[62:63], v13 offset:1024
ds_read_b64_tr_b16 v[64:65], v14 offset:0
ds_read_b64_tr_b16 v[66:67], v14 offset:1024
ds_read_b64_tr_b16 v[68:69], v15 offset:0
ds_read_b64_tr_b16 v[70:71], v15 offset:1024
s_waitcnt lgkmcnt(0)
v_mfma_f32_32x32x16_bf16 v[88:103], v[56:59], v[48:51], 0
ds_read_b128 v[52:55], v9 offset:0
ds_read_b64_tr_b16 v[72:73], v12 offset:4096
ds_read_b64_tr_b16 v[74:75], v12 offset:5120
ds_read_b64_tr_b16 v[76:77], v13 offset:4096
ds_read_b64_tr_b16 v[78:79], v13 offset:5120
v_lshlrev_b32 v24, 16, v48
v_mfma_f32_32x32x16_bf16 v[104:119], v[60:63], v[48:51], 0
ds_read_b64_tr_b16 v[80:81], v14 offset:4096
ds_read_b64_tr_b16 v[82:83], v14 offset:5120
ds_read_b64_tr_b16 v[84:85], v15 offset:4096
ds_read_b64_tr_b16 v[86:87], v15 offset:5120
s_add_u32 m0, s56, 32768
s_nop 0
buffer_load_dwordx4 v2, s[8:11], s53 offen lds
v_and_b32 v25, s63, v48
v_fmac_f32 v22, v24, v24
v_fmac_f32 v23, v25, v25
v_mfma_f32_32x32x16_bf16 v[120:135], v[64:67], v[48:51], 0
s_add_u32 m0, s57, 32768
s_nop 0
buffer_load_dwordx4 v4, s[12:15], s54 offen lds
v_lshlrev_b32 v26, 16, v49
v_and_b32 v27, s63, v49
v_mfma_f32_32x32x16_bf16 v[136:151], v[68:71], v[48:51], 0
v_fmac_f32 v22, v26, v26
v_fmac_f32 v23, v27, v27
v_mfma_f32_16x16x32_bf16 v[32:35], v[28:31], v[56:59], 0
s_waitcnt lgkmcnt(0)
v_mfma_f32_32x32x16_bf16 v[88:103], v[72:75], v[52:55], v[88:103]
ds_read_b128 v[48:51], v10 offset:0
ds_read_b64_tr_b16 v[56:57], v12 offset:8192
ds_read_b64_tr_b16 v[58:59], v12 offset:9216
ds_read_b64_tr_b16 v[60:61], v13 offset:8192
ds_read_b64_tr_b16 v[62:63], v13 offset:9216
v_lshlrev_b32 v24, 16, v52
v_mfma_f32_32x32x16_bf16 v[104:119], v[76:79], v[52:55], v[104:119]
ds_read_b64_tr_b16 v[64:65], v14 offset:8192
ds_read_b64_tr_b16 v[66:67], v14 offset:9216
ds_read_b64_tr_b16 v[68:69], v15 offset:8192
ds_read_b64_tr_b16 v[70:71], v15 offset:9216
s_add_u32 m0, s56, 33792
s_nop 0
buffer_load_dwordx4 v3, s[8:11], s53 offen lds
v_and_b32 v25, s63, v52
v_fmac_f32 v22, v24, v24
v_fmac_f32 v23, v25, v25
v_mfma_f32_32x32x16_bf16 v[120:135], v[80:83], v[52:55], v[120:135]
s_add_u32 m0, s57, 33792
s_nop 0
buffer_load_dwordx4 v5, s[12:15], s54 offen lds
v_lshlrev_b32 v26, 16, v53
v_and_b32 v27, s63, v53
v_mfma_f32_32x32x16_bf16 v[136:151], v[84:87], v[52:55], v[136:151]
v_fmac_f32 v22, v26, v26
v_fmac_f32 v23, v27, v27
v_mfma_f32_16x16x32_bf16 v[32:35], v[28:31], v[72:75], v[32:35]
s_waitcnt lgkmcnt(0)
v_mfma_f32_32x32x16_bf16 v[88:103], v[56:59], v[48:51], v[88:103]
ds_read_b128 v[52:55], v11 offset:0
ds_read_b64_tr_b16 v[72:73], v12 offset:12288
ds_read_b64_tr_b16 v[74:75], v12 offset:13312
ds_read_b64_tr_b16 v[76:77], v13 offset:12288
ds_read_b64_tr_b16 v[78:79], v13 offset:13312
v_lshlrev_b32 v24, 16, v48
v_mfma_f32_32x32x16_bf16 v[104:119], v[60:63], v[48:51], v[104:119]
ds_read_b64_tr_b16 v[80:81], v14 offset:12288
ds_read_b64_tr_b16 v[82:83], v14 offset:13312
ds_read_b64_tr_b16 v[84:85], v15 offset:12288
ds_read_b64_tr_b16 v[86:87], v15 offset:13312
s_add_u32 m0, s58, 24576
s_nop 0
buffer_load_dwordx4 v6, s[16:19], s55 offen lds
s_add_u32 s53, s53, 128
s_add_u32 s54, s54, 245760
s_add_u32 s55, s55, 196608
v_and_b32 v25, s63, v48
v_fmac_f32 v22, v24, v24
v_fmac_f32 v23, v25, v25
v_mfma_f32_32x32x16_bf16 v[120:135], v[64:67], v[48:51], v[120:135]
v_lshlrev_b32 v26, 16, v49
v_and_b32 v27, s63, v49
v_mfma_f32_32x32x16_bf16 v[136:151], v[68:71], v[48:51], v[136:151]
v_fmac_f32 v22, v26, v26
v_fmac_f32 v23, v27, v27
v_mfma_f32_16x16x32_bf16 v[32:35], v[28:31], v[56:59], v[32:35]
s_waitcnt lgkmcnt(0)
s_waitcnt vmcnt(5)
s_barrier
v_mfma_f32_32x32x16_bf16 v[88:103], v[72:75], v[52:55], v[88:103]
ds_read_b128 v[48:51], v8 offset:16384
ds_read_b64_tr_b16 v[56:57], v12 offset:16384
ds_read_b64_tr_b16 v[58:59], v12 offset:17408
ds_read_b64_tr_b16 v[60:61], v13 offset:16384
ds_read_b64_tr_b16 v[62:63], v13 offset:17408
v_lshlrev_b32 v24, 16, v52
v_mfma_f32_32x32x16_bf16 v[104:119], v[76:79], v[52:55], v[104:119]
ds_read_b64_tr_b16 v[64:65], v14 offset:16384
ds_read_b64_tr_b16 v[66:67], v14 offset:17408
ds_read_b64_tr_b16 v[68:69], v15 offset:16384
ds_read_b64_tr_b16 v[70:71], v15 offset:17408
s_add_u32 m0, s56, 0
s_nop 0
buffer_load_dwordx4 v2, s[8:11], s53 offen lds
v_and_b32 v25, s63, v52
v_fmac_f32 v22, v24, v24
v_fmac_f32 v23, v25, v25
v_mfma_f32_32x32x16_bf16 v[120:135], v[80:83], v[52:55], v[120:135]
s_add_u32 m0, s57, 0
s_nop 0
buffer_load_dwordx4 v4, s[12:15], s54 offen lds
v_lshlrev_b32 v26, 16, v53
v_and_b32 v27, s63, v53
v_mfma_f32_32x32x16_bf16 v[136:151], v[84:87], v[52:55], v[136:151]
v_fmac_f32 v22, v26, v26
v_fmac_f32 v23, v27, v27
v_mfma_f32_16x16x32_bf16 v[32:35], v[28:31], v[72:75], v[32:35]
s_waitcnt lgkmcnt(0)
v_mfma_f32_32x32x16_bf16 v[88:103], v[56:59], v[48:51], v[88:103]
ds_read_b128 v[52:55], v9 offset:16384
ds_read_b64_tr_b16 v[72:73], v12 offset:20480
ds_read_b64_tr_b16 v[74:75], v12 offset:21504
ds_read_b64_tr_b16 v[76:77], v13 offset:20480
ds_read_b64_tr_b16 v[78:79], v13 offset:21504
v_lshlrev_b32 v24, 16, v48
v_mfma_f32_32x32x16_bf16 v[104:119], v[60:63], v[48:51], v[104:119]
ds_read_b64_tr_b16 v[80:81], v14 offset:20480
ds_read_b64_tr_b16 v[82:83], v14 offset:21504
ds_read_b64_tr_b16 v[84:85], v15 offset:20480
ds_read_b64_tr_b16 v[86:87], v15 offset:21504
s_add_u32 m0, s56, 1024
s_nop 0
buffer_load_dwordx4 v3, s[8:11], s53 offen lds
v_and_b32 v25, s63, v48
v_fmac_f32 v22, v24, v24
v_fmac_f32 v23, v25, v25
v_mfma_f32_32x32x16_bf16 v[120:135], v[64:67], v[48:51], v[120:135]
v_lshlrev_b32 v26, 16, v49
v_and_b32 v27, s63, v49
v_mfma_f32_32x32x16_bf16 v[136:151], v[68:71], v[48:51], v[136:151]
v_fmac_f32 v22, v26, v26
v_fmac_f32 v23, v27, v27
v_mfma_f32_16x16x32_bf16 v[32:35], v[28:31], v[56:59], v[32:35]
s_waitcnt lgkmcnt(0)
v_mfma_f32_32x32x16_bf16 v[88:103], v[72:75], v[52:55], v[88:103]
ds_read_b128 v[48:51], v10 offset:16384
ds_read_b64_tr_b16 v[56:57], v12 offset:24576
ds_read_b64_tr_b16 v[58:59], v12 offset:25600
ds_read_b64_tr_b16 v[60:61], v13 offset:24576
ds_read_b64_tr_b16 v[62:63], v13 offset:25600
v_lshlrev_b32 v24, 16, v52
v_mfma_f32_32x32x16_bf16 v[104:119], v[76:79], v[52:55], v[104:119]
ds_read_b64_tr_b16 v[64:65], v14 offset:24576
ds_read_b64_tr_b16 v[66:67], v14 offset:25600
ds_read_b64_tr_b16 v[68:69], v15 offset:24576
ds_read_b64_tr_b16 v[70:71], v15 offset:25600
s_add_u32 m0, s57, 1024
s_nop 0
buffer_load_dwordx4 v5, s[12:15], s54 offen lds
v_and_b32 v25, s63, v52
v_fmac_f32 v22, v24, v24
v_fmac_f32 v23, v25, v25
v_mfma_f32_32x32x16_bf16 v[120:135], v[80:83], v[52:55], v[120:135]
v_lshlrev_b32 v26, 16, v53
v_and_b32 v27, s63, v53
v_mfma_f32_32x32x16_bf16 v[136:151], v[84:87], v[52:55], v[136:151]
v_fmac_f32 v22, v26, v26
v_fmac_f32 v23, v27, v27
v_mfma_f32_16x16x32_bf16 v[32:35], v[28:31], v[72:75], v[32:35]
s_waitcnt lgkmcnt(0)
v_mfma_f32_32x32x16_bf16 v[88:103], v[56:59], v[48:51], v[88:103]
ds_read_b128 v[52:55], v11 offset:16384
ds_read_b64_tr_b16 v[72:73], v12 offset:28672
ds_read_b64_tr_b16 v[74:75], v12 offset:29696
ds_read_b64_tr_b16 v[76:77], v13 offset:28672
ds_read_b64_tr_b16 v[78:79], v13 offset:29696
v_lshlrev_b32 v24, 16, v48
v_mfma_f32_32x32x16_bf16 v[104:119], v[60:63], v[48:51], v[104:119]
ds_read_b64_tr_b16 v[80:81], v14 offset:28672
ds_read_b64_tr_b16 v[82:83], v14 offset:29696
ds_read_b64_tr_b16 v[84:85], v15 offset:28672
ds_read_b64_tr_b16 v[86:87], v15 offset:29696
s_add_u32 m0, s58, 0
s_nop 0
buffer_load_dwordx4 v6, s[16:19], s55 offen lds
s_add_u32 s53, s53, 128
s_add_u32 s54, s54, 245760
s_add_u32 s55, s55, 196608
v_and_b32 v25, s63, v48
v_fmac_f32 v22, v24, v24
v_fmac_f32 v23, v25, v25
v_mfma_f32_32x32x16_bf16 v[120:135], v[64:67], v[48:51], v[120:135]
v_lshlrev_b32 v26, 16, v49
v_and_b32 v27, s63, v49
v_mfma_f32_32x32x16_bf16 v[136:151], v[68:71], v[48:51], v[136:151]
v_fmac_f32 v22, v26, v26
v_fmac_f32 v23, v27, v27
v_mfma_f32_16x16x32_bf16 v[32:35], v[28:31], v[56:59], v[32:35]
s_waitcnt lgkmcnt(0)
s_waitcnt vmcnt(5)
s_barrier
s_cmp_eq_u32 s52, 3
s_cbranch_scc0 L_g1_r2a
s_add_u32 m0, s70, 0
s_nop 0
buffer_load_dwordx4 v16, s[24:27], s69 offen lds
s_add_u32 m0, s70, 4096
s_nop 0
buffer_load_dwordx4 v17, s[24:27], s69 offen lds
s_add_u32 m0, s70, 8192
s_nop 0
buffer_load_dwordx4 v18, s[24:27], s69 offen lds
L_g1_r2a:
v_mfma_f32_32x32x16_bf16 v[88:103], v[72:75], v[52:55], v[88:103]
ds_read_b128 v[48:51], v8 offset:32768
ds_read_b64_tr_b16 v[56:57], v12 offset:32768
ds_read_b64_tr_b16 v[58:59], v12 offset:33792
ds_read_b64_tr_b16 v[60:61], v13 offset:32768
ds_read_b64_tr_b16 v[62:63], v13 offset:33792
v_lshlrev_b32 v24, 16, v52
v_mfma_f32_32x32x16_bf16 v[104:119], v[76:79], v[52:55], v[104:119]
ds_read_b64_tr_b16 v[64:65], v14 offset:32768
ds_read_b64_tr_b16 v[66:67], v14 offset:33792
ds_read_b64_tr_b16 v[68:69], v15 offset:32768
ds_read_b64_tr_b16 v[70:71], v15 offset:33792
s_add_u32 m0, s56, 16384
s_nop 0
buffer_load_dwordx4 v2, s[8:11], s53 offen lds
v_and_b32 v25, s63, v52
v_fmac_f32 v22, v24, v24
v_fmac_f32 v23, v25, v25
v_mfma_f32_32x32x16_bf16 v[120:135], v[80:83], v[52:55], v[120:135]
s_add_u32 m0, s57, 16384
s_nop 0
buffer_load_dwordx4 v4, s[12:15], s54 offen lds
v_lshlrev_b32 v26, 16, v53
v_and_b32 v27, s63, v53
v_mfma_f32_32x32x16_bf16 v[136:151], v[84:87], v[52:55], v[136:151]
v_fmac_f32 v22, v26, v26
v_fmac_f32 v23, v27, v27
v_mfma_f32_16x16x32_bf16 v[32:35], v[28:31], v[72:75], v[32:35]
s_waitcnt lgkmcnt(0)
v_mfma_f32_32x32x16_bf16 v[88:103], v[56:59], v[48:51], v[88:103]
ds_read_b128 v[52:55], v9 offset:32768
ds_read_b64_tr_b16 v[72:73], v12 offset:36864
ds_read_b64_tr_b16 v[74:75], v12 offset:37888
ds_read_b64_tr_b16 v[76:77], v13 offset:36864
ds_read_b64_tr_b16 v[78:79], v13 offset:37888
v_lshlrev_b32 v24, 16, v48
v_mfma_f32_32x32x16_bf16 v[104:119], v[60:63], v[48:51], v[104:119]
ds_read_b64_tr_b16 v[80:81], v14 offset:36864
ds_read_b64_tr_b16 v[82:83], v14 offset:37888
ds_read_b64_tr_b16 v[84:85], v15 offset:36864
ds_read_b64_tr_b16 v[86:87], v15 offset:37888
s_add_u32 m0, s56, 17408
s_nop 0
buffer_load_dwordx4 v3, s[8:11], s53 offen lds
v_and_b32 v25, s63, v48
v_fmac_f32 v22, v24, v24
v_fmac_f32 v23, v25, v25
v_mfma_f32_32x32x16_bf16 v[120:135], v[64:67], v[48:51], v[120:135]
v_lshlrev_b32 v26, 16, v49
v_and_b32 v27, s63, v49
v_mfma_f32_32x32x16_bf16 v[136:151], v[68:71], v[48:51], v[136:151]
v_fmac_f32 v22, v26, v26
v_fmac_f32 v23, v27, v27
v_mfma_f32_16x16x32_bf16 v[32:35], v[28:31], v[56:59], v[32:35]
s_waitcnt lgkmcnt(0)
v_mfma_f32_32x32x16_bf16 v[88:103], v[72:75], v[52:55], v[88:103]
ds_read_b128 v[48:51], v10 offset:32768
ds_read_b64_tr_b16 v[56:57], v12 offset:40960
ds_read_b64_tr_b16 v[58:59], v12 offset:41984
ds_read_b64_tr_b16 v[60:61], v13 offset:40960
ds_read_b64_tr_b16 v[62:63], v13 offset:41984
v_lshlrev_b32 v24, 16, v52
v_mfma_f32_32x32x16_bf16 v[104:119], v[76:79], v[52:55], v[104:119]
ds_read_b64_tr_b16 v[64:65], v14 offset:40960
ds_read_b64_tr_b16 v[66:67], v14 offset:41984
ds_read_b64_tr_b16 v[68:69], v15 offset:40960
ds_read_b64_tr_b16 v[70:71], v15 offset:41984
s_add_u32 m0, s57, 17408
s_nop 0
buffer_load_dwordx4 v5, s[12:15], s54 offen lds
v_and_b32 v25, s63, v52
v_fmac_f32 v22, v24, v24
v_fmac_f32 v23, v25, v25
v_mfma_f32_32x32x16_bf16 v[120:135], v[80:83], v[52:55], v[120:135]
v_lshlrev_b32 v26, 16, v53
v_and_b32 v27, s63, v53
v_mfma_f32_32x32x16_bf16 v[136:151], v[84:87], v[52:55], v[136:151]
v_fmac_f32 v22, v26, v26
v_fmac_f32 v23, v27, v27
v_mfma_f32_16x16x32_bf16 v[32:35], v[28:31], v[72:75], v[32:35]
s_waitcnt lgkmcnt(0)
v_mfma_f32_32x32x16_bf16 v[88:103], v[56:59], v[48:51], v[88:103]
ds_read_b128 v[52:55], v11 offset:32768
ds_read_b64_tr_b16 v[72:73], v12 offset:45056
ds_read_b64_tr_b16 v[74:75], v12 offset:46080
ds_read_b64_tr_b16 v[76:77], v13 offset:45056
ds_read_b64_tr_b16 v[78:79], v13 offset:46080
v_lshlrev_b32 v24, 16, v48
v_mfma_f32_32x32x16_bf16 v[104:119], v[60:63], v[48:51], v[104:119]
ds_read_b64_tr_b16 v[80:81], v14 offset:45056
ds_read_b64_tr_b16 v[82:83], v14 offset:46080
ds_read_b64_tr_b16 v[84:85], v15 offset:45056
ds_read_b64_tr_b16 v[86:87], v15 offset:46080
s_add_u32 m0, s58, 12288
s_nop 0
buffer_load_dwordx4 v6, s[16:19], s55 offen lds
s_add_u32 s53, s53, 128
s_add_u32 s54, s54, 245760
s_add_u32 s55, s55, 196608
v_and_b32 v25, s63, v48
v_fmac_f32 v22, v24, v24
v_fmac_f32 v23, v25, v25
v_mfma_f32_32x32x16_bf16 v[120:135], v[64:67], v[48:51], v[120:135]
v_lshlrev_b32 v26, 16, v49
v_and_b32 v27, s63, v49
v_mfma_f32_32x32x16_bf16 v[136:151], v[68:71], v[48:51], v[136:151]
v_fmac_f32 v22, v26, v26
v_fmac_f32 v23, v27, v27
v_mfma_f32_16x16x32_bf16 v[32:35], v[28:31], v[56:59], v[32:35]
s_waitcnt lgkmcnt(0)
s_waitcnt vmcnt(5)
s_barrier
v_mfma_f32_32x32x16_bf16 v[88:103], v[72:75], v[52:55], v[88:103]
ds_read_b128 v[48:51], v8 offset:0
ds_read_b64_tr_b16 v[56:57], v12 offset:0
ds_read_b64_tr_b16 v[58:59], v12 offset:1024
ds_read_b64_tr_b16 v[60:61], v13 offset:0
ds_read_b64_tr_b16 v[62:63], v13 offset:1024
v_lshlrev_b32 v24, 16, v52
v_mfma_f32_32x32x16_bf16 v[104:119], v[76:79], v[52:55], v[104:119]
ds_read_b64_tr_b16 v[64:65], v14 offset:0
ds_read_b64_tr_b16 v[66:67], v14 offset:1024
ds_read_b64_tr_b16 v[68:69], v15 offset:0
ds_read_b64_tr_b16 v[70:71], v15 offset:1024
s_add_u32 m0, s56, 32768
s_nop 0
buffer_load_dwordx4 v2, s[8:11], s53 offen lds
v_and_b32 v25, s63, v52
v_fmac_f32 v22, v24, v24
v_fmac_f32 v23, v25, v25
v_mfma_f32_32x32x16_bf16 v[120:135], v[80:83], v[52:55], v[120:135]
s_add_u32 m0, s57, 32768
s_nop 0
buffer_load_dwordx4 v4, s[12:15], s54 offen lds
v_lshlrev_b32 v26, 16, v53
v_and_b32 v27, s63, v53
v_mfma_f32_32x32x16_bf16 v[136:151], v[84:87], v[52:55], v[136:151]
v_fmac_f32 v22, v26, v26
v_fmac_f32 v23, v27, v27
v_mfma_f32_16x16x32_bf16 v[32:35], v[28:31], v[72:75], v[32:35]
s_waitcnt lgkmcnt(0)
v_mfma_f32_32x32x16_bf16 v[88:103], v[56:59], v[48:51], v[88:103]
ds_read_b128 v[52:55], v9 offset:0
ds_read_b64_tr_b16 v[72:73], v12 offset:4096
ds_read_b64_tr_b16 v[74:75], v12 offset:5120
ds_read_b64_tr_b16 v[76:77], v13 offset:4096
ds_read_b64_tr_b16 v[78:79], v13 offset:5120
v_lshlrev_b32 v24, 16, v48
v_mfma_f32_32x32x16_bf16 v[104:119], v[60:63], v[48:51], v[104:119]
ds_read_b64_tr_b16 v[80:81], v14 offset:4096
ds_read_b64_tr_b16 v[82:83], v14 offset:5120
ds_read_b64_tr_b16 v[84:85], v15 offset:4096
ds_read_b64_tr_b16 v[86:87], v15 offset:5120
s_add_u32 m0, s56, 33792
s_nop 0
buffer_load_dwordx4 v3, s[8:11], s53 offen lds
v_and_b32 v25, s63, v48
v_fmac_f32 v22, v24, v24
v_fmac_f32 v23, v25, v25
v_mfma_f32_32x32x16_bf16 v[120:135], v[64:67], v[48:51], v[120:135]
v_lshlrev_b32 v26, 16, v49
v_and_b32 v27, s63, v49
v_mfma_f32_32x32x16_bf16 v[136:151], v[68:71], v[48:51], v[136:151]
v_fmac_f32 v22, v26, v26
v_fmac_f32 v23, v27, v27
v_mfma_f32_16x16x32_bf16 v[32:35], v[28:31], v[56:59], v[32:35]
s_waitcnt lgkmcnt(0)
v_mfma_f32_32x32x16_bf16 v[88:103], v[72:75], v[52:55], v[88:103]
ds_read_b128 v[48:51], v10 offset:0
ds_read_b64_tr_b16 v[56:57], v12 offset:8192
ds_read_b64_tr_b16 v[58:59], v12 offset:9216
ds_read_b64_tr_b16 v[60:61], v13 offset:8192
ds_read_b64_tr_b16 v[62:63], v13 offset:9216
v_lshlrev_b32 v24, 16, v52
v_mfma_f32_32x32x16_bf16 v[104:119], v[76:79], v[52:55], v[104:119]
ds_read_b64_tr_b16 v[64:65], v14 offset:8192
ds_read_b64_tr_b16 v[66:67], v14 offset:9216
ds_read_b64_tr_b16 v[68:69], v15 offset:8192
ds_read_b64_tr_b16 v[70:71], v15 offset:9216
s_add_u32 m0, s57, 33792
s_nop 0
buffer_load_dwordx4 v5, s[12:15], s54 offen lds
v_and_b32 v25, s63, v52
v_fmac_f32 v22, v24, v24
v_fmac_f32 v23, v25, v25
v_mfma_f32_32x32x16_bf16 v[120:135], v[80:83], v[52:55], v[120:135]
v_lshlrev_b32 v26, 16, v53
v_and_b32 v27, s63, v53
v_mfma_f32_32x32x16_bf16 v[136:151], v[84:87], v[52:55], v[136:151]
v_fmac_f32 v22, v26, v26
v_fmac_f32 v23, v27, v27
v_mfma_f32_16x16x32_bf16 v[32:35], v[28:31], v[72:75], v[32:35]
s_waitcnt lgkmcnt(0)
v_mfma_f32_32x32x16_bf16 v[88:103], v[56:59], v[48:51], v[88:103]
ds_read_b128 v[52:55], v11 offset:0
ds_read_b64_tr_b16 v[72:73], v12 offset:12288
ds_read_b64_tr_b16 v[74:75], v12 offset:13312
ds_read_b64_tr_b16 v[76:77], v13 offset:12288
ds_read_b64_tr_b16 v[78:79], v13 offset:13312
v_lshlrev_b32 v24, 16, v48
v_mfma_f32_32x32x16_bf16 v[104:119], v[60:63], v[48:51], v[104:119]
ds_read_b64_tr_b16 v[80:81], v14 offset:12288
ds_read_b64_tr_b16 v[82:83], v14 offset:13312
ds_read_b64_tr_b16 v[84:85], v15 offset:12288
ds_read_b64_tr_b16 v[86:87], v15 offset:13312
s_add_u32 m0, s58, 24576
s_nop 0
buffer_load_dwordx4 v6, s[16:19], s55 offen lds
s_add_u32 s53, s53, 128
s_add_u32 s54, s54, 245760
s_add_u32 s55, s55, 196608
v_and_b32 v25, s63, v48
v_fmac_f32 v22, v24, v24
v_fmac_f32 v23, v25, v25
v_mfma_f32_32x32x16_bf16 v[120:135], v[64:67], v[48:51], v[120:135]
v_lshlrev_b32 v26, 16, v49
v_and_b32 v27, s63, v49
v_mfma_f32_32x32x16_bf16 v[136:151], v[68:71], v[48:51], v[136:151]
v_fmac_f32 v22, v26, v26
v_fmac_f32 v23, v27, v27
v_mfma_f32_16x16x32_bf16 v[32:35], v[28:31], v[56:59], v[32:35]
s_waitcnt lgkmcnt(0)
s_waitcnt vmcnt(5)
s_barrier
v_mfma_f32_32x32x16_bf16 v[88:103], v[72:75], v[52:55], v[88:103]
ds_read_b128 v[48:51], v8 offset:16384
ds_read_b64_tr_b16 v[56:57], v12 offset:16384
ds_read_b64_tr_b16 v[58:59], v12 offset:17408
ds_read_b64_tr_b16 v[60:61], v13 offset:16384
ds_read_b64_tr_b16 v[62:63], v13 offset:17408
v_lshlrev_b32 v24, 16, v52
v_mfma_f32_32x32x16_bf16 v[104:119], v[76:79], v[52:55], v[104:119]
ds_read_b64_tr_b16 v[64:65], v14 offset:16384
ds_read_b64_tr_b16 v[66:67], v14 offset:17408
ds_read_b64_tr_b16 v[68:69], v15 offset:16384
ds_read_b64_tr_b16 v[70:71], v15 offset:17408
s_add_u32 m0, s56, 0
s_nop 0
buffer_load_dwordx4 v2, s[8:11], s53 offen lds
v_and_b32 v25, s63, v52
v_fmac_f32 v22, v24, v24
v_fmac_f32 v23, v25, v25
v_mfma_f32_32x32x16_bf16 v[120:135], v[80:83], v[52:55], v[120:135]
s_add_u32 m0, s57, 0
s_nop 0
buffer_load_dwordx4 v4, s[12:15], s54 offen lds
v_lshlrev_b32 v26, 16, v53
v_and_b32 v27, s63, v53
v_mfma_f32_32x32x16_bf16 v[136:151], v[84:87], v[52:55], v[136:151]
v_fmac_f32 v22, v26, v26
v_fmac_f32 v23, v27, v27
v_mfma_f32_16x16x32_bf16 v[32:35], v[28:31], v[72:75], v[32:35]
s_waitcnt lgkmcnt(0)
v_mfma_f32_32x32x16_bf16 v[88:103], v[56:59], v[48:51], v[88:103]
s_cmp_eq_u32 s52, 3
s_cbranch_scc0 L_g1_r2b
ds_read_b64_tr_b16 v[152:153], v19 offset:0
ds_read_b64_tr_b16 v[154:155], v20 offset:0
ds_read_b64_tr_b16 v[156:157], v19 offset:128
ds_read_b64_tr_b16 v[158:159], v20 offset:128
ds_read_b64_tr_b16 v[160:161], v19 offset:256
ds_read_b64_tr_b16 v[162:163], v20 offset:256
L_g1_r2b:
ds_read_b128 v[52:55], v9 offset:16384
ds_read_b64_tr_b16 v[72:73], v12 offset:20480
ds_read_b64_tr_b16 v[74:75], v12 offset:21504
ds_read_b64_tr_b16 v[76:77], v13 offset:20480
ds_read_b64_tr_b16 v[78:79], v13 offset:21504
v_lshlrev_b32 v24, 16, v48
v_mfma_f32_32x32x16_bf16 v[104:119], v[60:63], v[48:51], v[104:119]
ds_read_b64_tr_b16 v[80:81], v14 offset:20480
ds_read_b64_tr_b16 v[82:83], v14 offset:21504
ds_read_b64_tr_b16 v[84:85], v15 offset:20480
ds_read_b64_tr_b16 v[86:87], v15 offset:21504
s_add_u32 m0, s56, 1024
s_nop 0
buffer_load_dwordx4 v3, s[8:11], s53 offen lds
v_and_b32 v25, s63, v48
v_fmac_f32 v22, v24, v24
v_fmac_f32 v23, v25, v25
v_mfma_f32_32x32x16_bf16 v[120:135], v[64:67], v[48:51], v[120:135]
v_lshlrev_b32 v26, 16, v49
v_and_b32 v27, s63, v49
v_mfma_f32_32x32x16_bf16 v[136:151], v[68:71], v[48:51], v[136:151]
v_fmac_f32 v22, v26, v26
v_fmac_f32 v23, v27, v27
v_mfma_f32_16x16x32_bf16 v[32:35], v[28:31], v[56:59], v[32:35]
s_waitcnt lgkmcnt(0)
v_mfma_f32_32x32x16_bf16 v[88:103], v[72:75], v[52:55], v[88:103]
s_cmp_eq_u32 s52, 3
s_cbranch_scc0 L_g1_r2c
buffer_store_dwordx4 v[152:155], v21, s[20:23], s71 offen sc1
buffer_store_dwordx4 v[156:159], v21, s[20:23], s72 offen sc1
s_cmp_lt_u32 s47, 2
s_cselect_b64 exec, -1, 0
buffer_store_dwordx4 v[160:163], v21, s[20:23], s73 offen sc1
s_mov_b64 exec, -1
s_mov_b32 s64, s2
s_lshr_b32 s59, s64, 2
s_cmp_lt_u32 s59, 48
s_cselect_b32 s24, s42, s36
s_cselect_b32 s25, s43, s37
s_mov_b32 s26, 819200
s_cselect_b32 s26, 1966080, s26
s_cselect_b32 s60, 0, 48
s_cselect_b32 s61, 4, 8
s_mov_b32 s62, 1280
s_cselect_b32 s62, 2560, s62
s_and_b32 s25, s25, 0xffff
s_mov_b32 s27, 0x20000
s_sub_u32 s69, s59, s60
s_mul_i32 s69, s69, 40960
s_and_b32 s60, s64, 3
s_mul_i32 s60, s60, 320
s_add_u32 s69, s69, s60
s_lshl_b32 s70, s47, 10
s_add_u32 s70, s70, 135168
v_lshrrev_b32 v40, 5, v1
v_lshlrev_b32 v40, 4, v40
v_bfe_u32 v41, v1, 4, 1
v_mul_u32_u24 v41, s61, v41
v_add_u32 v40, v40, v41
v_bfe_u32 v41, v1, 2, 2
v_add_u32 v40, v40, v41
v_mul_u32_u24 v40, 320, v40
v_and_b32 v41, 3, v1
v_lshl_add_u32 v40, v41, 3, v40
s_lshl_b32 s60, s47, 5
s_add_u32 s60, s60, 135168
v_add_u32 v19, s60, v40
v_add_u32 v20, s62, v19
v_lshlrev_b32 v21, 4, v1
s_lshl_b32 s60, s47, 6
v_add_u32 v40, s60, v1
v_mul_u32_u24 v41, 52429, v40
v_lshrrev_b32 v41, 20, v41
v_mul_u32_u24 v42, 20, v41
v_sub_u32 v42, v40, v42
v_mul_u32_u24 v41, 1280, v41
v_lshl_add_u32 v16, v42, 4, v41
v_add_u32 v40, s60, v1
v_add_u32 v40, 256, v40
v_mul_u32_u24 v41, 52429, v40
v_lshrrev_b32 v41, 20, v41
v_mul_u32_u24 v42, 20, v41
v_sub_u32 v42, v40, v42
v_mul_u32_u24 v41, 1280, v41
v_lshl_add_u32 v17, v42, 4, v41
v_add_u32 v40, s60, v1
v_add_u32 v40, 512, v40
v_mul_u32_u24 v41, 52429, v40
v_lshrrev_b32 v41, 20, v41
v_mul_u32_u24 v42, 20, v41
v_sub_u32 v42, v40, v42
v_mul_u32_u24 v41, 1280, v41
v_lshl_add_u32 v18, v42, 4, v41
s_add_u32 s60, s47, 0
s_cmp_ge_u32 s60, 5
s_cselect_b32 s61, 1, 0
s_cselect_b32 s62, 5, 0
s_sub_u32 s60, s60, s62
s_and_b32 s62, s64, 3
s_lshl_b32 s62, s62, 1
s_add_u32 s62, s62, s61
s_mul_i32 s62, s62, 68
s_add_u32 s62, s62, s59
s_mul_i32 s62, s62, 5
s_add_u32 s62, s62, s60
s_lshl_b32 s62, s62, 10
s_add_u32 s71, s62, 16777216
s_add_u32 s60, s47, 4
s_cmp_ge_u32 s60, 5
s_cselect_b32 s61, 1, 0
s_cselect_b32 s62, 5, 0
s_sub_u32 s60, s60, s62
s_and_b32 s62, s64, 3
s_lshl_b32 s62, s62, 1
s_add_u32 s62, s62, s61
s_mul_i32 s62, s62, 68
s_add_u32 s62, s62, s59
s_mul_i32 s62, s62, 5
s_add_u32 s62, s62, s60
s_lshl_b32 s62, s62, 10
s_add_u32 s72, s62, 16777216
s_add_u32 s60, s47, 8
s_cmp_ge_u32 s60, 5
s_cselect_b32 s61, 1, 0
s_cselect_b32 s62, 5, 0
s_sub_u32 s60, s60, s62
s_and_b32 s62, s64, 3
s_lshl_b32 s62, s62, 1
s_add_u32 s62, s62, s61
s_mul_i32 s62, s62, 68
s_add_u32 s62, s62, s59
s_mul_i32 s62, s62, 5
s_add_u32 s62, s62, s60
s_lshl_b32 s62, s62, 10
s_add_u32 s73, s62, 16777216
L_g1_r2c:
ds_read_b128 v[48:51], v10 offset:16384
ds_read_b64_tr_b16 v[56:57], v12 offset:24576
ds_read_b64_tr_b16 v[58:59], v12 offset:25600
ds_read_b64_tr_b16 v[60:61], v13 offset:24576
ds_read_b64_tr_b16 v[62:63], v13 offset:25600
v_lshlrev_b32 v24, 16, v52
v_mfma_f32_32x32x16_bf16 v[104:119], v[76:79], v[52:55], v[104:119]
ds_read_b64_tr_b16 v[64:65], v14 offset:24576
ds_read_b64_tr_b16 v[66:67], v14 offset:25600
ds_read_b64_tr_b16 v[68:69], v15 offset:24576
ds_read_b64_tr_b16 v[70:71], v15 offset:25600
s_add_u32 m0, s57, 1024
s_nop 0
buffer_load_dwordx4 v5, s[12:15], s54 offen lds
v_and_b32 v25, s63, v52
v_fmac_f32 v22, v24, v24
v_fmac_f32 v23, v25, v25
v_mfma_f32_32x32x16_bf16 v[120:135], v[80:83], v[52:55], v[120:135]
v_lshlrev_b32 v26, 16, v53
v_and_b32 v27, s63, v53
v_mfma_f32_32x32x16_bf16 v[136:151], v[84:87], v[52:55], v[136:151]
v_fmac_f32 v22, v26, v26
v_fmac_f32 v23, v27, v27
v_mfma_f32_16x16x32_bf16 v[32:35], v[28:31], v[72:75], v[32:35]
s_waitcnt lgkmcnt(0)
v_mfma_f32_32x32x16_bf16 v[88:103], v[56:59], v[48:51], v[88:103]
ds_read_b128 v[52:55], v11 offset:16384
ds_read_b64_tr_b16 v[72:73], v12 offset:28672
ds_read_b64_tr_b16 v[74:75], v12 offset:29696
ds_read_b64_tr_b16 v[76:77], v13 offset:28672
ds_read_b64_tr_b16 v[78:79], v13 offset:29696
v_lshlrev_b32 v24, 16, v48
v_mfma_f32_32x32x16_bf16 v[104:119], v[60:63], v[48:51], v[104:119]
ds_read_b64_tr_b16 v[80:81], v14 offset:28672
ds_read_b64_tr_b16 v[82:83], v14 offset:29696
ds_read_b64_tr_b16 v[84:85], v15 offset:28672
ds_read_b64_tr_b16 v[86:87], v15 offset:29696
s_add_u32 m0, s58, 0
s_nop 0
buffer_load_dwordx4 v6, s[16:19], s55 offen lds
s_add_u32 s53, s53, 128
s_add_u32 s54, s54, 245760
s_add_u32 s55, s55, 196608
v_and_b32 v25, s63, v48
v_fmac_f32 v22, v24, v24
v_fmac_f32 v23, v25, v25
v_mfma_f32_32x32x16_bf16 v[120:135], v[64:67], v[48:51], v[120:135]
v_lshlrev_b32 v26, 16, v49
v_and_b32 v27, s63, v49
v_mfma_f32_32x32x16_bf16 v[136:151], v[68:71], v[48:51], v[136:151]
v_fmac_f32 v22, v26, v26
v_fmac_f32 v23, v27, v27
v_mfma_f32_16x16x32_bf16 v[32:35], v[28:31], v[56:59], v[32:35]
s_waitcnt lgkmcnt(0)
s_waitcnt vmcnt(5)
s_barrier
v_mfma_f32_32x32x16_bf16 v[88:103], v[72:75], v[52:55], v[88:103]
ds_read_b128 v[48:51], v8 offset:32768
ds_read_b64_tr_b16 v[56:57], v12 offset:32768
ds_read_b64_tr_b16 v[58:59], v12 offset:33792
ds_read_b64_tr_b16 v[60:61], v13 offset:32768
ds_read_b64_tr_b16 v[62:63], v13 offset:33792
v_lshlrev_b32 v24, 16, v52
v_mfma_f32_32x32x16_bf16 v[104:119], v[76:79], v[52:55], v[104:119]
ds_read_b64_tr_b16 v[64:65], v14 offset:32768
ds_read_b64_tr_b16 v[66:67], v14 offset:33792
ds_read_b64_tr_b16 v[68:69], v15 offset:32768
ds_read_b64_tr_b16 v[70:71], v15 offset:33792
s_add_u32 m0, s56, 16384
s_nop 0
buffer_load_dwordx4 v2, s[8:11], s53 offen lds
v_and_b32 v25, s63, v52
v_fmac_f32 v22, v24, v24
v_fmac_f32 v23, v25, v25
v_mfma_f32_32x32x16_bf16 v[120:135], v[80:83], v[52:55], v[120:135]
s_add_u32 m0, s57, 16384
s_nop 0
buffer_load_dwordx4 v4, s[12:15], s54 offen lds
v_lshlrev_b32 v26, 16, v53
v_and_b32 v27, s63, v53
v_mfma_f32_32x32x16_bf16 v[136:151], v[84:87], v[52:55], v[136:151]
v_fmac_f32 v22, v26, v26
v_fmac_f32 v23, v27, v27
v_mfma_f32_16x16x32_bf16 v[32:35], v[28:31], v[72:75], v[32:35]
s_waitcnt lgkmcnt(0)
v_mfma_f32_32x32x16_bf16 v[88:103], v[56:59], v[48:51], v[88:103]
ds_read_b128 v[52:55], v9 offset:32768
ds_read_b64_tr_b16 v[72:73], v12 offset:36864
ds_read_b64_tr_b16 v[74:75], v12 offset:37888
ds_read_b64_tr_b16 v[76:77], v13 offset:36864
ds_read_b64_tr_b16 v[78:79], v13 offset:37888
v_lshlrev_b32 v24, 16, v48
v_mfma_f32_32x32x16_bf16 v[104:119], v[60:63], v[48:51], v[104:119]
ds_read_b64_tr_b16 v[80:81], v14 offset:36864
ds_read_b64_tr_b16 v[82:83], v14 offset:37888
ds_read_b64_tr_b16 v[84:85], v15 offset:36864
ds_read_b64_tr_b16 v[86:87], v15 offset:37888
s_add_u32 m0, s56, 17408
s_nop 0
buffer_load_dwordx4 v3, s[8:11], s53 offen lds
v_and_b32 v25, s63, v48
v_fmac_f32 v22, v24, v24
v_fmac_f32 v23, v25, v25
v_mfma_f32_32x32x16_bf16 v[120:135], v[64:67], v[48:51], v[120:135]
v_lshlrev_b32 v26, 16, v49
v_and_b32 v27, s63, v49
v_mfma_f32_32x32x16_bf16 v[136:151], v[68:71], v[48:51], v[136:151]
v_fmac_f32 v22, v26, v26
v_fmac_f32 v23, v27, v27
v_mfma_f32_16x16x32_bf16 v[32:35], v[28:31], v[56:59], v[32:35]
s_waitcnt lgkmcnt(0)
v_mfma_f32_32x32x16_bf16 v[88:103], v[72:75], v[52:55], v[88:103]
ds_read_b128 v[48:51], v10 offset:32768
ds_read_b64_tr_b16 v[56:57], v12 offset:40960
ds_read_b64_tr_b16 v[58:59], v12 offset:41984
ds_read_b64_tr_b16 v[60:61], v13 offset:40960
ds_read_b64_tr_b16 v[62:63], v13 offset:41984
v_lshlrev_b32 v24, 16, v52
v_mfma_f32_32x32x16_bf16 v[104:119], v[76:79], v[52:55], v[104:119]
ds_read_b64_tr_b16 v[64:65], v14 offset:40960
ds_read_b64_tr_b16 v[66:67], v14 offset:41984
ds_read_b64_tr_b16 v[68:69], v15 offset:40960
ds_read_b64_tr_b16 v[70:71], v15 offset:41984
s_add_u32 m0, s57, 17408
s_nop 0
buffer_load_dwordx4 v5, s[12:15], s54 offen lds
v_and_b32 v25, s63, v52
v_fmac_f32 v22, v24, v24
v_fmac_f32 v23, v25, v25
v_mfma_f32_32x32x16_bf16 v[120:135], v[80:83], v[52:55], v[120:135]
v_lshlrev_b32 v26, 16, v53
v_and_b32 v27, s63, v53
v_mfma_f32_32x32x16_bf16 v[136:151], v[84:87], v[52:55], v[136:151]
v_fmac_f32 v22, v26, v26
v_fmac_f32 v23, v27, v27
v_mfma_f32_16x16x32_bf16 v[32:35], v[28:31], v[72:75], v[32:35]
s_waitcnt lgkmcnt(0)
v_mfma_f32_32x32x16_bf16 v[88:103], v[56:59], v[48:51], v[88:103]
ds_read_b128 v[52:55], v11 offset:32768
ds_read_b64_tr_b16 v[72:73], v12 offset:45056
ds_read_b64_tr_b16 v[74:75], v12 offset:46080
ds_read_b64_tr_b16 v[76:77], v13 offset:45056
ds_read_b64_tr_b16 v[78:79], v13 offset:46080
v_lshlrev_b32 v24, 16, v48
v_mfma_f32_32x32x16_bf16 v[104:119], v[60:63], v[48:51], v[104:119]
ds_read_b64_tr_b16 v[80:81], v14 offset:45056
ds_read_b64_tr_b16 v[82:83], v14 offset:46080
ds_read_b64_tr_b16 v[84:85], v15 offset:45056
ds_read_b64_tr_b16 v[86:87], v15 offset:46080
s_add_u32 m0, s58, 12288
s_nop 0
buffer_load_dwordx4 v6, s[16:19], s55 offen lds
s_add_u32 s53, s53, 128
s_add_u32 s54, s54, 245760
s_add_u32 s55, s55, 196608
v_and_b32 v25, s63, v48
v_fmac_f32 v22, v24, v24
v_fmac_f32 v23, v25, v25
v_mfma_f32_32x32x16_bf16 v[120:135], v[64:67], v[48:51], v[120:135]
v_lshlrev_b32 v26, 16, v49
v_and_b32 v27, s63, v49
v_mfma_f32_32x32x16_bf16 v[136:151], v[68:71], v[48:51], v[136:151]
v_fmac_f32 v22, v26, v26
v_fmac_f32 v23, v27, v27
v_mfma_f32_16x16x32_bf16 v[32:35], v[28:31], v[56:59], v[32:35]
s_waitcnt lgkmcnt(0)
s_waitcnt vmcnt(5)
s_barrier
v_mfma_f32_32x32x16_bf16 v[88:103], v[72:75], v[52:55], v[88:103]
ds_read_b128 v[48:51], v8 offset:0
ds_read_b64_tr_b16 v[56:57], v12 offset:0
ds_read_b64_tr_b16 v[58:59], v12 offset:1024
ds_read_b64_tr_b16 v[60:61], v13 offset:0
ds_read_b64_tr_b16 v[62:63], v13 offset:1024
v_lshlrev_b32 v24, 16, v52
v_mfma_f32_32x32x16_bf16 v[104:119], v[76:79], v[52:55], v[104:119]
ds_read_b64_tr_b16 v[64:65], v14 offset:0
ds_read_b64_tr_b16 v[66:67], v14 offset:1024
ds_read_b64_tr_b16 v[68:69], v15 offset:0
ds_read_b64_tr_b16 v[70:71], v15 offset:1024
s_add_u32 m0, s56, 32768
s_nop 0
buffer_load_dwordx4 v2, s[8:11], s53 offen lds
v_and_b32 v25, s63, v52
v_fmac_f32 v22, v24, v24
v_fmac_f32 v23, v25, v25
v_mfma_f32_32x32x16_bf16 v[120:135], v[80:83], v[52:55], v[120:135]
s_add_u32 m0, s57, 32768
s_nop 0
buffer_load_dwordx4 v4, s[12:15], s54 offen lds
v_lshlrev_b32 v26, 16, v53
v_and_b32 v27, s63, v53
v_mfma_f32_32x32x16_bf16 v[136:151], v[84:87], v[52:55], v[136:151]
v_fmac_f32 v22, v26, v26
v_fmac_f32 v23, v27, v27
v_mfma_f32_16x16x32_bf16 v[32:35], v[28:31], v[72:75], v[32:35]
s_waitcnt lgkmcnt(0)
v_mfma_f32_32x32x16_bf16 v[88:103], v[56:59], v[48:51], v[88:103]
ds_read_b128 v[52:55], v9 offset:0
ds_read_b64_tr_b16 v[72:73], v12 offset:4096
ds_read_b64_tr_b16 v[74:75], v12 offset:5120
ds_read_b64_tr_b16 v[76:77], v13 offset:4096
ds_read_b64_tr_b16 v[78:79], v13 offset:5120
v_lshlrev_b32 v24, 16, v48
v_mfma_f32_32x32x16_bf16 v[104:119], v[60:63], v[48:51], v[104:119]
ds_read_b64_tr_b16 v[80:81], v14 offset:4096
ds_read_b64_tr_b16 v[82:83], v14 offset:5120
ds_read_b64_tr_b16 v[84:85], v15 offset:4096
ds_read_b64_tr_b16 v[86:87], v15 offset:5120
s_add_u32 m0, s56, 33792
s_nop 0
buffer_load_dwordx4 v3, s[8:11], s53 offen lds
v_and_b32 v25, s63, v48
v_fmac_f32 v22, v24, v24
v_fmac_f32 v23, v25, v25
v_mfma_f32_32x32x16_bf16 v[120:135], v[64:67], v[48:51], v[120:135]
v_lshlrev_b32 v26, 16, v49
v_and_b32 v27, s63, v49
v_mfma_f32_32x32x16_bf16 v[136:151], v[68:71], v[48:51], v[136:151]
v_fmac_f32 v22, v26, v26
v_fmac_f32 v23, v27, v27
v_mfma_f32_16x16x32_bf16 v[32:35], v[28:31], v[56:59], v[32:35]
s_waitcnt lgkmcnt(0)
v_mfma_f32_32x32x16_bf16 v[88:103], v[72:75], v[52:55], v[88:103]
ds_read_b128 v[48:51], v10 offset:0
ds_read_b64_tr_b16 v[56:57], v12 offset:8192
ds_read_b64_tr_b16 v[58:59], v12 offset:9216
ds_read_b64_tr_b16 v[60:61], v13 offset:8192
ds_read_b64_tr_b16 v[62:63], v13 offset:9216
v_lshlrev_b32 v24, 16, v52
v_mfma_f32_32x32x16_bf16 v[104:119], v[76:79], v[52:55], v[104:119]
ds_read_b64_tr_b16 v[64:65], v14 offset:8192
ds_read_b64_tr_b16 v[66:67], v14 offset:9216
ds_read_b64_tr_b16 v[68:69], v15 offset:8192
ds_read_b64_tr_b16 v[70:71], v15 offset:9216
s_add_u32 m0, s57, 33792
s_nop 0
buffer_load_dwordx4 v5, s[12:15], s54 offen lds
v_and_b32 v25, s63, v52
v_fmac_f32 v22, v24, v24
v_fmac_f32 v23, v25, v25
v_mfma_f32_32x32x16_bf16 v[120:135], v[80:83], v[52:55], v[120:135]
v_lshlrev_b32 v26, 16, v53
v_and_b32 v27, s63, v53
v_mfma_f32_32x32x16_bf16 v[136:151], v[84:87], v[52:55], v[136:151]
v_fmac_f32 v22, v26, v26
v_fmac_f32 v23, v27, v27
v_mfma_f32_16x16x32_bf16 v[32:35], v[28:31], v[72:75], v[32:35]
s_waitcnt lgkmcnt(0)
v_mfma_f32_32x32x16_bf16 v[88:103], v[56:59], v[48:51], v[88:103]
ds_read_b128 v[52:55], v11 offset:0
ds_read_b64_tr_b16 v[72:73], v12 offset:12288
ds_read_b64_tr_b16 v[74:75], v12 offset:13312
ds_read_b64_tr_b16 v[76:77], v13 offset:12288
ds_read_b64_tr_b16 v[78:79], v13 offset:13312
v_lshlrev_b32 v24, 16, v48
v_mfma_f32_32x32x16_bf16 v[104:119], v[60:63], v[48:51], v[104:119]
ds_read_b64_tr_b16 v[80:81], v14 offset:12288
ds_read_b64_tr_b16 v[82:83], v14 offset:13312
ds_read_b64_tr_b16 v[84:85], v15 offset:12288
ds_read_b64_tr_b16 v[86:87], v15 offset:13312
s_add_u32 m0, s58, 24576
s_nop 0
buffer_load_dwordx4 v6, s[16:19], s55 offen lds
s_add_u32 s53, s53, 128
s_add_u32 s54, s54, 245760
s_add_u32 s55, s55, 196608
v_and_b32 v25, s63, v48
v_fmac_f32 v22, v24, v24
v_fmac_f32 v23, v25, v25
v_mfma_f32_32x32x16_bf16 v[120:135], v[64:67], v[48:51], v[120:135]
v_lshlrev_b32 v26, 16, v49
v_and_b32 v27, s63, v49
v_mfma_f32_32x32x16_bf16 v[136:151], v[68:71], v[48:51], v[136:151]
v_fmac_f32 v22, v26, v26
v_fmac_f32 v23, v27, v27
v_mfma_f32_16x16x32_bf16 v[32:35], v[28:31], v[56:59], v[32:35]
s_waitcnt lgkmcnt(0)
s_waitcnt vmcnt(5)
s_barrier
v_mfma_f32_32x32x16_bf16 v[88:103], v[72:75], v[52:55], v[88:103]
ds_read_b128 v[48:51], v8 offset:16384
ds_read_b64_tr_b16 v[56:57], v12 offset:16384
ds_read_b64_tr_b16 v[58:59], v12 offset:17408
ds_read_b64_tr_b16 v[60:61], v13 offset:16384
ds_read_b64_tr_b16 v[62:63], v13 offset:17408
v_lshlrev_b32 v24, 16, v52
v_mfma_f32_32x32x16_bf16 v[104:119], v[76:79], v[52:55], v[104:119]
ds_read_b64_tr_b16 v[64:65], v14 offset:16384
ds_read_b64_tr_b16 v[66:67], v14 offset:17408
ds_read_b64_tr_b16 v[68:69], v15 offset:16384
ds_read_b64_tr_b16 v[70:71], v15 offset:17408
s_add_u32 m0, s56, 0
s_nop 0
buffer_load_dwordx4 v2, s[8:11], s53 offen lds
v_and_b32 v25, s63, v52
v_fmac_f32 v22, v24, v24
v_fmac_f32 v23, v25, v25
v_mfma_f32_32x32x16_bf16 v[120:135], v[80:83], v[52:55], v[120:135]
s_add_u32 m0, s57, 0
s_nop 0
buffer_load_dwordx4 v4, s[12:15], s54 offen lds
v_lshlrev_b32 v26, 16, v53
v_and_b32 v27, s63, v53
v_mfma_f32_32x32x16_bf16 v[136:151], v[84:87], v[52:55], v[136:151]
v_fmac_f32 v22, v26, v26
v_fmac_f32 v23, v27, v27
v_mfma_f32_16x16x32_bf16 v[32:35], v[28:31], v[72:75], v[32:35]
s_waitcnt lgkmcnt(0)
v_mfma_f32_32x32x16_bf16 v[88:103], v[56:59], v[48:51], v[88:103]
ds_read_b128 v[52:55], v9 offset:16384
ds_read_b64_tr_b16 v[72:73], v12 offset:20480
ds_read_b64_tr_b16 v[74:75], v12 offset:21504
ds_read_b64_tr_b16 v[76:77], v13 offset:20480
ds_read_b64_tr_b16 v[78:79], v13 offset:21504
v_lshlrev_b32 v24, 16, v48
v_mfma_f32_32x32x16_bf16 v[104:119], v[60:63], v[48:51], v[104:119]
ds_read_b64_tr_b16 v[80:81], v14 offset:20480
ds_read_b64_tr_b16 v[82:83], v14 offset:21504
ds_read_b64_tr_b16 v[84:85], v15 offset:20480
ds_read_b64_tr_b16 v[86:87], v15 offset:21504
s_add_u32 m0, s56, 1024
s_nop 0
buffer_load_dwordx4 v3, s[8:11], s53 offen lds
v_and_b32 v25, s63, v48
v_fmac_f32 v22, v24, v24
v_fmac_f32 v23, v25, v25
v_mfma_f32_32x32x16_bf16 v[120:135], v[64:67], v[48:51], v[120:135]
s_add_u32 m0, s57, 1024
s_nop 0
buffer_load_dwordx4 v5, s[12:15], s54 offen lds
v_lshlrev_b32 v26, 16, v49
v_and_b32 v27, s63, v49
v_mfma_f32_32x32x16_bf16 v[136:151], v[68:71], v[48:51], v[136:151]
v_fmac_f32 v22, v26, v26
v_fmac_f32 v23, v27, v27
v_mfma_f32_16x16x32_bf16 v[32:35], v[28:31], v[56:59], v[32:35]
s_waitcnt lgkmcnt(0)
v_mfma_f32_32x32x16_bf16 v[88:103], v[72:75], v[52:55], v[88:103]
ds_read_b128 v[48:51], v10 offset:16384
ds_read_b64_tr_b16 v[56:57], v12 offset:24576
ds_read_b64_tr_b16 v[58:59], v12 offset:25600
ds_read_b64_tr_b16 v[60:61], v13 offset:24576
ds_read_b64_tr_b16 v[62:63], v13 offset:25600
v_lshlrev_b32 v24, 16, v52
v_mfma_f32_32x32x16_bf16 v[104:119], v[76:79], v[52:55], v[104:119]
ds_read_b64_tr_b16 v[64:65], v14 offset:24576
ds_read_b64_tr_b16 v[66:67], v14 offset:25600
ds_read_b64_tr_b16 v[68:69], v15 offset:24576
ds_read_b64_tr_b16 v[70:71], v15 offset:25600
s_add_u32 m0, s58, 0
s_nop 0
buffer_load_dwordx4 v6, s[16:19], s55 offen lds
s_add_u32 s53, s53, 128
s_add_u32 s54, s54, 245760
s_add_u32 s55, s55, 196608
v_and_b32 v25, s63, v52
v_fmac_f32 v22, v24, v24
v_fmac_f32 v23, v25, v25
v_mfma_f32_32x32x16_bf16 v[120:135], v[80:83], v[52:55], v[120:135]
s_add_u32 m0, s70, 0
s_nop 0
buffer_load_dwordx4 v16, s[24:27], s69 offen lds
v_lshlrev_b32 v26, 16, v53
v_and_b32 v27, s63, v53
v_mfma_f32_32x32x16_bf16 v[136:151], v[84:87], v[52:55], v[136:151]
v_fmac_f32 v22, v26, v26
v_fmac_f32 v23, v27, v27
v_mfma_f32_16x16x32_bf16 v[32:35], v[28:31], v[72:75], v[32:35]
s_waitcnt lgkmcnt(0)
v_mfma_f32_32x32x16_bf16 v[88:103], v[56:59], v[48:51], v[88:103]
ds_read_b128 v[52:55], v11 offset:16384
ds_read_b64_tr_b16 v[72:73], v12 offset:28672
ds_read_b64_tr_b16 v[74:75], v12 offset:29696
ds_read_b64_tr_b16 v[76:77], v13 offset:28672
ds_read_b64_tr_b16 v[78:79], v13 offset:29696
v_lshlrev_b32 v24, 16, v48
v_mfma_f32_32x32x16_bf16 v[104:119], v[60:63], v[48:51], v[104:119]
ds_read_b64_tr_b16 v[80:81], v14 offset:28672
ds_read_b64_tr_b16 v[82:83], v14 offset:29696
ds_read_b64_tr_b16 v[84:85], v15 offset:28672
ds_read_b64_tr_b16 v[86:87], v15 offset:29696
s_add_u32 m0, s70, 4096
s_nop 0
buffer_load_dwordx4 v17, s[24:27], s69 offen lds
v_and_b32 v25, s63, v48
v_fmac_f32 v22, v24, v24
v_fmac_f32 v23, v25, v25
v_mfma_f32_32x32x16_bf16 v[120:135], v[64:67], v[48:51], v[120:135]
s_add_u32 m0, s70, 8192
s_nop 0
buffer_load_dwordx4 v18, s[24:27], s69 offen lds
v_lshlrev_b32 v26, 16, v49
v_and_b32 v27, s63, v49
v_mfma_f32_32x32x16_bf16 v[136:151], v[68:71], v[48:51], v[136:151]
v_fmac_f32 v22, v26, v26
v_fmac_f32 v23, v27, v27
v_mfma_f32_16x16x32_bf16 v[32:35], v[28:31], v[56:59], v[32:35]
s_waitcnt lgkmcnt(0)
s_waitcnt vmcnt(8)
s_barrier
v_mfma_f32_32x32x16_bf16 v[88:103], v[72:75], v[52:55], v[88:103]
ds_read_b128 v[48:51], v8 offset:32768
ds_read_b64_tr_b16 v[56:57], v12 offset:32768
ds_read_b64_tr_b16 v[58:59], v12 offset:33792
ds_read_b64_tr_b16 v[60:61], v13 offset:32768
ds_read_b64_tr_b16 v[62:63], v13 offset:33792
v_lshlrev_b32 v24, 16, v52
v_mfma_f32_32x32x16_bf16 v[104:119], v[76:79], v[52:55], v[104:119]
ds_read_b64_tr_b16 v[64:65], v14 offset:32768
ds_read_b64_tr_b16 v[66:67], v14 offset:33792
ds_read_b64_tr_b16 v[68:69], v15 offset:32768
ds_read_b64_tr_b16 v[70:71], v15 offset:33792
v_and_b32 v25, s63, v52
v_fmac_f32 v22, v24, v24
v_fmac_f32 v23, v25, v25
v_mfma_f32_32x32x16_bf16 v[120:135], v[80:83], v[52:55], v[120:135]
v_lshlrev_b32 v26, 16, v53
v_and_b32 v27, s63, v53
v_mfma_f32_32x32x16_bf16 v[136:151], v[84:87], v[52:55], v[136:151]
v_fmac_f32 v22, v26, v26
v_fmac_f32 v23, v27, v27
v_mfma_f32_16x16x32_bf16 v[32:35], v[28:31], v[72:75], v[32:35]
s_waitcnt lgkmcnt(0)
v_mfma_f32_32x32x16_bf16 v[88:103], v[56:59], v[48:51], v[88:103]
ds_read_b128 v[52:55], v9 offset:32768
ds_read_b64_tr_b16 v[72:73], v12 offset:36864
ds_read_b64_tr_b16 v[74:75], v12 offset:37888
ds_read_b64_tr_b16 v[76:77], v13 offset:36864
ds_read_b64_tr_b16 v[78:79], v13 offset:37888
v_lshlrev_b32 v24, 16, v48
v_mfma_f32_32x32x16_bf16 v[104:119], v[60:63], v[48:51], v[104:119]
ds_read_b64_tr_b16 v[80:81], v14 offset:36864
ds_read_b64_tr_b16 v[82:83], v14 offset:37888
ds_read_b64_tr_b16 v[84:85], v15 offset:36864
ds_read_b64_tr_b16 v[86:87], v15 offset:37888
v_and_b32 v25, s63, v48
v_fmac_f32 v22, v24, v24
v_fmac_f32 v23, v25, v25
v_mfma_f32_32x32x16_bf16 v[120:135], v[64:67], v[48:51], v[120:135]
v_lshlrev_b32 v26, 16, v49
v_and_b32 v27, s63, v49
v_mfma_f32_32x32x16_bf16 v[136:151], v[68:71], v[48:51], v[136:151]
v_fmac_f32 v22, v26, v26
v_fmac_f32 v23, v27, v27
v_mfma_f32_16x16x32_bf16 v[32:35], v[28:31], v[56:59], v[32:35]
s_waitcnt lgkmcnt(0)
v_mfma_f32_32x32x16_bf16 v[88:103], v[72:75], v[52:55], v[88:103]
ds_read_b128 v[48:51], v10 offset:32768
ds_read_b64_tr_b16 v[56:57], v12 offset:40960
ds_read_b64_tr_b16 v[58:59], v12 offset:41984
ds_read_b64_tr_b16 v[60:61], v13 offset:40960
ds_read_b64_tr_b16 v[62:63], v13 offset:41984
v_lshlrev_b32 v24, 16, v52
v_mfma_f32_32x32x16_bf16 v[104:119], v[76:79], v[52:55], v[104:119]
ds_read_b64_tr_b16 v[64:65], v14 offset:40960
ds_read_b64_tr_b16 v[66:67], v14 offset:41984
ds_read_b64_tr_b16 v[68:69], v15 offset:40960
ds_read_b64_tr_b16 v[70:71], v15 offset:41984
v_and_b32 v25, s63, v52
v_fmac_f32 v22, v24, v24
v_fmac_f32 v23, v25, v25
v_mfma_f32_32x32x16_bf16 v[120:135], v[80:83], v[52:55], v[120:135]
v_lshlrev_b32 v26, 16, v53
v_and_b32 v27, s63, v53
v_mfma_f32_32x32x16_bf16 v[136:151], v[84:87], v[52:55], v[136:151]
v_fmac_f32 v22, v26, v26
v_fmac_f32 v23, v27, v27
v_mfma_f32_16x16x32_bf16 v[32:35], v[28:31], v[72:75], v[32:35]
s_waitcnt lgkmcnt(0)
v_mfma_f32_32x32x16_bf16 v[88:103], v[56:59], v[48:51], v[88:103]
ds_read_b128 v[52:55], v11 offset:32768
ds_read_b64_tr_b16 v[72:73], v12 offset:45056
ds_read_b64_tr_b16 v[74:75], v12 offset:46080
ds_read_b64_tr_b16 v[76:77], v13 offset:45056
ds_read_b64_tr_b16 v[78:79], v13 offset:46080
v_lshlrev_b32 v24, 16, v48
v_mfma_f32_32x32x16_bf16 v[104:119], v[60:63], v[48:51], v[104:119]
ds_read_b64_tr_b16 v[80:81], v14 offset:45056
ds_read_b64_tr_b16 v[82:83], v14 offset:46080
ds_read_b64_tr_b16 v[84:85], v15 offset:45056
ds_read_b64_tr_b16 v[86:87], v15 offset:46080
v_and_b32 v25, s63, v48
v_fmac_f32 v22, v24, v24
v_fmac_f32 v23, v25, v25
v_mfma_f32_32x32x16_bf16 v[120:135], v[64:67], v[48:51], v[120:135]
v_lshlrev_b32 v26, 16, v49
v_and_b32 v27, s63, v49
v_mfma_f32_32x32x16_bf16 v[136:151], v[68:71], v[48:51], v[136:151]
v_fmac_f32 v22, v26, v26
v_fmac_f32 v23, v27, v27
v_mfma_f32_16x16x32_bf16 v[32:35], v[28:31], v[56:59], v[32:35]
s_waitcnt lgkmcnt(0)
s_waitcnt vmcnt(3)
s_waitcnt vmcnt(0)
s_barrier
v_mfma_f32_32x32x16_bf16 v[88:103], v[72:75], v[52:55], v[88:103]
ds_read_b128 v[48:51], v8 offset:0
ds_read_b64_tr_b16 v[56:57], v12 offset:0
ds_read_b64_tr_b16 v[58:59], v12 offset:1024
ds_read_b64_tr_b16 v[60:61], v13 offset:0
ds_read_b64_tr_b16 v[62:63], v13 offset:1024
v_lshlrev_b32 v24, 16, v52
v_mfma_f32_32x32x16_bf16 v[104:119], v[76:79], v[52:55], v[104:119]
ds_read_b64_tr_b16 v[64:65], v14 offset:0
ds_read_b64_tr_b16 v[66:67], v14 offset:1024
ds_read_b64_tr_b16 v[68:69], v15 offset:0
ds_read_b64_tr_b16 v[70:71], v15 offset:1024
v_and_b32 v25, s63, v52
v_fmac_f32 v22, v24, v24
v_fmac_f32 v23, v25, v25
v_mfma_f32_32x32x16_bf16 v[120:135], v[80:83], v[52:55], v[120:135]
v_lshlrev_b32 v26, 16, v53
v_and_b32 v27, s63, v53
v_mfma_f32_32x32x16_bf16 v[136:151], v[84:87], v[52:55], v[136:151]
v_fmac_f32 v22, v26, v26
v_fmac_f32 v23, v27, v27
v_mfma_f32_16x16x32_bf16 v[32:35], v[28:31], v[72:75], v[32:35]
s_waitcnt lgkmcnt(0)
v_mfma_f32_32x32x16_bf16 v[88:103], v[56:59], v[48:51], v[88:103]
ds_read_b128 v[52:55], v9 offset:0
ds_read_b64_tr_b16 v[72:73], v12 offset:4096
ds_read_b64_tr_b16 v[74:75], v12 offset:5120
ds_read_b64_tr_b16 v[76:77], v13 offset:4096
ds_read_b64_tr_b16 v[78:79], v13 offset:5120
v_lshlrev_b32 v24, 16, v48
v_mfma_f32_32x32x16_bf16 v[104:119], v[60:63], v[48:51], v[104:119]
ds_read_b64_tr_b16 v[80:81], v14 offset:4096
ds_read_b64_tr_b16 v[82:83], v14 offset:5120
ds_read_b64_tr_b16 v[84:85], v15 offset:4096
ds_read_b64_tr_b16 v[86:87], v15 offset:5120
ds_read_b64_tr_b16 v[152:153], v19 offset:0
ds_read_b64_tr_b16 v[154:155], v20 offset:0
ds_read_b64_tr_b16 v[156:157], v19 offset:128
ds_read_b64_tr_b16 v[158:159], v20 offset:128
ds_read_b64_tr_b16 v[160:161], v19 offset:256
ds_read_b64_tr_b16 v[162:163], v20 offset:256
v_and_b32 v25, s63, v48
v_fmac_f32 v22, v24, v24
v_fmac_f32 v23, v25, v25
v_mfma_f32_32x32x16_bf16 v[120:135], v[64:67], v[48:51], v[120:135]
v_lshlrev_b32 v26, 16, v49
v_and_b32 v27, s63, v49
v_mfma_f32_32x32x16_bf16 v[136:151], v[68:71], v[48:51], v[136:151]
v_fmac_f32 v22, v26, v26
v_fmac_f32 v23, v27, v27
v_mfma_f32_16x16x32_bf16 v[32:35], v[28:31], v[56:59], v[32:35]
s_waitcnt lgkmcnt(0)
v_mfma_f32_32x32x16_bf16 v[88:103], v[72:75], v[52:55], v[88:103]
ds_read_b128 v[48:51], v10 offset:0
ds_read_b64_tr_b16 v[56:57], v12 offset:8192
ds_read_b64_tr_b16 v[58:59], v12 offset:9216
ds_read_b64_tr_b16 v[60:61], v13 offset:8192
ds_read_b64_tr_b16 v[62:63], v13 offset:9216
v_lshlrev_b32 v24, 16, v52
v_mfma_f32_32x32x16_bf16 v[104:119], v[76:79], v[52:55], v[104:119]
ds_read_b64_tr_b16 v[64:65], v14 offset:8192
ds_read_b64_tr_b16 v[66:67], v14 offset:9216
ds_read_b64_tr_b16 v[68:69], v15 offset:8192
ds_read_b64_tr_b16 v[70:71], v15 offset:9216
v_and_b32 v25, s63, v52
v_fmac_f32 v22, v24, v24
v_fmac_f32 v23, v25, v25
v_mfma_f32_32x32x16_bf16 v[120:135], v[80:83], v[52:55], v[120:135]
buffer_store_dwordx4 v[152:155], v21, s[20:23], s71 offen sc1
buffer_store_dwordx4 v[156:159], v21, s[20:23], s72 offen sc1
s_cmp_lt_u32 s47, 2
s_cselect_b64 exec, -1, 0
buffer_store_dwordx4 v[160:163], v21, s[20:23], s73 offen sc1
s_mov_b64 exec, -1
v_lshlrev_b32 v26, 16, v53
v_and_b32 v27, s63, v53
v_mfma_f32_32x32x16_bf16 v[136:151], v[84:87], v[52:55], v[136:151]
v_fmac_f32 v22, v26, v26
v_fmac_f32 v23, v27, v27
v_mfma_f32_16x16x32_bf16 v[32:35], v[28:31], v[72:75], v[32:35]
s_waitcnt lgkmcnt(0)
v_mfma_f32_32x32x16_bf16 v[88:103], v[56:59], v[48:51], v[88:103]
ds_read_b128 v[52:55], v11 offset:0
ds_read_b64_tr_b16 v[72:73], v12 offset:12288
ds_read_b64_tr_b16 v[74:75], v12 offset:13312
ds_read_b64_tr_b16 v[76:77], v13 offset:12288
ds_read_b64_tr_b16 v[78:79], v13 offset:13312
v_lshlrev_b32 v24, 16, v48
v_mfma_f32_32x32x16_bf16 v[104:119], v[60:63], v[48:51], v[104:119]
ds_read_b64_tr_b16 v[80:81], v14 offset:12288
ds_read_b64_tr_b16 v[82:83], v14 offset:13312
ds_read_b64_tr_b16 v[84:85], v15 offset:12288
ds_read_b64_tr_b16 v[86:87], v15 offset:13312
v_and_b32 v25, s63, v48
v_fmac_f32 v22, v24, v24
v_fmac_f32 v23, v25, v25
v_mfma_f32_32x32x16_bf16 v[120:135], v[64:67], v[48:51], v[120:135]
s_lshr_b32 s59, s2, 3
s_mul_i32 s59, s59, 278528
s_and_b32 s60, s2, 7
s_mul_i32 s60, s60, 10240
s_add_u32 s59, s59, s60
s_mul_i32 s60, s47, 2560
s_add_u32 s59, s59, s60
s_add_u32 s59, s59, 8060928
v_lshlrev_b32 v172, 4, v1
v_mov_b32 v168, -1
v_mov_b32 v169, -1
v_mov_b32 v170, -1
v_mov_b32 v171, -1
buffer_store_dwordx4 v[168:171], v172, s[20:23], s59 offen sc1
buffer_store_dwordx4 v[168:171], v172, s[20:23], s59 offen offset:1024 sc1
s_mov_b32 exec_hi, 0
buffer_store_dwordx4 v[168:171], v172, s[20:23], s59 offen offset:2048 sc1
s_mov_b64 exec, -1
v_lshlrev_b32 v26, 16, v49
v_and_b32 v27, s63, v49
v_mfma_f32_32x32x16_bf16 v[136:151], v[68:71], v[48:51], v[136:151]
v_fmac_f32 v22, v26, v26
v_fmac_f32 v23, v27, v27
v_mfma_f32_16x16x32_bf16 v[32:35], v[28:31], v[56:59], v[32:35]
s_waitcnt lgkmcnt(0)
v_mfma_f32_32x32x16_bf16 v[88:103], v[72:75], v[52:55], v[88:103]
v_lshlrev_b32 v24, 16, v52
v_mfma_f32_32x32x16_bf16 v[104:119], v[76:79], v[52:55], v[104:119]
v_and_b32 v25, s63, v52
v_fmac_f32 v22, v24, v24
v_fmac_f32 v23, v25, v25
v_mfma_f32_32x32x16_bf16 v[120:135], v[80:83], v[52:55], v[120:135]
v_lshlrev_b32 v26, 16, v53
v_and_b32 v27, s63, v53
v_mfma_f32_32x32x16_bf16 v[136:151], v[84:87], v[52:55], v[136:151]
v_fmac_f32 v22, v26, v26
v_fmac_f32 v23, v27, v27
v_mfma_f32_16x16x32_bf16 v[32:35], v[28:31], v[72:75], v[32:35]
v_add_f32 v22, v22, v23
v_mov_b32 v23, v22
v_and_b32 v40, 31, v1
v_lshlrev_b32 v40, 2, v40
v_permlane32_swap_b32 v22, v23
s_lshl_b32 s59, s47, 7
s_add_u32 s60, s59, 147968
v_add_u32 v41, s60, v40
v_add_f32 v22, v22, v23
ds_write_b32 v41, v22
s_lshl_b32 s60, s65, 7
s_add_u32 s60, s60, 149504
v_add_u32 v41, s60, v40
s_mov_b64 exec, 0xffff
ds_write2_b32 v41, v32, v33 offset0:0 offset1:16
s_mov_b64 exec, -1
s_add_u32 s59, s59, 147456
v_add_u32 v41, s59, v40
s_waitcnt lgkmcnt(0)
s_barrier
ds_read_b32 v42, v41
ds_read2st64_b32 v[24:25], v41 offset0:2 offset1:4
v_lshrrev_b32 v46, 5, v1
v_lshlrev_b32 v46, 4, v46
v_add_u32 v46, 149504, v46
s_lshl_b32 s59, s65, 7
v_add_u32 v47, s59, v46
ds_read_b128 v[152:155], v47 offset:0
ds_read_b128 v[156:159], v47 offset:32
ds_read_b128 v[160:163], v47 offset:64
ds_read_b128 v[164:167], v47 offset:96
s_lshl_b32 s59, s66, 7
v_add_u32 v47, s59, v46
ds_read_b128 v[168:171], v47 offset:0
ds_read_b128 v[172:175], v47 offset:32
ds_read_b128 v[176:179], v47 offset:64
ds_read_b128 v[180:183], v47 offset:96
s_lshl_b32 s59, s67, 7
v_add_u32 v47, s59, v46
ds_read_b128 v[184:187], v47 offset:0
ds_read_b128 v[188:191], v47 offset:32
ds_read_b128 v[192:195], v47 offset:64
ds_read_b128 v[196:199], v47 offset:96
s_lshl_b32 s59, s68, 7
v_add_u32 v47, s59, v46
ds_read_b128 v[200:203], v47 offset:0
ds_read_b128 v[204:207], v47 offset:32
ds_read_b128 v[208:211], v47 offset:64
ds_read_b128 v[212:215], v47 offset:96
s_waitcnt lgkmcnt(15)
s_waitcnt lgkmcnt(0)
v_add_f32 v44, v24, v25
v_mul_f32 v42, 0x3acccccd, v42
v_mul_f32 v44, 0x3acccccd, v44
v_fma_f32 v44, -v42, v42, v44
v_max_f32 v44, 0, v44
v_cvt_pk_bf16_f32 v44, v44, v42
v_and_b32 v42, s63, v44
v_lshlrev_b32 v44, 16, v44
v_add_f32 v44, 0x3727c5ac, v44
v_cvt_pk_bf16_f32 v44, v44, v44
v_lshlrev_b32 v44, 16, v44
v_sqrt_f32 v44, v44
s_nop 0
v_cvt_pk_bf16_f32 v44, v44, v44
v_lshlrev_b32 v44, 16, v44
v_rcp_f32 v44, v44
s_cmp_eq_u32 s52, 3
s_cbranch_scc1 L_g1_none
s_cmp_eq_u32 s52, 0
s_cselect_b32 s59, 0x3ea52b5c, 0x3f800000
v_mul_f32 v44, s59, v44
v_lshlrev_b32 v41, 4, v1
s_mul_i32 s60, s52, 2621440
s_lshl_b32 s61, s49, 2
s_add_u32 s61, s61, s47
s_mul_i32 s61, s61, 80
s_lshl_b32 s62, s51, 4
s_add_u32 s61, s61, s62
s_lshl_b32 s61, s61, 9
s_add_u32 s60, s60, s61
v_pk_fma_f32 v[88:89], v[152:153], v[42:43], v[88:89] op_sel_hi:[1,0,1] neg_lo:[0,1,0] neg_hi:[0,1,0]
v_pk_fma_f32 v[90:91], v[154:155], v[42:43], v[90:91] op_sel_hi:[1,0,1] neg_lo:[0,1,0] neg_hi:[0,1,0]
v_pk_fma_f32 v[92:93], v[156:157], v[42:43], v[92:93] op_sel_hi:[1,0,1] neg_lo:[0,1,0] neg_hi:[0,1,0]
v_pk_fma_f32 v[94:95], v[158:159], v[42:43], v[94:95] op_sel_hi:[1,0,1] neg_lo:[0,1,0] neg_hi:[0,1,0]
v_pk_fma_f32 v[96:97], v[160:161], v[42:43], v[96:97] op_sel_hi:[1,0,1] neg_lo:[0,1,0] neg_hi:[0,1,0]
v_pk_fma_f32 v[98:99], v[162:163], v[42:43], v[98:99] op_sel_hi:[1,0,1] neg_lo:[0,1,0] neg_hi:[0,1,0]
v_pk_fma_f32 v[100:101], v[164:165], v[42:43], v[100:101] op_sel_hi:[1,0,1] neg_lo:[0,1,0] neg_hi:[0,1,0]
v_pk_fma_f32 v[102:103], v[166:167], v[42:43], v[102:103] op_sel_hi:[1,0,1] neg_lo:[0,1,0] neg_hi:[0,1,0]
v_pk_mul_f32 v[88:89], v[88:89], v[44:45] op_sel_hi:[1,0]
v_pk_mul_f32 v[90:91], v[90:91], v[44:45] op_sel_hi:[1,0]
v_pk_mul_f32 v[92:93], v[92:93], v[44:45] op_sel_hi:[1,0]
v_pk_mul_f32 v[94:95], v[94:95], v[44:45] op_sel_hi:[1,0]
v_pk_mul_f32 v[96:97], v[96:97], v[44:45] op_sel_hi:[1,0]
v_pk_mul_f32 v[98:99], v[98:99], v[44:45] op_sel_hi:[1,0]
v_pk_mul_f32 v[100:101], v[100:101], v[44:45] op_sel_hi:[1,0]
v_pk_mul_f32 v[102:103], v[102:103], v[44:45] op_sel_hi:[1,0]
v_cvt_pk_bf16_f32 v56, v88, v89
v_cvt_pk_bf16_f32 v57, v90, v91
v_cvt_pk_bf16_f32 v58, v92, v93
v_cvt_pk_bf16_f32 v59, v94, v95
v_cvt_pk_bf16_f32 v60, v96, v97
v_cvt_pk_bf16_f32 v61, v98, v99
v_cvt_pk_bf16_f32 v62, v100, v101
v_cvt_pk_bf16_f32 v63, v102, v103
v_permlane32_swap_b32 v56, v58
v_permlane32_swap_b32 v57, v59
v_permlane32_swap_b32 v60, v62
v_permlane32_swap_b32 v61, v63
s_lshl_b32 s59, s65, 11
s_add_u32 s59, s59, s60
buffer_store_dwordx4 v[56:59], v41, s[20:23], s59 offen sc1
buffer_store_dwordx4 v[60:63], v41, s[20:23], s59 offen offset:1024 sc1
v_pk_fma_f32 v[104:105], v[168:169], v[42:43], v[104:105] op_sel_hi:[1,0,1] neg_lo:[0,1,0] neg_hi:[0,1,0]
v_pk_fma_f32 v[106:107], v[170:171], v[42:43], v[106:107] op_sel_hi:[1,0,1] neg_lo:[0,1,0] neg_hi:[0,1,0]
v_pk_fma_f32 v[108:109], v[172:173], v[42:43], v[108:109] op_sel_hi:[1,0,1] neg_lo:[0,1,0] neg_hi:[0,1,0]
v_pk_fma_f32 v[110:111], v[174:175], v[42:43], v[110:111] op_sel_hi:[1,0,1] neg_lo:[0,1,0] neg_hi:[0,1,0]
v_pk_fma_f32 v[112:113], v[176:177], v[42:43], v[112:113] op_sel_hi:[1,0,1] neg_lo:[0,1,0] neg_hi:[0,1,0]
v_pk_fma_f32 v[114:115], v[178:179], v[42:43], v[114:115] op_sel_hi:[1,0,1] neg_lo:[0,1,0] neg_hi:[0,1,0]
v_pk_fma_f32 v[116:117], v[180:181], v[42:43], v[116:117] op_sel_hi:[1,0,1] neg_lo:[0,1,0] neg_hi:[0,1,0]
v_pk_fma_f32 v[118:119], v[182:183], v[42:43], v[118:119] op_sel_hi:[1,0,1] neg_lo:[0,1,0] neg_hi:[0,1,0]
v_pk_mul_f32 v[104:105], v[104:105], v[44:45] op_sel_hi:[1,0]
v_pk_mul_f32 v[106:107], v[106:107], v[44:45] op_sel_hi:[1,0]
v_pk_mul_f32 v[108:109], v[108:109], v[44:45] op_sel_hi:[1,0]
v_pk_mul_f32 v[110:111], v[110:111], v[44:45] op_sel_hi:[1,0]
v_pk_mul_f32 v[112:113], v[112:113], v[44:45] op_sel_hi:[1,0]
v_pk_mul_f32 v[114:115], v[114:115], v[44:45] op_sel_hi:[1,0]
v_pk_mul_f32 v[116:117], v[116:117], v[44:45] op_sel_hi:[1,0]
v_pk_mul_f32 v[118:119], v[118:119], v[44:45] op_sel_hi:[1,0]
v_cvt_pk_bf16_f32 v64, v104, v105
v_cvt_pk_bf16_f32 v65, v106, v107
v_cvt_pk_bf16_f32 v66, v108, v109
v_cvt_pk_bf16_f32 v67, v110, v111
v_cvt_pk_bf16_f32 v68, v112, v113
v_cvt_pk_bf16_f32 v69, v114, v115
v_cvt_pk_bf16_f32 v70, v116, v117
v_cvt_pk_bf16_f32 v71, v118, v119
v_permlane32_swap_b32 v64, v66
v_permlane32_swap_b32 v65, v67
v_permlane32_swap_b32 v68, v70
v_permlane32_swap_b32 v69, v71
s_lshl_b32 s59, s66, 11
s_add_u32 s59, s59, s60
buffer_store_dwordx4 v[64:67], v41, s[20:23], s59 offen sc1
buffer_store_dwordx4 v[68:71], v41, s[20:23], s59 offen offset:1024 sc1
v_pk_fma_f32 v[120:121], v[184:185], v[42:43], v[120:121] op_sel_hi:[1,0,1] neg_lo:[0,1,0] neg_hi:[0,1,0]
v_pk_fma_f32 v[122:123], v[186:187], v[42:43], v[122:123] op_sel_hi:[1,0,1] neg_lo:[0,1,0] neg_hi:[0,1,0]
v_pk_fma_f32 v[124:125], v[188:189], v[42:43], v[124:125] op_sel_hi:[1,0,1] neg_lo:[0,1,0] neg_hi:[0,1,0]
v_pk_fma_f32 v[126:127], v[190:191], v[42:43], v[126:127] op_sel_hi:[1,0,1] neg_lo:[0,1,0] neg_hi:[0,1,0]
v_pk_fma_f32 v[128:129], v[192:193], v[42:43], v[128:129] op_sel_hi:[1,0,1] neg_lo:[0,1,0] neg_hi:[0,1,0]
v_pk_fma_f32 v[130:131], v[194:195], v[42:43], v[130:131] op_sel_hi:[1,0,1] neg_lo:[0,1,0] neg_hi:[0,1,0]
v_pk_fma_f32 v[132:133], v[196:197], v[42:43], v[132:133] op_sel_hi:[1,0,1] neg_lo:[0,1,0] neg_hi:[0,1,0]
v_pk_fma_f32 v[134:135], v[198:199], v[42:43], v[134:135] op_sel_hi:[1,0,1] neg_lo:[0,1,0] neg_hi:[0,1,0]
v_pk_mul_f32 v[120:121], v[120:121], v[44:45] op_sel_hi:[1,0]
v_pk_mul_f32 v[122:123], v[122:123], v[44:45] op_sel_hi:[1,0]
v_pk_mul_f32 v[124:125], v[124:125], v[44:45] op_sel_hi:[1,0]
v_pk_mul_f32 v[126:127], v[126:127], v[44:45] op_sel_hi:[1,0]
v_pk_mul_f32 v[128:129], v[128:129], v[44:45] op_sel_hi:[1,0]
v_pk_mul_f32 v[130:131], v[130:131], v[44:45] op_sel_hi:[1,0]
v_pk_mul_f32 v[132:133], v[132:133], v[44:45] op_sel_hi:[1,0]
v_pk_mul_f32 v[134:135], v[134:135], v[44:45] op_sel_hi:[1,0]
v_cvt_pk_bf16_f32 v56, v120, v121
v_cvt_pk_bf16_f32 v57, v122, v123
v_cvt_pk_bf16_f32 v58, v124, v125
v_cvt_pk_bf16_f32 v59, v126, v127
v_cvt_pk_bf16_f32 v60, v128, v129
v_cvt_pk_bf16_f32 v61, v130, v131
v_cvt_pk_bf16_f32 v62, v132, v133
v_cvt_pk_bf16_f32 v63, v134, v135
v_permlane32_swap_b32 v56, v58
v_permlane32_swap_b32 v57, v59
v_permlane32_swap_b32 v60, v62
v_permlane32_swap_b32 v61, v63
s_lshl_b32 s59, s67, 11
s_add_u32 s59, s59, s60
buffer_store_dwordx4 v[56:59], v41, s[20:23], s59 offen sc1
buffer_store_dwordx4 v[60:63], v41, s[20:23], s59 offen offset:1024 sc1
v_pk_fma_f32 v[136:137], v[200:201], v[42:43], v[136:137] op_sel_hi:[1,0,1] neg_lo:[0,1,0] neg_hi:[0,1,0]
v_pk_fma_f32 v[138:139], v[202:203], v[42:43], v[138:139] op_sel_hi:[1,0,1] neg_lo:[0,1,0] neg_hi:[0,1,0]
v_pk_fma_f32 v[140:141], v[204:205], v[42:43], v[140:141] op_sel_hi:[1,0,1] neg_lo:[0,1,0] neg_hi:[0,1,0]
v_pk_fma_f32 v[142:143], v[206:207], v[42:43], v[142:143] op_sel_hi:[1,0,1] neg_lo:[0,1,0] neg_hi:[0,1,0]
v_pk_fma_f32 v[144:145], v[208:209], v[42:43], v[144:145] op_sel_hi:[1,0,1] neg_lo:[0,1,0] neg_hi:[0,1,0]
v_pk_fma_f32 v[146:147], v[210:211], v[42:43], v[146:147] op_sel_hi:[1,0,1] neg_lo:[0,1,0] neg_hi:[0,1,0]
v_pk_fma_f32 v[148:149], v[212:213], v[42:43], v[148:149] op_sel_hi:[1,0,1] neg_lo:[0,1,0] neg_hi:[0,1,0]
v_pk_fma_f32 v[150:151], v[214:215], v[42:43], v[150:151] op_sel_hi:[1,0,1] neg_lo:[0,1,0] neg_hi:[0,1,0]
v_pk_mul_f32 v[136:137], v[136:137], v[44:45] op_sel_hi:[1,0]
v_pk_mul_f32 v[138:139], v[138:139], v[44:45] op_sel_hi:[1,0]
v_pk_mul_f32 v[140:141], v[140:141], v[44:45] op_sel_hi:[1,0]
v_pk_mul_f32 v[142:143], v[142:143], v[44:45] op_sel_hi:[1,0]
v_pk_mul_f32 v[144:145], v[144:145], v[44:45] op_sel_hi:[1,0]
v_pk_mul_f32 v[146:147], v[146:147], v[44:45] op_sel_hi:[1,0]
v_pk_mul_f32 v[148:149], v[148:149], v[44:45] op_sel_hi:[1,0]
v_pk_mul_f32 v[150:151], v[150:151], v[44:45] op_sel_hi:[1,0]
v_cvt_pk_bf16_f32 v64, v136, v137
v_cvt_pk_bf16_f32 v65, v138, v139
v_cvt_pk_bf16_f32 v66, v140, v141
v_cvt_pk_bf16_f32 v67, v142, v143
v_cvt_pk_bf16_f32 v68, v144, v145
v_cvt_pk_bf16_f32 v69, v146, v147
v_cvt_pk_bf16_f32 v70, v148, v149
v_cvt_pk_bf16_f32 v71, v150, v151
v_permlane32_swap_b32 v64, v66
v_permlane32_swap_b32 v65, v67
v_permlane32_swap_b32 v68, v70
v_permlane32_swap_b32 v69, v71
s_lshl_b32 s59, s68, 11
s_add_u32 s59, s59, s60
buffer_store_dwordx4 v[64:67], v41, s[20:23], s59 offen sc1
buffer_store_dwordx4 v[68:71], v41, s[20:23], s59 offen offset:1024 sc1
s_branch L_g1_fin
L_g1_vtype:
s_waitcnt vmcnt(5)
s_barrier
ds_read_b128 v[48:51], v8 offset:0
ds_read_b64_tr_b16 v[56:57], v12 offset:0
ds_read_b64_tr_b16 v[58:59], v12 offset:1024
ds_read_b64_tr_b16 v[60:61], v13 offset:0
ds_read_b64_tr_b16 v[62:63], v13 offset:1024
ds_read_b64_tr_b16 v[64:65], v14 offset:0
ds_read_b64_tr_b16 v[66:67], v14 offset:1024
ds_read_b64_tr_b16 v[68:69], v15 offset:0
ds_read_b64_tr_b16 v[70:71], v15 offset:1024
s_waitcnt lgkmcnt(0)
v_mfma_f32_32x32x16_bf16 v[88:103], v[48:51], v[56:59], 0
ds_read_b128 v[52:55], v9 offset:0
ds_read_b64_tr_b16 v[72:73], v12 offset:4096
ds_read_b64_tr_b16 v[74:75], v12 offset:5120
ds_read_b64_tr_b16 v[76:77], v13 offset:4096
ds_read_b64_tr_b16 v[78:79], v13 offset:5120
v_lshlrev_b32 v24, 16, v48
v_mfma_f32_32x32x16_bf16 v[104:119], v[48:51], v[60:63], 0
ds_read_b64_tr_b16 v[80:81], v14 offset:4096
ds_read_b64_tr_b16 v[82:83], v14 offset:5120
ds_read_b64_tr_b16 v[84:85], v15 offset:4096
ds_read_b64_tr_b16 v[86:87], v15 offset:5120
s_add_u32 m0, s56, 32768
s_nop 0
buffer_load_dwordx4 v2, s[8:11], s53 offen lds
v_and_b32 v25, s63, v48
v_fmac_f32 v22, v24, v24
v_fmac_f32 v23, v25, v25
v_mfma_f32_32x32x16_bf16 v[120:135], v[48:51], v[64:67], 0
s_add_u32 m0, s57, 32768
s_nop 0
buffer_load_dwordx4 v4, s[12:15], s54 offen lds
v_lshlrev_b32 v26, 16, v49
v_and_b32 v27, s63, v49
v_mfma_f32_32x32x16_bf16 v[136:151], v[48:51], v[68:71], 0
v_fmac_f32 v22, v26, v26
v_fmac_f32 v23, v27, v27
v_mfma_f32_16x16x32_bf16 v[32:35], v[28:31], v[56:59], 0
s_waitcnt lgkmcnt(0)
v_mfma_f32_32x32x16_bf16 v[88:103], v[52:55], v[72:75], v[88:103]
ds_read_b128 v[48:51], v10 offset:0
ds_read_b64_tr_b16 v[56:57], v12 offset:8192
ds_read_b64_tr_b16 v[58:59], v12 offset:9216
ds_read_b64_tr_b16 v[60:61], v13 offset:8192
ds_read_b64_tr_b16 v[62:63], v13 offset:9216
v_lshlrev_b32 v24, 16, v52
v_mfma_f32_32x32x16_bf16 v[104:119], v[52:55], v[76:79], v[104:119]
ds_read_b64_tr_b16 v[64:65], v14 offset:8192
ds_read_b64_tr_b16 v[66:67], v14 offset:9216
ds_read_b64_tr_b16 v[68:69], v15 offset:8192
ds_read_b64_tr_b16 v[70:71], v15 offset:9216
s_add_u32 m0, s56, 33792
s_nop 0
buffer_load_dwordx4 v3, s[8:11], s53 offen lds
v_and_b32 v25, s63, v52
v_fmac_f32 v22, v24, v24
v_fmac_f32 v23, v25, v25
v_mfma_f32_32x32x16_bf16 v[120:135], v[52:55], v[80:83], v[120:135]
s_add_u32 m0, s57, 33792
s_nop 0
buffer_load_dwordx4 v5, s[12:15], s54 offen lds
v_lshlrev_b32 v26, 16, v53
v_and_b32 v27, s63, v53
v_mfma_f32_32x32x16_bf16 v[136:151], v[52:55], v[84:87], v[136:151]
v_fmac_f32 v22, v26, v26
v_fmac_f32 v23, v27, v27
v_mfma_f32_16x16x32_bf16 v[32:35], v[28:31], v[72:75], v[32:35]
s_waitcnt lgkmcnt(0)
v_mfma_f32_32x32x16_bf16 v[88:103], v[48:51], v[56:59], v[88:103]
ds_read_b128 v[52:55], v11 offset:0
ds_read_b64_tr_b16 v[72:73], v12 offset:12288
ds_read_b64_tr_b16 v[74:75], v12 offset:13312
ds_read_b64_tr_b16 v[76:77], v13 offset:12288
ds_read_b64_tr_b16 v[78:79], v13 offset:13312
v_lshlrev_b32 v24, 16, v48
v_mfma_f32_32x32x16_bf16 v[104:119], v[48:51], v[60:63], v[104:119]
ds_read_b64_tr_b16 v[80:81], v14 offset:12288
ds_read_b64_tr_b16 v[82:83], v14 offset:13312
ds_read_b64_tr_b16 v[84:85], v15 offset:12288
ds_read_b64_tr_b16 v[86:87], v15 offset:13312
s_add_u32 m0, s58, 24576
s_nop 0
buffer_load_dwordx4 v6, s[16:19], s55 offen lds
s_add_u32 s53, s53, 128
s_add_u32 s54, s54, 245760
s_add_u32 s55, s55, 196608
v_and_b32 v25, s63, v48
v_fmac_f32 v22, v24, v24
v_fmac_f32 v23, v25, v25
v_mfma_f32_32x32x16_bf16 v[120:135], v[48:51], v[64:67], v[120:135]
v_lshlrev_b32 v26, 16, v49
v_and_b32 v27, s63, v49
v_mfma_f32_32x32x16_bf16 v[136:151], v[48:51], v[68:71], v[136:151]
v_fmac_f32 v22, v26, v26
v_fmac_f32 v23, v27, v27
v_mfma_f32_16x16x32_bf16 v[32:35], v[28:31], v[56:59], v[32:35]
s_waitcnt lgkmcnt(0)
s_waitcnt vmcnt(5)
s_barrier
v_mfma_f32_32x32x16_bf16 v[88:103], v[52:55], v[72:75], v[88:103]
ds_read_b128 v[48:51], v8 offset:16384
ds_read_b64_tr_b16 v[56:57], v12 offset:16384
ds_read_b64_tr_b16 v[58:59], v12 offset:17408
ds_read_b64_tr_b16 v[60:61], v13 offset:16384
ds_read_b64_tr_b16 v[62:63], v13 offset:17408
v_lshlrev_b32 v24, 16, v52
v_mfma_f32_32x32x16_bf16 v[104:119], v[52:55], v[76:79], v[104:119]
ds_read_b64_tr_b16 v[64:65], v14 offset:16384
ds_read_b64_tr_b16 v[66:67], v14 offset:17408
ds_read_b64_tr_b16 v[68:69], v15 offset:16384
ds_read_b64_tr_b16 v[70:71], v15 offset:17408
s_add_u32 m0, s56, 0
s_nop 0
buffer_load_dwordx4 v2, s[8:11], s53 offen lds
v_and_b32 v25, s63, v52
v_fmac_f32 v22, v24, v24
v_fmac_f32 v23, v25, v25
v_mfma_f32_32x32x16_bf16 v[120:135], v[52:55], v[80:83], v[120:135]
s_add_u32 m0, s57, 0
s_nop 0
buffer_load_dwordx4 v4, s[12:15], s54 offen lds
v_lshlrev_b32 v26, 16, v53
v_and_b32 v27, s63, v53
v_mfma_f32_32x32x16_bf16 v[136:151], v[52:55], v[84:87], v[136:151]
v_fmac_f32 v22, v26, v26
v_fmac_f32 v23, v27, v27
v_mfma_f32_16x16x32_bf16 v[32:35], v[28:31], v[72:75], v[32:35]
s_waitcnt lgkmcnt(0)
v_mfma_f32_32x32x16_bf16 v[88:103], v[48:51], v[56:59], v[88:103]
ds_read_b128 v[52:55], v9 offset:16384
ds_read_b64_tr_b16 v[72:73], v12 offset:20480
ds_read_b64_tr_b16 v[74:75], v12 offset:21504
ds_read_b64_tr_b16 v[76:77], v13 offset:20480
ds_read_b64_tr_b16 v[78:79], v13 offset:21504
v_lshlrev_b32 v24, 16, v48
v_mfma_f32_32x32x16_bf16 v[104:119], v[48:51], v[60:63], v[104:119]
ds_read_b64_tr_b16 v[80:81], v14 offset:20480
ds_read_b64_tr_b16 v[82:83], v14 offset:21504
ds_read_b64_tr_b16 v[84:85], v15 offset:20480
ds_read_b64_tr_b16 v[86:87], v15 offset:21504
s_add_u32 m0, s56, 1024
s_nop 0
buffer_load_dwordx4 v3, s[8:11], s53 offen lds
v_and_b32 v25, s63, v48
v_fmac_f32 v22, v24, v24
v_fmac_f32 v23, v25, v25
v_mfma_f32_32x32x16_bf16 v[120:135], v[48:51], v[64:67], v[120:135]
v_lshlrev_b32 v26, 16, v49
v_and_b32 v27, s63, v49
v_mfma_f32_32x32x16_bf16 v[136:151], v[48:51], v[68:71], v[136:151]
v_fmac_f32 v22, v26, v26
v_fmac_f32 v23, v27, v27
v_mfma_f32_16x16x32_bf16 v[32:35], v[28:31], v[56:59], v[32:35]
s_waitcnt lgkmcnt(0)
v_mfma_f32_32x32x16_bf16 v[88:103], v[52:55], v[72:75], v[88:103]
ds_read_b128 v[48:51], v10 offset:16384
ds_read_b64_tr_b16 v[56:57], v12 offset:24576
ds_read_b64_tr_b16 v[58:59], v12 offset:25600
ds_read_b64_tr_b16 v[60:61], v13 offset:24576
ds_read_b64_tr_b16 v[62:63], v13 offset:25600
v_lshlrev_b32 v24, 16, v52
v_mfma_f32_32x32x16_bf16 v[104:119], v[52:55], v[76:79], v[104:119]
ds_read_b64_tr_b16 v[64:65], v14 offset:24576
ds_read_b64_tr_b16 v[66:67], v14 offset:25600
ds_read_b64_tr_b16 v[68:69], v15 offset:24576
ds_read_b64_tr_b16 v[70:71], v15 offset:25600
s_add_u32 m0, s57, 1024
s_nop 0
buffer_load_dwordx4 v5, s[12:15], s54 offen lds
v_and_b32 v25, s63, v52
v_fmac_f32 v22, v24, v24
v_fmac_f32 v23, v25, v25
v_mfma_f32_32x32x16_bf16 v[120:135], v[52:55], v[80:83], v[120:135]
v_lshlrev_b32 v26, 16, v53
v_and_b32 v27, s63, v53
v_mfma_f32_32x32x16_bf16 v[136:151], v[52:55], v[84:87], v[136:151]
v_fmac_f32 v22, v26, v26
v_fmac_f32 v23, v27, v27
v_mfma_f32_16x16x32_bf16 v[32:35], v[28:31], v[72:75], v[32:35]
s_waitcnt lgkmcnt(0)
v_mfma_f32_32x32x16_bf16 v[88:103], v[48:51], v[56:59], v[88:103]
ds_read_b128 v[52:55], v11 offset:16384
ds_read_b64_tr_b16 v[72:73], v12 offset:28672
ds_read_b64_tr_b16 v[74:75], v12 offset:29696
ds_read_b64_tr_b16 v[76:77], v13 offset:28672
ds_read_b64_tr_b16 v[78:79], v13 offset:29696
v_lshlrev_b32 v24, 16, v48
v_mfma_f32_32x32x16_bf16 v[104:119], v[48:51], v[60:63], v[104:119]
ds_read_b64_tr_b16 v[80:81], v14 offset:28672
ds_read_b64_tr_b16 v[82:83], v14 offset:29696
ds_read_b64_tr_b16 v[84:85], v15 offset:28672
ds_read_b64_tr_b16 v[86:87], v15 offset:29696
s_add_u32 m0, s58, 0
s_nop 0
buffer_load_dwordx4 v6, s[16:19], s55 offen lds
s_add_u32 s53, s53, 128
s_add_u32 s54, s54, 245760
s_add_u32 s55, s55, 196608
v_and_b32 v25, s63, v48
v_fmac_f32 v22, v24, v24
v_fmac_f32 v23, v25, v25
v_mfma_f32_32x32x16_bf16 v[120:135], v[48:51], v[64:67], v[120:135]
v_lshlrev_b32 v26, 16, v49
v_and_b32 v27, s63, v49
v_mfma_f32_32x32x16_bf16 v[136:151], v[48:51], v[68:71], v[136:151]
v_fmac_f32 v22, v26, v26
v_fmac_f32 v23, v27, v27
v_mfma_f32_16x16x32_bf16 v[32:35], v[28:31], v[56:59], v[32:35]
s_waitcnt lgkmcnt(0)
s_waitcnt vmcnt(5)
s_barrier
v_mfma_f32_32x32x16_bf16 v[88:103], v[52:55], v[72:75], v[88:103]
ds_read_b128 v[48:51], v8 offset:32768
ds_read_b64_tr_b16 v[56:57], v12 offset:32768
ds_read_b64_tr_b16 v[58:59], v12 offset:33792
ds_read_b64_tr_b16 v[60:61], v13 offset:32768
ds_read_b64_tr_b16 v[62:63], v13 offset:33792
v_lshlrev_b32 v24, 16, v52
v_mfma_f32_32x32x16_bf16 v[104:119], v[52:55], v[76:79], v[104:119]
ds_read_b64_tr_b16 v[64:65], v14 offset:32768
ds_read_b64_tr_b16 v[66:67], v14 offset:33792
ds_read_b64_tr_b16 v[68:69], v15 offset:32768
ds_read_b64_tr_b16 v[70:71], v15 offset:33792
s_add_u32 m0, s56, 16384
s_nop 0
buffer_load_dwordx4 v2, s[8:11], s53 offen lds
v_and_b32 v25, s63, v52
v_fmac_f32 v22, v24, v24
v_fmac_f32 v23, v25, v25
v_mfma_f32_32x32x16_bf16 v[120:135], v[52:55], v[80:83], v[120:135]
s_add_u32 m0, s57, 16384
s_nop 0
buffer_load_dwordx4 v4, s[12:15], s54 offen lds
v_lshlrev_b32 v26, 16, v53
v_and_b32 v27, s63, v53
v_mfma_f32_32x32x16_bf16 v[136:151], v[52:55], v[84:87], v[136:151]
v_fmac_f32 v22, v26, v26
v_fmac_f32 v23, v27, v27
v_mfma_f32_16x16x32_bf16 v[32:35], v[28:31], v[72:75], v[32:35]
s_waitcnt lgkmcnt(0)
v_mfma_f32_32x32x16_bf16 v[88:103], v[48:51], v[56:59], v[88:103]
ds_read_b128 v[52:55], v9 offset:32768
ds_read_b64_tr_b16 v[72:73], v12 offset:36864
ds_read_b64_tr_b16 v[74:75], v12 offset:37888
ds_read_b64_tr_b16 v[76:77], v13 offset:36864
ds_read_b64_tr_b16 v[78:79], v13 offset:37888
v_lshlrev_b32 v24, 16, v48
v_mfma_f32_32x32x16_bf16 v[104:119], v[48:51], v[60:63], v[104:119]
ds_read_b64_tr_b16 v[80:81], v14 offset:36864
ds_read_b64_tr_b16 v[82:83], v14 offset:37888
ds_read_b64_tr_b16 v[84:85], v15 offset:36864
ds_read_b64_tr_b16 v[86:87], v15 offset:37888
s_add_u32 m0, s56, 17408
s_nop 0
buffer_load_dwordx4 v3, s[8:11], s53 offen lds
v_and_b32 v25, s63, v48
v_fmac_f32 v22, v24, v24
v_fmac_f32 v23, v25, v25
v_mfma_f32_32x32x16_bf16 v[120:135], v[48:51], v[64:67], v[120:135]
v_lshlrev_b32 v26, 16, v49
v_and_b32 v27, s63, v49
v_mfma_f32_32x32x16_bf16 v[136:151], v[48:51], v[68:71], v[136:151]
v_fmac_f32 v22, v26, v26
v_fmac_f32 v23, v27, v27
v_mfma_f32_16x16x32_bf16 v[32:35], v[28:31], v[56:59], v[32:35]
s_waitcnt lgkmcnt(0)
v_mfma_f32_32x32x16_bf16 v[88:103], v[52:55], v[72:75], v[88:103]
ds_read_b128 v[48:51], v10 offset:32768
ds_read_b64_tr_b16 v[56:57], v12 offset:40960
ds_read_b64_tr_b16 v[58:59], v12 offset:41984
ds_read_b64_tr_b16 v[60:61], v13 offset:40960
ds_read_b64_tr_b16 v[62:63], v13 offset:41984
v_lshlrev_b32 v24, 16, v52
v_mfma_f32_32x32x16_bf16 v[104:119], v[52:55], v[76:79], v[104:119]
ds_read_b64_tr_b16 v[64:65], v14 offset:40960
ds_read_b64_tr_b16 v[66:67], v14 offset:41984
ds_read_b64_tr_b16 v[68:69], v15 offset:40960
ds_read_b64_tr_b16 v[70:71], v15 offset:41984
s_add_u32 m0, s57, 17408
s_nop 0
buffer_load_dwordx4 v5, s[12:15], s54 offen lds
v_and_b32 v25, s63, v52
v_fmac_f32 v22, v24, v24
v_fmac_f32 v23, v25, v25
v_mfma_f32_32x32x16_bf16 v[120:135], v[52:55], v[80:83], v[120:135]
v_lshlrev_b32 v26, 16, v53
v_and_b32 v27, s63, v53
v_mfma_f32_32x32x16_bf16 v[136:151], v[52:55], v[84:87], v[136:151]
v_fmac_f32 v22, v26, v26
v_fmac_f32 v23, v27, v27
v_mfma_f32_16x16x32_bf16 v[32:35], v[28:31], v[72:75], v[32:35]
s_waitcnt lgkmcnt(0)
v_mfma_f32_32x32x16_bf16 v[88:103], v[48:51], v[56:59], v[88:103]
ds_read_b128 v[52:55], v11 offset:32768
ds_read_b64_tr_b16 v[72:73], v12 offset:45056
ds_read_b64_tr_b16 v[74:75], v12 offset:46080
ds_read_b64_tr_b16 v[76:77], v13 offset:45056
ds_read_b64_tr_b16 v[78:79], v13 offset:46080
v_lshlrev_b32 v24, 16, v48
v_mfma_f32_32x32x16_bf16 v[104:119], v[48:51], v[60:63], v[104:119]
ds_read_b64_tr_b16 v[80:81], v14 offset:45056
ds_read_b64_tr_b16 v[82:83], v14 offset:46080
ds_read_b64_tr_b16 v[84:85], v15 offset:45056
ds_read_b64_tr_b16 v[86:87], v15 offset:46080
s_add_u32 m0, s58, 12288
s_nop 0
buffer_load_dwordx4 v6, s[16:19], s55 offen lds
s_add_u32 s53, s53, 128
s_add_u32 s54, s54, 245760
s_add_u32 s55, s55, 196608
v_and_b32 v25, s63, v48
v_fmac_f32 v22, v24, v24
v_fmac_f32 v23, v25, v25
v_mfma_f32_32x32x16_bf16 v[120:135], v[48:51], v[64:67], v[120:135]
v_lshlrev_b32 v26, 16, v49
v_and_b32 v27, s63, v49
v_mfma_f32_32x32x16_bf16 v[136:151], v[48:51], v[68:71], v[136:151]
v_fmac_f32 v22, v26, v26
v_fmac_f32 v23, v27, v27
v_mfma_f32_16x16x32_bf16 v[32:35], v[28:31], v[56:59], v[32:35]
s_waitcnt lgkmcnt(0)
s_waitcnt vmcnt(5)
s_barrier
v_mfma_f32_32x32x16_bf16 v[88:103], v[52:55], v[72:75], v[88:103]
ds_read_b128 v[48:51], v8 offset:0
ds_read_b64_tr_b16 v[56:57], v12 offset:0
ds_read_b64_tr_b16 v[58:59], v12 offset:1024
ds_read_b64_tr_b16 v[60:61], v13 offset:0
ds_read_b64_tr_b16 v[62:63], v13 offset:1024
v_lshlrev_b32 v24, 16, v52
v_mfma_f32_32x32x16_bf16 v[104:119], v[52:55], v[76:79], v[104:119]
ds_read_b64_tr_b16 v[64:65], v14 offset:0
ds_read_b64_tr_b16 v[66:67], v14 offset:1024
ds_read_b64_tr_b16 v[68:69], v15 offset:0
ds_read_b64_tr_b16 v[70:71], v15 offset:1024
s_add_u32 m0, s56, 32768
s_nop 0
buffer_load_dwordx4 v2, s[8:11], s53 offen lds
v_and_b32 v25, s63, v52
v_fmac_f32 v22, v24, v24
v_fmac_f32 v23, v25, v25
v_mfma_f32_32x32x16_bf16 v[120:135], v[52:55], v[80:83], v[120:135]
s_add_u32 m0, s57, 32768
s_nop 0
buffer_load_dwordx4 v4, s[12:15], s54 offen lds
v_lshlrev_b32 v26, 16, v53
v_and_b32 v27, s63, v53
v_mfma_f32_32x32x16_bf16 v[136:151], v[52:55], v[84:87], v[136:151]
v_fmac_f32 v22, v26, v26
v_fmac_f32 v23, v27, v27
v_mfma_f32_16x16x32_bf16 v[32:35], v[28:31], v[72:75], v[32:35]
s_waitcnt lgkmcnt(0)
v_mfma_f32_32x32x16_bf16 v[88:103], v[48:51], v[56:59], v[88:103]
ds_read_b128 v[52:55], v9 offset:0
ds_read_b64_tr_b16 v[72:73], v12 offset:4096
ds_read_b64_tr_b16 v[74:75], v12 offset:5120
ds_read_b64_tr_b16 v[76:77], v13 offset:4096
ds_read_b64_tr_b16 v[78:79], v13 offset:5120
v_lshlrev_b32 v24, 16, v48
v_mfma_f32_32x32x16_bf16 v[104:119], v[48:51], v[60:63], v[104:119]
ds_read_b64_tr_b16 v[80:81], v14 offset:4096
ds_read_b64_tr_b16 v[82:83], v14 offset:5120
ds_read_b64_tr_b16 v[84:85], v15 offset:4096
ds_read_b64_tr_b16 v[86:87], v15 offset:5120
s_add_u32 m0, s56, 33792
s_nop 0
buffer_load_dwordx4 v3, s[8:11], s53 offen lds
v_and_b32 v25, s63, v48
v_fmac_f32 v22, v24, v24
v_fmac_f32 v23, v25, v25
v_mfma_f32_32x32x16_bf16 v[120:135], v[48:51], v[64:67], v[120:135]
v_lshlrev_b32 v26, 16, v49
v_and_b32 v27, s63, v49
v_mfma_f32_32x32x16_bf16 v[136:151], v[48:51], v[68:71], v[136:151]
v_fmac_f32 v22, v26, v26
v_fmac_f32 v23, v27, v27
v_mfma_f32_16x16x32_bf16 v[32:35], v[28:31], v[56:59], v[32:35]
s_waitcnt lgkmcnt(0)
v_mfma_f32_32x32x16_bf16 v[88:103], v[52:55], v[72:75], v[88:103]
ds_read_b128 v[48:51], v10 offset:0
ds_read_b64_tr_b16 v[56:57], v12 offset:8192
ds_read_b64_tr_b16 v[58:59], v12 offset:9216
ds_read_b64_tr_b16 v[60:61], v13 offset:8192
ds_read_b64_tr_b16 v[62:63], v13 offset:9216
v_lshlrev_b32 v24, 16, v52
v_mfma_f32_32x32x16_bf16 v[104:119], v[52:55], v[76:79], v[104:119]
ds_read_b64_tr_b16 v[64:65], v14 offset:8192
ds_read_b64_tr_b16 v[66:67], v14 offset:9216
ds_read_b64_tr_b16 v[68:69], v15 offset:8192
ds_read_b64_tr_b16 v[70:71], v15 offset:9216
s_add_u32 m0, s57, 33792
s_nop 0
buffer_load_dwordx4 v5, s[12:15], s54 offen lds
v_and_b32 v25, s63, v52
v_fmac_f32 v22, v24, v24
v_fmac_f32 v23, v25, v25
v_mfma_f32_32x32x16_bf16 v[120:135], v[52:55], v[80:83], v[120:135]
v_lshlrev_b32 v26, 16, v53
v_and_b32 v27, s63, v53
v_mfma_f32_32x32x16_bf16 v[136:151], v[52:55], v[84:87], v[136:151]
v_fmac_f32 v22, v26, v26
v_fmac_f32 v23, v27, v27
v_mfma_f32_16x16x32_bf16 v[32:35], v[28:31], v[72:75], v[32:35]
s_waitcnt lgkmcnt(0)
v_mfma_f32_32x32x16_bf16 v[88:103], v[48:51], v[56:59], v[88:103]
ds_read_b128 v[52:55], v11 offset:0
ds_read_b64_tr_b16 v[72:73], v12 offset:12288
ds_read_b64_tr_b16 v[74:75], v12 offset:13312
ds_read_b64_tr_b16 v[76:77], v13 offset:12288
ds_read_b64_tr_b16 v[78:79], v13 offset:13312
v_lshlrev_b32 v24, 16, v48
v_mfma_f32_32x32x16_bf16 v[104:119], v[48:51], v[60:63], v[104:119]
ds_read_b64_tr_b16 v[80:81], v14 offset:12288
ds_read_b64_tr_b16 v[82:83], v14 offset:13312
ds_read_b64_tr_b16 v[84:85], v15 offset:12288
ds_read_b64_tr_b16 v[86:87], v15 offset:13312
s_add_u32 m0, s58, 24576
s_nop 0
buffer_load_dwordx4 v6, s[16:19], s55 offen lds
s_add_u32 s53, s53, 128
s_add_u32 s54, s54, 245760
s_add_u32 s55, s55, 196608
v_and_b32 v25, s63, v48
v_fmac_f32 v22, v24, v24
v_fmac_f32 v23, v25, v25
v_mfma_f32_32x32x16_bf16 v[120:135], v[48:51], v[64:67], v[120:135]
v_lshlrev_b32 v26, 16, v49
v_and_b32 v27, s63, v49
v_mfma_f32_32x32x16_bf16 v[136:151], v[48:51], v[68:71], v[136:151]
v_fmac_f32 v22, v26, v26
v_fmac_f32 v23, v27, v27
v_mfma_f32_16x16x32_bf16 v[32:35], v[28:31], v[56:59], v[32:35]
s_waitcnt lgkmcnt(0)
s_waitcnt vmcnt(5)
s_barrier
v_mfma_f32_32x32x16_bf16 v[88:103], v[52:55], v[72:75], v[88:103]
ds_read_b128 v[48:51], v8 offset:16384
ds_read_b64_tr_b16 v[56:57], v12 offset:16384
ds_read_b64_tr_b16 v[58:59], v12 offset:17408
ds_read_b64_tr_b16 v[60:61], v13 offset:16384
ds_read_b64_tr_b16 v[62:63], v13 offset:17408
v_lshlrev_b32 v24, 16, v52
v_mfma_f32_32x32x16_bf16 v[104:119], v[52:55], v[76:79], v[104:119]
ds_read_b64_tr_b16 v[64:65], v14 offset:16384
ds_read_b64_tr_b16 v[66:67], v14 offset:17408
ds_read_b64_tr_b16 v[68:69], v15 offset:16384
ds_read_b64_tr_b16 v[70:71], v15 offset:17408
s_add_u32 m0, s56, 0
s_nop 0
buffer_load_dwordx4 v2, s[8:11], s53 offen lds
v_and_b32 v25, s63, v52
v_fmac_f32 v22, v24, v24
v_fmac_f32 v23, v25, v25
v_mfma_f32_32x32x16_bf16 v[120:135], v[52:55], v[80:83], v[120:135]
s_add_u32 m0, s57, 0
s_nop 0
buffer_load_dwordx4 v4, s[12:15], s54 offen lds
v_lshlrev_b32 v26, 16, v53
v_and_b32 v27, s63, v53
v_mfma_f32_32x32x16_bf16 v[136:151], v[52:55], v[84:87], v[136:151]
v_fmac_f32 v22, v26, v26
v_fmac_f32 v23, v27, v27
v_mfma_f32_16x16x32_bf16 v[32:35], v[28:31], v[72:75], v[32:35]
s_waitcnt lgkmcnt(0)
v_mfma_f32_32x32x16_bf16 v[88:103], v[48:51], v[56:59], v[88:103]
ds_read_b128 v[52:55], v9 offset:16384
ds_read_b64_tr_b16 v[72:73], v12 offset:20480
ds_read_b64_tr_b16 v[74:75], v12 offset:21504
ds_read_b64_tr_b16 v[76:77], v13 offset:20480
ds_read_b64_tr_b16 v[78:79], v13 offset:21504
v_lshlrev_b32 v24, 16, v48
v_mfma_f32_32x32x16_bf16 v[104:119], v[48:51], v[60:63], v[104:119]
ds_read_b64_tr_b16 v[80:81], v14 offset:20480
ds_read_b64_tr_b16 v[82:83], v14 offset:21504
ds_read_b64_tr_b16 v[84:85], v15 offset:20480
ds_read_b64_tr_b16 v[86:87], v15 offset:21504
s_add_u32 m0, s56, 1024
s_nop 0
buffer_load_dwordx4 v3, s[8:11], s53 offen lds
v_and_b32 v25, s63, v48
v_fmac_f32 v22, v24, v24
v_fmac_f32 v23, v25, v25
v_mfma_f32_32x32x16_bf16 v[120:135], v[48:51], v[64:67], v[120:135]
v_lshlrev_b32 v26, 16, v49
v_and_b32 v27, s63, v49
v_mfma_f32_32x32x16_bf16 v[136:151], v[48:51], v[68:71], v[136:151]
v_fmac_f32 v22, v26, v26
v_fmac_f32 v23, v27, v27
v_mfma_f32_16x16x32_bf16 v[32:35], v[28:31], v[56:59], v[32:35]
s_waitcnt lgkmcnt(0)
v_mfma_f32_32x32x16_bf16 v[88:103], v[52:55], v[72:75], v[88:103]
ds_read_b128 v[48:51], v10 offset:16384
ds_read_b64_tr_b16 v[56:57], v12 offset:24576
ds_read_b64_tr_b16 v[58:59], v12 offset:25600
ds_read_b64_tr_b16 v[60:61], v13 offset:24576
ds_read_b64_tr_b16 v[62:63], v13 offset:25600
v_lshlrev_b32 v24, 16, v52
v_mfma_f32_32x32x16_bf16 v[104:119], v[52:55], v[76:79], v[104:119]
ds_read_b64_tr_b16 v[64:65], v14 offset:24576
ds_read_b64_tr_b16 v[66:67], v14 offset:25600
ds_read_b64_tr_b16 v[68:69], v15 offset:24576
ds_read_b64_tr_b16 v[70:71], v15 offset:25600
s_add_u32 m0, s57, 1024
s_nop 0
buffer_load_dwordx4 v5, s[12:15], s54 offen lds
v_and_b32 v25, s63, v52
v_fmac_f32 v22, v24, v24
v_fmac_f32 v23, v25, v25
v_mfma_f32_32x32x16_bf16 v[120:135], v[52:55], v[80:83], v[120:135]
v_lshlrev_b32 v26, 16, v53
v_and_b32 v27, s63, v53
v_mfma_f32_32x32x16_bf16 v[136:151], v[52:55], v[84:87], v[136:151]
v_fmac_f32 v22, v26, v26
v_fmac_f32 v23, v27, v27
v_mfma_f32_16x16x32_bf16 v[32:35], v[28:31], v[72:75], v[32:35]
s_waitcnt lgkmcnt(0)
v_mfma_f32_32x32x16_bf16 v[88:103], v[48:51], v[56:59], v[88:103]
ds_read_b128 v[52:55], v11 offset:16384
ds_read_b64_tr_b16 v[72:73], v12 offset:28672
ds_read_b64_tr_b16 v[74:75], v12 offset:29696
ds_read_b64_tr_b16 v[76:77], v13 offset:28672
ds_read_b64_tr_b16 v[78:79], v13 offset:29696
v_lshlrev_b32 v24, 16, v48
v_mfma_f32_32x32x16_bf16 v[104:119], v[48:51], v[60:63], v[104:119]
ds_read_b64_tr_b16 v[80:81], v14 offset:28672
ds_read_b64_tr_b16 v[82:83], v14 offset:29696
ds_read_b64_tr_b16 v[84:85], v15 offset:28672
ds_read_b64_tr_b16 v[86:87], v15 offset:29696
s_add_u32 m0, s58, 0
s_nop 0
buffer_load_dwordx4 v6, s[16:19], s55 offen lds
s_add_u32 s53, s53, 128
s_add_u32 s54, s54, 245760
s_add_u32 s55, s55, 196608
v_and_b32 v25, s63, v48
v_fmac_f32 v22, v24, v24
v_fmac_f32 v23, v25, v25
v_mfma_f32_32x32x16_bf16 v[120:135], v[48:51], v[64:67], v[120:135]
v_lshlrev_b32 v26, 16, v49
v_and_b32 v27, s63, v49
v_mfma_f32_32x32x16_bf16 v[136:151], v[48:51], v[68:71], v[136:151]
v_fmac_f32 v22, v26, v26
v_fmac_f32 v23, v27, v27
v_mfma_f32_16x16x32_bf16 v[32:35], v[28:31], v[56:59], v[32:35]
s_waitcnt lgkmcnt(0)
s_waitcnt vmcnt(5)
s_barrier
v_mfma_f32_32x32x16_bf16 v[88:103], v[52:55], v[72:75], v[88:103]
ds_read_b128 v[48:51], v8 offset:32768
ds_read_b64_tr_b16 v[56:57], v12 offset:32768
ds_read_b64_tr_b16 v[58:59], v12 offset:33792
ds_read_b64_tr_b16 v[60:61], v13 offset:32768
ds_read_b64_tr_b16 v[62:63], v13 offset:33792
v_lshlrev_b32 v24, 16, v52
v_mfma_f32_32x32x16_bf16 v[104:119], v[52:55], v[76:79], v[104:119]
ds_read_b64_tr_b16 v[64:65], v14 offset:32768
ds_read_b64_tr_b16 v[66:67], v14 offset:33792
ds_read_b64_tr_b16 v[68:69], v15 offset:32768
ds_read_b64_tr_b16 v[70:71], v15 offset:33792
s_add_u32 m0, s56, 16384
s_nop 0
buffer_load_dwordx4 v2, s[8:11], s53 offen lds
v_and_b32 v25, s63, v52
v_fmac_f32 v22, v24, v24
v_fmac_f32 v23, v25, v25
v_mfma_f32_32x32x16_bf16 v[120:135], v[52:55], v[80:83], v[120:135]
s_add_u32 m0, s57, 16384
s_nop 0
buffer_load_dwordx4 v4, s[12:15], s54 offen lds
v_lshlrev_b32 v26, 16, v53
v_and_b32 v27, s63, v53
v_mfma_f32_32x32x16_bf16 v[136:151], v[52:55], v[84:87], v[136:151]
v_fmac_f32 v22, v26, v26
v_fmac_f32 v23, v27, v27
v_mfma_f32_16x16x32_bf16 v[32:35], v[28:31], v[72:75], v[32:35]
s_waitcnt lgkmcnt(0)
v_mfma_f32_32x32x16_bf16 v[88:103], v[48:51], v[56:59], v[88:103]
ds_read_b128 v[52:55], v9 offset:32768
ds_read_b64_tr_b16 v[72:73], v12 offset:36864
ds_read_b64_tr_b16 v[74:75], v12 offset:37888
ds_read_b64_tr_b16 v[76:77], v13 offset:36864
ds_read_b64_tr_b16 v[78:79], v13 offset:37888
v_lshlrev_b32 v24, 16, v48
v_mfma_f32_32x32x16_bf16 v[104:119], v[48:51], v[60:63], v[104:119]
ds_read_b64_tr_b16 v[80:81], v14 offset:36864
ds_read_b64_tr_b16 v[82:83], v14 offset:37888
ds_read_b64_tr_b16 v[84:85], v15 offset:36864
ds_read_b64_tr_b16 v[86:87], v15 offset:37888
s_add_u32 m0, s56, 17408
s_nop 0
buffer_load_dwordx4 v3, s[8:11], s53 offen lds
v_and_b32 v25, s63, v48
v_fmac_f32 v22, v24, v24
v_fmac_f32 v23, v25, v25
v_mfma_f32_32x32x16_bf16 v[120:135], v[48:51], v[64:67], v[120:135]
v_lshlrev_b32 v26, 16, v49
v_and_b32 v27, s63, v49
v_mfma_f32_32x32x16_bf16 v[136:151], v[48:51], v[68:71], v[136:151]
v_fmac_f32 v22, v26, v26
v_fmac_f32 v23, v27, v27
v_mfma_f32_16x16x32_bf16 v[32:35], v[28:31], v[56:59], v[32:35]
s_waitcnt lgkmcnt(0)
v_mfma_f32_32x32x16_bf16 v[88:103], v[52:55], v[72:75], v[88:103]
ds_read_b128 v[48:51], v10 offset:32768
ds_read_b64_tr_b16 v[56:57], v12 offset:40960
ds_read_b64_tr_b16 v[58:59], v12 offset:41984
ds_read_b64_tr_b16 v[60:61], v13 offset:40960
ds_read_b64_tr_b16 v[62:63], v13 offset:41984
v_lshlrev_b32 v24, 16, v52
v_mfma_f32_32x32x16_bf16 v[104:119], v[52:55], v[76:79], v[104:119]
ds_read_b64_tr_b16 v[64:65], v14 offset:40960
ds_read_b64_tr_b16 v[66:67], v14 offset:41984
ds_read_b64_tr_b16 v[68:69], v15 offset:40960
ds_read_b64_tr_b16 v[70:71], v15 offset:41984
s_add_u32 m0, s57, 17408
s_nop 0
buffer_load_dwordx4 v5, s[12:15], s54 offen lds
v_and_b32 v25, s63, v52
v_fmac_f32 v22, v24, v24
v_fmac_f32 v23, v25, v25
v_mfma_f32_32x32x16_bf16 v[120:135], v[52:55], v[80:83], v[120:135]
v_lshlrev_b32 v26, 16, v53
v_and_b32 v27, s63, v53
v_mfma_f32_32x32x16_bf16 v[136:151], v[52:55], v[84:87], v[136:151]
v_fmac_f32 v22, v26, v26
v_fmac_f32 v23, v27, v27
v_mfma_f32_16x16x32_bf16 v[32:35], v[28:31], v[72:75], v[32:35]
s_waitcnt lgkmcnt(0)
v_mfma_f32_32x32x16_bf16 v[88:103], v[48:51], v[56:59], v[88:103]
ds_read_b128 v[52:55], v11 offset:32768
ds_read_b64_tr_b16 v[72:73], v12 offset:45056
ds_read_b64_tr_b16 v[74:75], v12 offset:46080
ds_read_b64_tr_b16 v[76:77], v13 offset:45056
ds_read_b64_tr_b16 v[78:79], v13 offset:46080
v_lshlrev_b32 v24, 16, v48
v_mfma_f32_32x32x16_bf16 v[104:119], v[48:51], v[60:63], v[104:119]
ds_read_b64_tr_b16 v[80:81], v14 offset:45056
ds_read_b64_tr_b16 v[82:83], v14 offset:46080
ds_read_b64_tr_b16 v[84:85], v15 offset:45056
ds_read_b64_tr_b16 v[86:87], v15 offset:46080
s_add_u32 m0, s58, 12288
s_nop 0
buffer_load_dwordx4 v6, s[16:19], s55 offen lds
s_add_u32 s53, s53, 128
s_add_u32 s54, s54, 245760
s_add_u32 s55, s55, 196608
v_and_b32 v25, s63, v48
v_fmac_f32 v22, v24, v24
v_fmac_f32 v23, v25, v25
v_mfma_f32_32x32x16_bf16 v[120:135], v[48:51], v[64:67], v[120:135]
v_lshlrev_b32 v26, 16, v49
v_and_b32 v27, s63, v49
v_mfma_f32_32x32x16_bf16 v[136:151], v[48:51], v[68:71], v[136:151]
v_fmac_f32 v22, v26, v26
v_fmac_f32 v23, v27, v27
v_mfma_f32_16x16x32_bf16 v[32:35], v[28:31], v[56:59], v[32:35]
s_waitcnt lgkmcnt(0)
s_waitcnt vmcnt(5)
s_barrier
v_mfma_f32_32x32x16_bf16 v[88:103], v[52:55], v[72:75], v[88:103]
ds_read_b128 v[48:51], v8 offset:0
ds_read_b64_tr_b16 v[56:57], v12 offset:0
ds_read_b64_tr_b16 v[58:59], v12 offset:1024
ds_read_b64_tr_b16 v[60:61], v13 offset:0
ds_read_b64_tr_b16 v[62:63], v13 offset:1024
v_lshlrev_b32 v24, 16, v52
v_mfma_f32_32x32x16_bf16 v[104:119], v[52:55], v[76:79], v[104:119]
ds_read_b64_tr_b16 v[64:65], v14 offset:0
ds_read_b64_tr_b16 v[66:67], v14 offset:1024
ds_read_b64_tr_b16 v[68:69], v15 offset:0
ds_read_b64_tr_b16 v[70:71], v15 offset:1024
s_add_u32 m0, s56, 32768
s_nop 0
buffer_load_dwordx4 v2, s[8:11], s53 offen lds
v_and_b32 v25, s63, v52
v_fmac_f32 v22, v24, v24
v_fmac_f32 v23, v25, v25
v_mfma_f32_32x32x16_bf16 v[120:135], v[52:55], v[80:83], v[120:135]
s_add_u32 m0, s57, 32768
s_nop 0
buffer_load_dwordx4 v4, s[12:15], s54 offen lds
v_lshlrev_b32 v26, 16, v53
v_and_b32 v27, s63, v53
v_mfma_f32_32x32x16_bf16 v[136:151], v[52:55], v[84:87], v[136:151]
v_fmac_f32 v22, v26, v26
v_fmac_f32 v23, v27, v27
v_mfma_f32_16x16x32_bf16 v[32:35], v[28:31], v[72:75], v[32:35]
s_waitcnt lgkmcnt(0)
v_mfma_f32_32x32x16_bf16 v[88:103], v[48:51], v[56:59], v[88:103]
ds_read_b128 v[52:55], v9 offset:0
ds_read_b64_tr_b16 v[72:73], v12 offset:4096
ds_read_b64_tr_b16 v[74:75], v12 offset:5120
ds_read_b64_tr_b16 v[76:77], v13 offset:4096
ds_read_b64_tr_b16 v[78:79], v13 offset:5120
v_lshlrev_b32 v24, 16, v48
v_mfma_f32_32x32x16_bf16 v[104:119], v[48:51], v[60:63], v[104:119]
ds_read_b64_tr_b16 v[80:81], v14 offset:4096
ds_read_b64_tr_b16 v[82:83], v14 offset:5120
ds_read_b64_tr_b16 v[84:85], v15 offset:4096
ds_read_b64_tr_b16 v[86:87], v15 offset:5120
s_add_u32 m0, s56, 33792
s_nop 0
buffer_load_dwordx4 v3, s[8:11], s53 offen lds
v_and_b32 v25, s63, v48
v_fmac_f32 v22, v24, v24
v_fmac_f32 v23, v25, v25
v_mfma_f32_32x32x16_bf16 v[120:135], v[48:51], v[64:67], v[120:135]
v_lshlrev_b32 v26, 16, v49
v_and_b32 v27, s63, v49
v_mfma_f32_32x32x16_bf16 v[136:151], v[48:51], v[68:71], v[136:151]
v_fmac_f32 v22, v26, v26
v_fmac_f32 v23, v27, v27
v_mfma_f32_16x16x32_bf16 v[32:35], v[28:31], v[56:59], v[32:35]
s_waitcnt lgkmcnt(0)
v_mfma_f32_32x32x16_bf16 v[88:103], v[52:55], v[72:75], v[88:103]
ds_read_b128 v[48:51], v10 offset:0
ds_read_b64_tr_b16 v[56:57], v12 offset:8192
ds_read_b64_tr_b16 v[58:59], v12 offset:9216
ds_read_b64_tr_b16 v[60:61], v13 offset:8192
ds_read_b64_tr_b16 v[62:63], v13 offset:9216
v_lshlrev_b32 v24, 16, v52
v_mfma_f32_32x32x16_bf16 v[104:119], v[52:55], v[76:79], v[104:119]
ds_read_b64_tr_b16 v[64:65], v14 offset:8192
ds_read_b64_tr_b16 v[66:67], v14 offset:9216
ds_read_b64_tr_b16 v[68:69], v15 offset:8192
ds_read_b64_tr_b16 v[70:71], v15 offset:9216
s_add_u32 m0, s57, 33792
s_nop 0
buffer_load_dwordx4 v5, s[12:15], s54 offen lds
v_and_b32 v25, s63, v52
v_fmac_f32 v22, v24, v24
v_fmac_f32 v23, v25, v25
v_mfma_f32_32x32x16_bf16 v[120:135], v[52:55], v[80:83], v[120:135]
v_lshlrev_b32 v26, 16, v53
v_and_b32 v27, s63, v53
v_mfma_f32_32x32x16_bf16 v[136:151], v[52:55], v[84:87], v[136:151]
v_fmac_f32 v22, v26, v26
v_fmac_f32 v23, v27, v27
v_mfma_f32_16x16x32_bf16 v[32:35], v[28:31], v[72:75], v[32:35]
s_waitcnt lgkmcnt(0)
v_mfma_f32_32x32x16_bf16 v[88:103], v[48:51], v[56:59], v[88:103]
ds_read_b128 v[52:55], v11 offset:0
ds_read_b64_tr_b16 v[72:73], v12 offset:12288
ds_read_b64_tr_b16 v[74:75], v12 offset:13312
ds_read_b64_tr_b16 v[76:77], v13 offset:12288
ds_read_b64_tr_b16 v[78:79], v13 offset:13312
v_lshlrev_b32 v24, 16, v48
v_mfma_f32_32x32x16_bf16 v[104:119], v[48:51], v[60:63], v[104:119]
ds_read_b64_tr_b16 v[80:81], v14 offset:12288
ds_read_b64_tr_b16 v[82:83], v14 offset:13312
ds_read_b64_tr_b16 v[84:85], v15 offset:12288
ds_read_b64_tr_b16 v[86:87], v15 offset:13312
s_add_u32 m0, s58, 24576
s_nop 0
buffer_load_dwordx4 v6, s[16:19], s55 offen lds
s_add_u32 s53, s53, 128
s_add_u32 s54, s54, 245760
s_add_u32 s55, s55, 196608
v_and_b32 v25, s63, v48
v_fmac_f32 v22, v24, v24
v_fmac_f32 v23, v25, v25
v_mfma_f32_32x32x16_bf16 v[120:135], v[48:51], v[64:67], v[120:135]
v_lshlrev_b32 v26, 16, v49
v_and_b32 v27, s63, v49
v_mfma_f32_32x32x16_bf16 v[136:151], v[48:51], v[68:71], v[136:151]
v_fmac_f32 v22, v26, v26
v_fmac_f32 v23, v27, v27
v_mfma_f32_16x16x32_bf16 v[32:35], v[28:31], v[56:59], v[32:35]
s_waitcnt lgkmcnt(0)
s_waitcnt vmcnt(5)
s_barrier
v_mfma_f32_32x32x16_bf16 v[88:103], v[52:55], v[72:75], v[88:103]
ds_read_b128 v[48:51], v8 offset:16384
ds_read_b64_tr_b16 v[56:57], v12 offset:16384
ds_read_b64_tr_b16 v[58:59], v12 offset:17408
ds_read_b64_tr_b16 v[60:61], v13 offset:16384
ds_read_b64_tr_b16 v[62:63], v13 offset:17408
v_lshlrev_b32 v24, 16, v52
v_mfma_f32_32x32x16_bf16 v[104:119], v[52:55], v[76:79], v[104:119]
ds_read_b64_tr_b16 v[64:65], v14 offset:16384
ds_read_b64_tr_b16 v[66:67], v14 offset:17408
ds_read_b64_tr_b16 v[68:69], v15 offset:16384
ds_read_b64_tr_b16 v[70:71], v15 offset:17408
s_add_u32 m0, s56, 0
s_nop 0
buffer_load_dwordx4 v2, s[8:11], s53 offen lds
v_and_b32 v25, s63, v52
v_fmac_f32 v22, v24, v24
v_fmac_f32 v23, v25, v25
v_mfma_f32_32x32x16_bf16 v[120:135], v[52:55], v[80:83], v[120:135]
s_add_u32 m0, s57, 0
s_nop 0
buffer_load_dwordx4 v4, s[12:15], s54 offen lds
v_lshlrev_b32 v26, 16, v53
v_and_b32 v27, s63, v53
v_mfma_f32_32x32x16_bf16 v[136:151], v[52:55], v[84:87], v[136:151]
v_fmac_f32 v22, v26, v26
v_fmac_f32 v23, v27, v27
v_mfma_f32_16x16x32_bf16 v[32:35], v[28:31], v[72:75], v[32:35]
s_waitcnt lgkmcnt(0)
v_mfma_f32_32x32x16_bf16 v[88:103], v[48:51], v[56:59], v[88:103]
ds_read_b128 v[52:55], v9 offset:16384
ds_read_b64_tr_b16 v[72:73], v12 offset:20480
ds_read_b64_tr_b16 v[74:75], v12 offset:21504
ds_read_b64_tr_b16 v[76:77], v13 offset:20480
ds_read_b64_tr_b16 v[78:79], v13 offset:21504
v_lshlrev_b32 v24, 16, v48
v_mfma_f32_32x32x16_bf16 v[104:119], v[48:51], v[60:63], v[104:119]
ds_read_b64_tr_b16 v[80:81], v14 offset:20480
ds_read_b64_tr_b16 v[82:83], v14 offset:21504
ds_read_b64_tr_b16 v[84:85], v15 offset:20480
ds_read_b64_tr_b16 v[86:87], v15 offset:21504
s_add_u32 m0, s56, 1024
s_nop 0
buffer_load_dwordx4 v3, s[8:11], s53 offen lds
v_and_b32 v25, s63, v48
v_fmac_f32 v22, v24, v24
v_fmac_f32 v23, v25, v25
v_mfma_f32_32x32x16_bf16 v[120:135], v[48:51], v[64:67], v[120:135]
s_add_u32 m0, s57, 1024
s_nop 0
buffer_load_dwordx4 v5, s[12:15], s54 offen lds
v_lshlrev_b32 v26, 16, v49
v_and_b32 v27, s63, v49
v_mfma_f32_32x32x16_bf16 v[136:151], v[48:51], v[68:71], v[136:151]
v_fmac_f32 v22, v26, v26
v_fmac_f32 v23, v27, v27
v_mfma_f32_16x16x32_bf16 v[32:35], v[28:31], v[56:59], v[32:35]
s_waitcnt lgkmcnt(0)
v_mfma_f32_32x32x16_bf16 v[88:103], v[52:55], v[72:75], v[88:103]
ds_read_b128 v[48:51], v10 offset:16384
ds_read_b64_tr_b16 v[56:57], v12 offset:24576
ds_read_b64_tr_b16 v[58:59], v12 offset:25600
ds_read_b64_tr_b16 v[60:61], v13 offset:24576
ds_read_b64_tr_b16 v[62:63], v13 offset:25600
v_lshlrev_b32 v24, 16, v52
v_mfma_f32_32x32x16_bf16 v[104:119], v[52:55], v[76:79], v[104:119]
ds_read_b64_tr_b16 v[64:65], v14 offset:24576
ds_read_b64_tr_b16 v[66:67], v14 offset:25600
ds_read_b64_tr_b16 v[68:69], v15 offset:24576
ds_read_b64_tr_b16 v[70:71], v15 offset:25600
s_add_u32 m0, s58, 0
s_nop 0
buffer_load_dwordx4 v6, s[16:19], s55 offen lds
s_add_u32 s53, s53, 128
s_add_u32 s54, s54, 245760
s_add_u32 s55, s55, 196608
v_and_b32 v25, s63, v52
v_fmac_f32 v22, v24, v24
v_fmac_f32 v23, v25, v25
v_mfma_f32_32x32x16_bf16 v[120:135], v[52:55], v[80:83], v[120:135]
s_add_u32 m0, s70, 0
s_nop 0
buffer_load_dwordx4 v16, s[24:27], s69 offen lds
v_lshlrev_b32 v26, 16, v53
v_and_b32 v27, s63, v53
v_mfma_f32_32x32x16_bf16 v[136:151], v[52:55], v[84:87], v[136:151]
v_fmac_f32 v22, v26, v26
v_fmac_f32 v23, v27, v27
v_mfma_f32_16x16x32_bf16 v[32:35], v[28:31], v[72:75], v[32:35]
s_waitcnt lgkmcnt(0)
v_mfma_f32_32x32x16_bf16 v[88:103], v[48:51], v[56:59], v[88:103]
ds_read_b128 v[52:55], v11 offset:16384
ds_read_b64_tr_b16 v[72:73], v12 offset:28672
ds_read_b64_tr_b16 v[74:75], v12 offset:29696
ds_read_b64_tr_b16 v[76:77], v13 offset:28672
ds_read_b64_tr_b16 v[78:79], v13 offset:29696
v_lshlrev_b32 v24, 16, v48
v_mfma_f32_32x32x16_bf16 v[104:119], v[48:51], v[60:63], v[104:119]
ds_read_b64_tr_b16 v[80:81], v14 offset:28672
ds_read_b64_tr_b16 v[82:83], v14 offset:29696
ds_read_b64_tr_b16 v[84:85], v15 offset:28672
ds_read_b64_tr_b16 v[86:87], v15 offset:29696
s_add_u32 m0, s70, 4096
s_nop 0
buffer_load_dwordx4 v17, s[24:27], s69 offen lds
v_and_b32 v25, s63, v48
v_fmac_f32 v22, v24, v24
v_fmac_f32 v23, v25, v25
v_mfma_f32_32x32x16_bf16 v[120:135], v[48:51], v[64:67], v[120:135]
s_add_u32 m0, s70, 8192
s_nop 0
buffer_load_dwordx4 v18, s[24:27], s69 offen lds
v_lshlrev_b32 v26, 16, v49
v_and_b32 v27, s63, v49
v_mfma_f32_32x32x16_bf16 v[136:151], v[48:51], v[68:71], v[136:151]
v_fmac_f32 v22, v26, v26
v_fmac_f32 v23, v27, v27
v_mfma_f32_16x16x32_bf16 v[32:35], v[28:31], v[56:59], v[32:35]
s_waitcnt lgkmcnt(0)
s_waitcnt vmcnt(8)
s_barrier
v_mfma_f32_32x32x16_bf16 v[88:103], v[52:55], v[72:75], v[88:103]
ds_read_b128 v[48:51], v8 offset:32768
ds_read_b64_tr_b16 v[56:57], v12 offset:32768
ds_read_b64_tr_b16 v[58:59], v12 offset:33792
ds_read_b64_tr_b16 v[60:61], v13 offset:32768
ds_read_b64_tr_b16 v[62:63], v13 offset:33792
v_lshlrev_b32 v24, 16, v52
v_mfma_f32_32x32x16_bf16 v[104:119], v[52:55], v[76:79], v[104:119]
ds_read_b64_tr_b16 v[64:65], v14 offset:32768
ds_read_b64_tr_b16 v[66:67], v14 offset:33792
ds_read_b64_tr_b16 v[68:69], v15 offset:32768
ds_read_b64_tr_b16 v[70:71], v15 offset:33792
v_and_b32 v25, s63, v52
v_fmac_f32 v22, v24, v24
v_fmac_f32 v23, v25, v25
v_mfma_f32_32x32x16_bf16 v[120:135], v[52:55], v[80:83], v[120:135]
v_lshlrev_b32 v26, 16, v53
v_and_b32 v27, s63, v53
v_mfma_f32_32x32x16_bf16 v[136:151], v[52:55], v[84:87], v[136:151]
v_fmac_f32 v22, v26, v26
v_fmac_f32 v23, v27, v27
v_mfma_f32_16x16x32_bf16 v[32:35], v[28:31], v[72:75], v[32:35]
s_waitcnt lgkmcnt(0)
v_mfma_f32_32x32x16_bf16 v[88:103], v[48:51], v[56:59], v[88:103]
ds_read_b128 v[52:55], v9 offset:32768
ds_read_b64_tr_b16 v[72:73], v12 offset:36864
ds_read_b64_tr_b16 v[74:75], v12 offset:37888
ds_read_b64_tr_b16 v[76:77], v13 offset:36864
ds_read_b64_tr_b16 v[78:79], v13 offset:37888
v_lshlrev_b32 v24, 16, v48
v_mfma_f32_32x32x16_bf16 v[104:119], v[48:51], v[60:63], v[104:119]
ds_read_b64_tr_b16 v[80:81], v14 offset:36864
ds_read_b64_tr_b16 v[82:83], v14 offset:37888
ds_read_b64_tr_b16 v[84:85], v15 offset:36864
ds_read_b64_tr_b16 v[86:87], v15 offset:37888
v_and_b32 v25, s63, v48
v_fmac_f32 v22, v24, v24
v_fmac_f32 v23, v25, v25
v_mfma_f32_32x32x16_bf16 v[120:135], v[48:51], v[64:67], v[120:135]
v_lshlrev_b32 v26, 16, v49
v_and_b32 v27, s63, v49
v_mfma_f32_32x32x16_bf16 v[136:151], v[48:51], v[68:71], v[136:151]
v_fmac_f32 v22, v26, v26
v_fmac_f32 v23, v27, v27
v_mfma_f32_16x16x32_bf16 v[32:35], v[28:31], v[56:59], v[32:35]
s_waitcnt lgkmcnt(0)
v_mfma_f32_32x32x16_bf16 v[88:103], v[52:55], v[72:75], v[88:103]
ds_read_b128 v[48:51], v10 offset:32768
ds_read_b64_tr_b16 v[56:57], v12 offset:40960
ds_read_b64_tr_b16 v[58:59], v12 offset:41984
ds_read_b64_tr_b16 v[60:61], v13 offset:40960
ds_read_b64_tr_b16 v[62:63], v13 offset:41984
v_lshlrev_b32 v24, 16, v52
v_mfma_f32_32x32x16_bf16 v[104:119], v[52:55], v[76:79], v[104:119]
ds_read_b64_tr_b16 v[64:65], v14 offset:40960
ds_read_b64_tr_b16 v[66:67], v14 offset:41984
ds_read_b64_tr_b16 v[68:69], v15 offset:40960
ds_read_b64_tr_b16 v[70:71], v15 offset:41984
v_and_b32 v25, s63, v52
v_fmac_f32 v22, v24, v24
v_fmac_f32 v23, v25, v25
v_mfma_f32_32x32x16_bf16 v[120:135], v[52:55], v[80:83], v[120:135]
v_lshlrev_b32 v26, 16, v53
v_and_b32 v27, s63, v53
v_mfma_f32_32x32x16_bf16 v[136:151], v[52:55], v[84:87], v[136:151]
v_fmac_f32 v22, v26, v26
v_fmac_f32 v23, v27, v27
v_mfma_f32_16x16x32_bf16 v[32:35], v[28:31], v[72:75], v[32:35]
s_waitcnt lgkmcnt(0)
v_mfma_f32_32x32x16_bf16 v[88:103], v[48:51], v[56:59], v[88:103]
ds_read_b128 v[52:55], v11 offset:32768
ds_read_b64_tr_b16 v[72:73], v12 offset:45056
ds_read_b64_tr_b16 v[74:75], v12 offset:46080
ds_read_b64_tr_b16 v[76:77], v13 offset:45056
ds_read_b64_tr_b16 v[78:79], v13 offset:46080
v_lshlrev_b32 v24, 16, v48
v_mfma_f32_32x32x16_bf16 v[104:119], v[48:51], v[60:63], v[104:119]
ds_read_b64_tr_b16 v[80:81], v14 offset:45056
ds_read_b64_tr_b16 v[82:83], v14 offset:46080
ds_read_b64_tr_b16 v[84:85], v15 offset:45056
ds_read_b64_tr_b16 v[86:87], v15 offset:46080
v_and_b32 v25, s63, v48
v_fmac_f32 v22, v24, v24
v_fmac_f32 v23, v25, v25
v_mfma_f32_32x32x16_bf16 v[120:135], v[48:51], v[64:67], v[120:135]
v_lshlrev_b32 v26, 16, v49
v_and_b32 v27, s63, v49
v_mfma_f32_32x32x16_bf16 v[136:151], v[48:51], v[68:71], v[136:151]
v_fmac_f32 v22, v26, v26
v_fmac_f32 v23, v27, v27
v_mfma_f32_16x16x32_bf16 v[32:35], v[28:31], v[56:59], v[32:35]
s_waitcnt lgkmcnt(0)
s_waitcnt vmcnt(3)
s_waitcnt vmcnt(0)
s_barrier
v_mfma_f32_32x32x16_bf16 v[88:103], v[52:55], v[72:75], v[88:103]
ds_read_b128 v[48:51], v8 offset:0
ds_read_b64_tr_b16 v[56:57], v12 offset:0
ds_read_b64_tr_b16 v[58:59], v12 offset:1024
ds_read_b64_tr_b16 v[60:61], v13 offset:0
ds_read_b64_tr_b16 v[62:63], v13 offset:1024
v_lshlrev_b32 v24, 16, v52
v_mfma_f32_32x32x16_bf16 v[104:119], v[52:55], v[76:79], v[104:119]
ds_read_b64_tr_b16 v[64:65], v14 offset:0
ds_read_b64_tr_b16 v[66:67], v14 offset:1024
ds_read_b64_tr_b16 v[68:69], v15 offset:0
ds_read_b64_tr_b16 v[70:71], v15 offset:1024
v_and_b32 v25, s63, v52
v_fmac_f32 v22, v24, v24
v_fmac_f32 v23, v25, v25
v_mfma_f32_32x32x16_bf16 v[120:135], v[52:55], v[80:83], v[120:135]
v_lshlrev_b32 v26, 16, v53
v_and_b32 v27, s63, v53
v_mfma_f32_32x32x16_bf16 v[136:151], v[52:55], v[84:87], v[136:151]
v_fmac_f32 v22, v26, v26
v_fmac_f32 v23, v27, v27
v_mfma_f32_16x16x32_bf16 v[32:35], v[28:31], v[72:75], v[32:35]
s_waitcnt lgkmcnt(0)
v_mfma_f32_32x32x16_bf16 v[88:103], v[48:51], v[56:59], v[88:103]
ds_read_b128 v[52:55], v9 offset:0
ds_read_b64_tr_b16 v[72:73], v12 offset:4096
ds_read_b64_tr_b16 v[74:75], v12 offset:5120
ds_read_b64_tr_b16 v[76:77], v13 offset:4096
ds_read_b64_tr_b16 v[78:79], v13 offset:5120
v_lshlrev_b32 v24, 16, v48
v_mfma_f32_32x32x16_bf16 v[104:119], v[48:51], v[60:63], v[104:119]
ds_read_b64_tr_b16 v[80:81], v14 offset:4096
ds_read_b64_tr_b16 v[82:83], v14 offset:5120
ds_read_b64_tr_b16 v[84:85], v15 offset:4096
ds_read_b64_tr_b16 v[86:87], v15 offset:5120
ds_read_b64_tr_b16 v[152:153], v19 offset:0
ds_read_b64_tr_b16 v[154:155], v20 offset:0
ds_read_b64_tr_b16 v[156:157], v19 offset:128
ds_read_b64_tr_b16 v[158:159], v20 offset:128
ds_read_b64_tr_b16 v[160:161], v19 offset:256
ds_read_b64_tr_b16 v[162:163], v20 offset:256
v_and_b32 v25, s63, v48
v_fmac_f32 v22, v24, v24
v_fmac_f32 v23, v25, v25
v_mfma_f32_32x32x16_bf16 v[120:135], v[48:51], v[64:67], v[120:135]
v_lshlrev_b32 v26, 16, v49
v_and_b32 v27, s63, v49
v_mfma_f32_32x32x16_bf16 v[136:151], v[48:51], v[68:71], v[136:151]
v_fmac_f32 v22, v26, v26
v_fmac_f32 v23, v27, v27
v_mfma_f32_16x16x32_bf16 v[32:35], v[28:31], v[56:59], v[32:35]
s_waitcnt lgkmcnt(0)
v_mfma_f32_32x32x16_bf16 v[88:103], v[52:55], v[72:75], v[88:103]
ds_read_b128 v[48:51], v10 offset:0
ds_read_b64_tr_b16 v[56:57], v12 offset:8192
ds_read_b64_tr_b16 v[58:59], v12 offset:9216
ds_read_b64_tr_b16 v[60:61], v13 offset:8192
ds_read_b64_tr_b16 v[62:63], v13 offset:9216
v_lshlrev_b32 v24, 16, v52
v_mfma_f32_32x32x16_bf16 v[104:119], v[52:55], v[76:79], v[104:119]
ds_read_b64_tr_b16 v[64:65], v14 offset:8192
ds_read_b64_tr_b16 v[66:67], v14 offset:9216
ds_read_b64_tr_b16 v[68:69], v15 offset:8192
ds_read_b64_tr_b16 v[70:71], v15 offset:9216
v_and_b32 v25, s63, v52
v_fmac_f32 v22, v24, v24
v_fmac_f32 v23, v25, v25
v_mfma_f32_32x32x16_bf16 v[120:135], v[52:55], v[80:83], v[120:135]
buffer_store_dwordx4 v[152:155], v21, s[20:23], s71 offen sc1
buffer_store_dwordx4 v[156:159], v21, s[20:23], s72 offen sc1
s_cmp_lt_u32 s47, 2
s_cselect_b64 exec, -1, 0
buffer_store_dwordx4 v[160:163], v21, s[20:23], s73 offen sc1
s_mov_b64 exec, -1
v_lshlrev_b32 v26, 16, v53
v_and_b32 v27, s63, v53
v_mfma_f32_32x32x16_bf16 v[136:151], v[52:55], v[84:87], v[136:151]
v_fmac_f32 v22, v26, v26
v_fmac_f32 v23, v27, v27
v_mfma_f32_16x16x32_bf16 v[32:35], v[28:31], v[72:75], v[32:35]
s_waitcnt lgkmcnt(0)
v_mfma_f32_32x32x16_bf16 v[88:103], v[48:51], v[56:59], v[88:103]
ds_read_b128 v[52:55], v11 offset:0
ds_read_b64_tr_b16 v[72:73], v12 offset:12288
ds_read_b64_tr_b16 v[74:75], v12 offset:13312
ds_read_b64_tr_b16 v[76:77], v13 offset:12288
ds_read_b64_tr_b16 v[78:79], v13 offset:13312
v_lshlrev_b32 v24, 16, v48
v_mfma_f32_32x32x16_bf16 v[104:119], v[48:51], v[60:63], v[104:119]
ds_read_b64_tr_b16 v[80:81], v14 offset:12288
ds_read_b64_tr_b16 v[82:83], v14 offset:13312
ds_read_b64_tr_b16 v[84:85], v15 offset:12288
ds_read_b64_tr_b16 v[86:87], v15 offset:13312
v_and_b32 v25, s63, v48
v_fmac_f32 v22, v24, v24
v_fmac_f32 v23, v25, v25
v_mfma_f32_32x32x16_bf16 v[120:135], v[48:51], v[64:67], v[120:135]
s_lshr_b32 s59, s2, 3
s_mul_i32 s59, s59, 278528
s_and_b32 s60, s2, 7
s_mul_i32 s60, s60, 10240
s_add_u32 s59, s59, s60
s_mul_i32 s60, s47, 2560
s_add_u32 s59, s59, s60
s_add_u32 s59, s59, 8060928
v_lshlrev_b32 v172, 4, v1
v_mov_b32 v168, -1
v_mov_b32 v169, -1
v_mov_b32 v170, -1
v_mov_b32 v171, -1
buffer_store_dwordx4 v[168:171], v172, s[20:23], s59 offen sc1
buffer_store_dwordx4 v[168:171], v172, s[20:23], s59 offen offset:1024 sc1
s_mov_b32 exec_hi, 0
buffer_store_dwordx4 v[168:171], v172, s[20:23], s59 offen offset:2048 sc1
s_mov_b64 exec, -1
v_lshlrev_b32 v26, 16, v49
v_and_b32 v27, s63, v49
v_mfma_f32_32x32x16_bf16 v[136:151], v[48:51], v[68:71], v[136:151]
v_fmac_f32 v22, v26, v26
v_fmac_f32 v23, v27, v27
v_mfma_f32_16x16x32_bf16 v[32:35], v[28:31], v[56:59], v[32:35]
s_waitcnt lgkmcnt(0)
v_mfma_f32_32x32x16_bf16 v[88:103], v[52:55], v[72:75], v[88:103]
v_lshlrev_b32 v24, 16, v52
v_mfma_f32_32x32x16_bf16 v[104:119], v[52:55], v[76:79], v[104:119]
v_and_b32 v25, s63, v52
v_fmac_f32 v22, v24, v24
v_fmac_f32 v23, v25, v25
v_mfma_f32_32x32x16_bf16 v[120:135], v[52:55], v[80:83], v[120:135]
v_lshlrev_b32 v26, 16, v53
v_and_b32 v27, s63, v53
v_mfma_f32_32x32x16_bf16 v[136:151], v[52:55], v[84:87], v[136:151]
v_fmac_f32 v22, v26, v26
v_fmac_f32 v23, v27, v27
v_mfma_f32_16x16x32_bf16 v[32:35], v[28:31], v[72:75], v[32:35]
v_add_f32 v22, v22, v23
v_mov_b32 v23, v22
v_and_b32 v40, 31, v1
v_lshlrev_b32 v40, 2, v40
v_permlane32_swap_b32 v22, v23
s_lshl_b32 s59, s47, 7
s_add_u32 s60, s59, 147968
v_add_u32 v41, s60, v40
v_add_f32 v22, v22, v23
ds_write_b32 v41, v22
s_lshl_b32 s60, s65, 7
s_add_u32 s60, s60, 149504
v_add_u32 v41, s60, v40
s_mov_b64 exec, 0xffff
ds_write2_b32 v41, v32, v33 offset0:0 offset1:16
s_mov_b64 exec, -1
s_add_u32 s59, s59, 147456
v_add_u32 v41, s59, v40
s_waitcnt lgkmcnt(0)
s_barrier
ds_read_b32 v42, v41
ds_read2st64_b32 v[24:25], v41 offset0:2 offset1:4
v_and_b32 v46, 31, v1
v_lshlrev_b32 v46, 2, v46
v_add_u32 v46, 149504, v46
s_lshl_b32 s59, s65, 7
v_add_u32 v47, s59, v46
ds_read_b32 v184, v47
s_lshl_b32 s59, s66, 7
v_add_u32 v47, s59, v46
ds_read_b32 v186, v47
s_lshl_b32 s59, s67, 7
v_add_u32 v47, s59, v46
ds_read_b32 v188, v47
s_lshl_b32 s59, s68, 7
v_add_u32 v47, s59, v46
ds_read_b32 v190, v47
s_waitcnt lgkmcnt(4)
v_add_f32 v44, v24, v25
v_mul_f32 v42, 0x3acccccd, v42
v_mul_f32 v44, 0x3acccccd, v44
v_fma_f32 v44, -v42, v42, v44
v_max_f32 v44, 0, v44
v_cvt_pk_bf16_f32 v44, v44, v42
v_and_b32 v42, s63, v44
v_lshlrev_b32 v44, 16, v44
v_add_f32 v44, 0x3727c5ac, v44
v_cvt_pk_bf16_f32 v44, v44, v44
v_lshlrev_b32 v44, 16, v44
v_sqrt_f32 v44, v44
s_nop 0
v_cvt_pk_bf16_f32 v44, v44, v44
v_lshlrev_b32 v44, 16, v44
v_rcp_f32 v44, v44
v_and_b32 v40, 31, v1
v_lshlrev_b32 v40, 2, v40
s_lshl_b32 s59, s47, 7
s_add_u32 s59, s59, 151040
v_add_u32 v41, s59, v40
ds_write2st64_b32 v41, v42, v44 offset0:0 offset1:2
v_lshrrev_b32 v41, 5, v1
v_lshlrev_b32 v41, 4, v41
v_add_u32 v41, s59, v41
s_waitcnt lgkmcnt(0)
ds_read_b128 v[152:155], v41 offset:0
ds_read_b128 v[168:171], v41 offset:512
ds_read_b128 v[156:159], v41 offset:32
ds_read_b128 v[172:175], v41 offset:544
ds_read_b128 v[160:163], v41 offset:64
ds_read_b128 v[176:179], v41 offset:576
ds_read_b128 v[164:167], v41 offset:96
ds_read_b128 v[180:183], v41 offset:608
v_lshrrev_b32 v41, 5, v1
v_mul_u32_u24 v41, 10240, v41
v_lshl_add_u32 v41, v40, 2, v41
s_lshl_b32 s61, s49, 2
s_add_u32 s61, s61, s47
s_mul_i32 s61, s61, 40960
s_lshl_b32 s62, s51, 11
s_add_u32 s60, s61, s62
s_add_u32 s60, s60, 5242880
s_waitcnt lgkmcnt(0)
v_pk_fma_f32 v[88:89], v[152:153], v[184:185], v[88:89] op_sel_hi:[1,0,1] neg_lo:[0,1,0] neg_hi:[0,1,0]
v_pk_fma_f32 v[90:91], v[154:155], v[184:185], v[90:91] op_sel_hi:[1,0,1] neg_lo:[0,1,0] neg_hi:[0,1,0]
v_pk_fma_f32 v[92:93], v[156:157], v[184:185], v[92:93] op_sel_hi:[1,0,1] neg_lo:[0,1,0] neg_hi:[0,1,0]
v_pk_fma_f32 v[94:95], v[158:159], v[184:185], v[94:95] op_sel_hi:[1,0,1] neg_lo:[0,1,0] neg_hi:[0,1,0]
v_pk_fma_f32 v[96:97], v[160:161], v[184:185], v[96:97] op_sel_hi:[1,0,1] neg_lo:[0,1,0] neg_hi:[0,1,0]
v_pk_fma_f32 v[98:99], v[162:163], v[184:185], v[98:99] op_sel_hi:[1,0,1] neg_lo:[0,1,0] neg_hi:[0,1,0]
v_pk_fma_f32 v[100:101], v[164:165], v[184:185], v[100:101] op_sel_hi:[1,0,1] neg_lo:[0,1,0] neg_hi:[0,1,0]
v_pk_fma_f32 v[102:103], v[166:167], v[184:185], v[102:103] op_sel_hi:[1,0,1] neg_lo:[0,1,0] neg_hi:[0,1,0]
v_pk_mul_f32 v[88:89], v[88:89], v[168:169]
v_pk_mul_f32 v[90:91], v[90:91], v[170:171]
v_pk_mul_f32 v[92:93], v[92:93], v[172:173]
v_pk_mul_f32 v[94:95], v[94:95], v[174:175]
v_pk_mul_f32 v[96:97], v[96:97], v[176:177]
v_pk_mul_f32 v[98:99], v[98:99], v[178:179]
v_pk_mul_f32 v[100:101], v[100:101], v[180:181]
v_pk_mul_f32 v[102:103], v[102:103], v[182:183]
v_cvt_pk_bf16_f32 v56, v88, v89
v_cvt_pk_bf16_f32 v57, v90, v91
v_cvt_pk_bf16_f32 v58, v92, v93
v_cvt_pk_bf16_f32 v59, v94, v95
v_cvt_pk_bf16_f32 v60, v96, v97
v_cvt_pk_bf16_f32 v61, v98, v99
v_cvt_pk_bf16_f32 v62, v100, v101
v_cvt_pk_bf16_f32 v63, v102, v103
s_lshl_b32 s59, s65, 9
s_add_u32 s59, s59, s60
buffer_store_dwordx4 v[56:59], v41, s[20:23], s59 offen sc1
s_add_u32 s59, s59, 20480
buffer_store_dwordx4 v[60:63], v41, s[20:23], s59 offen sc1
v_pk_fma_f32 v[104:105], v[152:153], v[186:187], v[104:105] op_sel_hi:[1,0,1] neg_lo:[0,1,0] neg_hi:[0,1,0]
v_pk_fma_f32 v[106:107], v[154:155], v[186:187], v[106:107] op_sel_hi:[1,0,1] neg_lo:[0,1,0] neg_hi:[0,1,0]
v_pk_fma_f32 v[108:109], v[156:157], v[186:187], v[108:109] op_sel_hi:[1,0,1] neg_lo:[0,1,0] neg_hi:[0,1,0]
v_pk_fma_f32 v[110:111], v[158:159], v[186:187], v[110:111] op_sel_hi:[1,0,1] neg_lo:[0,1,0] neg_hi:[0,1,0]
v_pk_fma_f32 v[112:113], v[160:161], v[186:187], v[112:113] op_sel_hi:[1,0,1] neg_lo:[0,1,0] neg_hi:[0,1,0]
v_pk_fma_f32 v[114:115], v[162:163], v[186:187], v[114:115] op_sel_hi:[1,0,1] neg_lo:[0,1,0] neg_hi:[0,1,0]
v_pk_fma_f32 v[116:117], v[164:165], v[186:187], v[116:117] op_sel_hi:[1,0,1] neg_lo:[0,1,0] neg_hi:[0,1,0]
v_pk_fma_f32 v[118:119], v[166:167], v[186:187], v[118:119] op_sel_hi:[1,0,1] neg_lo:[0,1,0] neg_hi:[0,1,0]
v_pk_mul_f32 v[104:105], v[104:105], v[168:169]
v_pk_mul_f32 v[106:107], v[106:107], v[170:171]
v_pk_mul_f32 v[108:109], v[108:109], v[172:173]
v_pk_mul_f32 v[110:111], v[110:111], v[174:175]
v_pk_mul_f32 v[112:113], v[112:113], v[176:177]
v_pk_mul_f32 v[114:115], v[114:115], v[178:179]
v_pk_mul_f32 v[116:117], v[116:117], v[180:181]
v_pk_mul_f32 v[118:119], v[118:119], v[182:183]
v_cvt_pk_bf16_f32 v64, v104, v105
v_cvt_pk_bf16_f32 v65, v106, v107
v_cvt_pk_bf16_f32 v66, v108, v109
v_cvt_pk_bf16_f32 v67, v110, v111
v_cvt_pk_bf16_f32 v68, v112, v113
v_cvt_pk_bf16_f32 v69, v114, v115
v_cvt_pk_bf16_f32 v70, v116, v117
v_cvt_pk_bf16_f32 v71, v118, v119
s_lshl_b32 s59, s66, 9
s_add_u32 s59, s59, s60
buffer_store_dwordx4 v[64:67], v41, s[20:23], s59 offen sc1
s_add_u32 s59, s59, 20480
buffer_store_dwordx4 v[68:71], v41, s[20:23], s59 offen sc1
v_pk_fma_f32 v[120:121], v[152:153], v[188:189], v[120:121] op_sel_hi:[1,0,1] neg_lo:[0,1,0] neg_hi:[0,1,0]
v_pk_fma_f32 v[122:123], v[154:155], v[188:189], v[122:123] op_sel_hi:[1,0,1] neg_lo:[0,1,0] neg_hi:[0,1,0]
v_pk_fma_f32 v[124:125], v[156:157], v[188:189], v[124:125] op_sel_hi:[1,0,1] neg_lo:[0,1,0] neg_hi:[0,1,0]
v_pk_fma_f32 v[126:127], v[158:159], v[188:189], v[126:127] op_sel_hi:[1,0,1] neg_lo:[0,1,0] neg_hi:[0,1,0]
v_pk_fma_f32 v[128:129], v[160:161], v[188:189], v[128:129] op_sel_hi:[1,0,1] neg_lo:[0,1,0] neg_hi:[0,1,0]
v_pk_fma_f32 v[130:131], v[162:163], v[188:189], v[130:131] op_sel_hi:[1,0,1] neg_lo:[0,1,0] neg_hi:[0,1,0]
v_pk_fma_f32 v[132:133], v[164:165], v[188:189], v[132:133] op_sel_hi:[1,0,1] neg_lo:[0,1,0] neg_hi:[0,1,0]
v_pk_fma_f32 v[134:135], v[166:167], v[188:189], v[134:135] op_sel_hi:[1,0,1] neg_lo:[0,1,0] neg_hi:[0,1,0]
v_pk_mul_f32 v[120:121], v[120:121], v[168:169]
v_pk_mul_f32 v[122:123], v[122:123], v[170:171]
v_pk_mul_f32 v[124:125], v[124:125], v[172:173]
v_pk_mul_f32 v[126:127], v[126:127], v[174:175]
v_pk_mul_f32 v[128:129], v[128:129], v[176:177]
v_pk_mul_f32 v[130:131], v[130:131], v[178:179]
v_pk_mul_f32 v[132:133], v[132:133], v[180:181]
v_pk_mul_f32 v[134:135], v[134:135], v[182:183]
v_cvt_pk_bf16_f32 v56, v120, v121
v_cvt_pk_bf16_f32 v57, v122, v123
v_cvt_pk_bf16_f32 v58, v124, v125
v_cvt_pk_bf16_f32 v59, v126, v127
v_cvt_pk_bf16_f32 v60, v128, v129
v_cvt_pk_bf16_f32 v61, v130, v131
v_cvt_pk_bf16_f32 v62, v132, v133
v_cvt_pk_bf16_f32 v63, v134, v135
s_lshl_b32 s59, s67, 9
s_add_u32 s59, s59, s60
buffer_store_dwordx4 v[56:59], v41, s[20:23], s59 offen sc1
s_add_u32 s59, s59, 20480
buffer_store_dwordx4 v[60:63], v41, s[20:23], s59 offen sc1
v_pk_fma_f32 v[136:137], v[152:153], v[190:191], v[136:137] op_sel_hi:[1,0,1] neg_lo:[0,1,0] neg_hi:[0,1,0]
v_pk_fma_f32 v[138:139], v[154:155], v[190:191], v[138:139] op_sel_hi:[1,0,1] neg_lo:[0,1,0] neg_hi:[0,1,0]
v_pk_fma_f32 v[140:141], v[156:157], v[190:191], v[140:141] op_sel_hi:[1,0,1] neg_lo:[0,1,0] neg_hi:[0,1,0]
v_pk_fma_f32 v[142:143], v[158:159], v[190:191], v[142:143] op_sel_hi:[1,0,1] neg_lo:[0,1,0] neg_hi:[0,1,0]
v_pk_fma_f32 v[144:145], v[160:161], v[190:191], v[144:145] op_sel_hi:[1,0,1] neg_lo:[0,1,0] neg_hi:[0,1,0]
v_pk_fma_f32 v[146:147], v[162:163], v[190:191], v[146:147] op_sel_hi:[1,0,1] neg_lo:[0,1,0] neg_hi:[0,1,0]
v_pk_fma_f32 v[148:149], v[164:165], v[190:191], v[148:149] op_sel_hi:[1,0,1] neg_lo:[0,1,0] neg_hi:[0,1,0]
v_pk_fma_f32 v[150:151], v[166:167], v[190:191], v[150:151] op_sel_hi:[1,0,1] neg_lo:[0,1,0] neg_hi:[0,1,0]
v_pk_mul_f32 v[136:137], v[136:137], v[168:169]
v_pk_mul_f32 v[138:139], v[138:139], v[170:171]
v_pk_mul_f32 v[140:141], v[140:141], v[172:173]
v_pk_mul_f32 v[142:143], v[142:143], v[174:175]
v_pk_mul_f32 v[144:145], v[144:145], v[176:177]
v_pk_mul_f32 v[146:147], v[146:147], v[178:179]
v_pk_mul_f32 v[148:149], v[148:149], v[180:181]
v_pk_mul_f32 v[150:151], v[150:151], v[182:183]
v_cvt_pk_bf16_f32 v64, v136, v137
v_cvt_pk_bf16_f32 v65, v138, v139
v_cvt_pk_bf16_f32 v66, v140, v141
v_cvt_pk_bf16_f32 v67, v142, v143
v_cvt_pk_bf16_f32 v68, v144, v145
v_cvt_pk_bf16_f32 v69, v146, v147
v_cvt_pk_bf16_f32 v70, v148, v149
v_cvt_pk_bf16_f32 v71, v150, v151
s_lshl_b32 s59, s68, 9
s_add_u32 s59, s59, s60
buffer_store_dwordx4 v[64:67], v41, s[20:23], s59 offen sc1
s_add_u32 s59, s59, 20480
buffer_store_dwordx4 v[68:71], v41, s[20:23], s59 offen sc1
s_branch L_g1_fin
L_g1_none:
s_branch L_g1_fin
L_g1_ch1:
s_mov_b32 s20, s44
s_and_b32 s21, s45, 0xffff
s_mov_b32 s22, 20611072
s_mov_b32 s23, 0x20000
s_mul_i32 s52, s50, 52
s_lshr_b32 s52, s52, 8
s_mul_i32 s61, s52, 5
s_sub_u32 s51, s50, s61
s_mov_b32 s63, 0xffff0000
v_mov_b32 v22, 0
v_mov_b32 v23, 0
v_and_b32 v40, 15, v1
v_bfe_u32 v41, v1, 4, 1
v_cmp_eq_u32 vcc, v40, v41
v_mov_b32 v42, 0x3f803f80
s_nop 0
v_cndmask_b32_e64 v28, 0, v42, vcc
v_cndmask_b32_e64 v29, 0, v42, vcc
v_cndmask_b32_e64 v30, 0, v42, vcc
v_cndmask_b32_e64 v31, 0, v42, vcc
s_mov_b32 s28, s40
s_and_b32 s29, s41, 0xffff
s_mov_b32 s30, 3072
s_mov_b32 s31, 0x20000
v_lshlrev_b32 v40, 2, v1
s_mul_i32 s59, s50, 192
buffer_load_dword v16, v40, s[28:31], s59 offen
v_and_b32 v40, 31, v1
v_lshrrev_b32 v41, 5, v1
v_bfe_u32 v42, v1, 1, 3
v_xor_b32 v41, v41, v42
v_lshlrev_b32 v41, 4, v41
v_lshl_add_u32 v41, v40, 7, v41
s_lshl_b32 s59, s47, 12
v_add_u32 v8, s59, v41
v_xor_b32 v9, 32, v8
v_xor_b32 v10, 64, v8
v_xor_b32 v11, 96, v8
v_lshrrev_b32 v40, 5, v1
v_lshlrev_b32 v40, 3, v40
v_bfe_u32 v41, v1, 2, 2
v_add_u32 v40, v40, v41
v_bfe_u32 v42, v1, 4, 1
v_lshlrev_b32 v42, 5, v42
v_and_b32 v43, 3, v1
v_lshl_add_u32 v42, v43, 3, v42
v_mul_u32_u24 v40, 192, v40
v_add_u32 v42, v40, v42
v_add_u32 v42, 98304, v42
s_add_u32 s65, s47, 0
s_cmp_ge_u32 s65, 3
s_cselect_b32 s59, 3, 0
s_sub_u32 s65, s65, s59
s_cmp_ge_u32 s65, 3
s_cselect_b32 s59, 3, 0
s_sub_u32 s65, s65, s59
s_lshl_b32 s59, s65, 6
v_add_u32 v12, s59, v42
s_add_u32 s66, s47, 1
s_cmp_ge_u32 s66, 3
s_cselect_b32 s59, 3, 0
s_sub_u32 s66, s66, s59
s_cmp_ge_u32 s66, 3
s_cselect_b32 s59, 3, 0
s_sub_u32 s66, s66, s59
s_lshl_b32 s59, s66, 6
v_add_u32 v13, s59, v42
s_add_u32 s67, s47, 2
s_cmp_ge_u32 s67, 3
s_cselect_b32 s59, 3, 0
s_sub_u32 s67, s67, s59
s_cmp_ge_u32 s67, 3
s_cselect_b32 s59, 3, 0
s_sub_u32 s67, s67, s59
s_lshl_b32 s59, s67, 6
v_add_u32 v14, s59, v42
s_waitcnt vmcnt(6)
s_barrier
ds_read_b128 v[48:51], v8 offset:0
ds_read_b64_tr_b16 v[56:57], v12 offset:0
ds_read_b64_tr_b16 v[58:59], v12 offset:768
ds_read_b64_tr_b16 v[60:61], v13 offset:0
ds_read_b64_tr_b16 v[62:63], v13 offset:768
ds_read_b64_tr_b16 v[64:65], v14 offset:0
ds_read_b64_tr_b16 v[66:67], v14 offset:768
s_waitcnt lgkmcnt(0)
v_mfma_f32_32x32x16_bf16 v[88:103], v[56:59], v[48:51], 0
ds_read_b128 v[52:55], v9 offset:0
ds_read_b64_tr_b16 v[72:73], v12 offset:3072
ds_read_b64_tr_b16 v[74:75], v12 offset:3840
ds_read_b64_tr_b16 v[76:77], v13 offset:3072
ds_read_b64_tr_b16 v[78:79], v13 offset:3840
v_lshlrev_b32 v24, 16, v50
v_mfma_f32_32x32x16_bf16 v[104:119], v[60:63], v[48:51], 0
ds_read_b64_tr_b16 v[80:81], v14 offset:3072
ds_read_b64_tr_b16 v[82:83], v14 offset:3840
s_add_u32 m0, s56, 32768
s_nop 0
buffer_load_dwordx4 v2, s[8:11], s53 offen lds
v_and_b32 v25, s63, v50
v_fmac_f32 v22, v24, v24
v_fmac_f32 v23, v25, v25
v_mfma_f32_32x32x16_bf16 v[120:135], v[64:67], v[48:51], 0
s_add_u32 m0, s57, 32768
s_nop 0
buffer_load_dwordx4 v4, s[12:15], s54 offen lds
v_lshlrev_b32 v26, 16, v51
v_and_b32 v27, s63, v51
v_fmac_f32 v22, v26, v26
v_fmac_f32 v23, v27, v27
v_mfma_f32_16x16x32_bf16 v[32:35], v[28:31], v[56:59], 0
v_mfma_f32_16x16x32_bf16 v[36:39], v[28:31], v[48:51], 0
s_waitcnt lgkmcnt(0)
v_mfma_f32_32x32x16_bf16 v[88:103], v[72:75], v[52:55], v[88:103]
ds_read_b128 v[48:51], v10 offset:0
ds_read_b64_tr_b16 v[56:57], v12 offset:6144
ds_read_b64_tr_b16 v[58:59], v12 offset:6912
ds_read_b64_tr_b16 v[60:61], v13 offset:6144
ds_read_b64_tr_b16 v[62:63], v13 offset:6912
v_lshlrev_b32 v24, 16, v54
v_mfma_f32_32x32x16_bf16 v[104:119], v[76:79], v[52:55], v[104:119]
ds_read_b64_tr_b16 v[64:65], v14 offset:6144
ds_read_b64_tr_b16 v[66:67], v14 offset:6912
s_add_u32 m0, s56, 33792
s_nop 0
buffer_load_dwordx4 v3, s[8:11], s53 offen lds
v_and_b32 v25, s63, v54
v_fmac_f32 v22, v24, v24
v_fmac_f32 v23, v25, v25
v_mfma_f32_32x32x16_bf16 v[120:135], v[80:83], v[52:55], v[120:135]
s_add_u32 m0, s57, 33792
s_nop 0
buffer_load_dwordx4 v5, s[12:15], s54 offen lds
v_lshlrev_b32 v26, 16, v55
v_and_b32 v27, s63, v55
v_fmac_f32 v22, v26, v26
v_fmac_f32 v23, v27, v27
v_mfma_f32_16x16x32_bf16 v[32:35], v[28:31], v[72:75], v[32:35]
v_mfma_f32_16x16x32_bf16 v[36:39], v[28:31], v[52:55], v[36:39]
s_waitcnt lgkmcnt(0)
v_mfma_f32_32x32x16_bf16 v[88:103], v[56:59], v[48:51], v[88:103]
ds_read_b128 v[52:55], v11 offset:0
ds_read_b64_tr_b16 v[72:73], v12 offset:9216
ds_read_b64_tr_b16 v[74:75], v12 offset:9984
ds_read_b64_tr_b16 v[76:77], v13 offset:9216
ds_read_b64_tr_b16 v[78:79], v13 offset:9984
v_lshlrev_b32 v24, 16, v50
v_mfma_f32_32x32x16_bf16 v[104:119], v[60:63], v[48:51], v[104:119]
ds_read_b64_tr_b16 v[80:81], v14 offset:9216
ds_read_b64_tr_b16 v[82:83], v14 offset:9984
s_add_u32 m0, s58, 24576
s_nop 0
buffer_load_dwordx4 v6, s[16:19], s55 offen lds
v_and_b32 v25, s63, v50
v_fmac_f32 v22, v24, v24
v_fmac_f32 v23, v25, v25
v_mfma_f32_32x32x16_bf16 v[120:135], v[64:67], v[48:51], v[120:135]
s_add_u32 m0, s58, 25600
s_nop 0
buffer_load_dwordx4 v7, s[16:19], s55 offen lds
s_add_u32 s53, s53, 128
s_add_u32 s54, s54, 245760
s_add_u32 s55, s55, 196608
v_lshlrev_b32 v26, 16, v51
v_and_b32 v27, s63, v51
v_fmac_f32 v22, v26, v26
v_fmac_f32 v23, v27, v27
v_mfma_f32_16x16x32_bf16 v[32:35], v[28:31], v[56:59], v[32:35]
v_mfma_f32_16x16x32_bf16 v[36:39], v[28:31], v[48:51], v[36:39]
s_waitcnt lgkmcnt(0)
s_waitcnt vmcnt(6)
s_barrier
v_mfma_f32_32x32x16_bf16 v[88:103], v[72:75], v[52:55], v[88:103]
ds_read_b128 v[48:51], v8 offset:16384
ds_read_b64_tr_b16 v[56:57], v12 offset:12288
ds_read_b64_tr_b16 v[58:59], v12 offset:13056
ds_read_b64_tr_b16 v[60:61], v13 offset:12288
ds_read_b64_tr_b16 v[62:63], v13 offset:13056
v_lshlrev_b32 v24, 16, v54
v_mfma_f32_32x32x16_bf16 v[104:119], v[76:79], v[52:55], v[104:119]
ds_read_b64_tr_b16 v[64:65], v14 offset:12288
ds_read_b64_tr_b16 v[66:67], v14 offset:13056
s_add_u32 m0, s56, 0
s_nop 0
buffer_load_dwordx4 v2, s[8:11], s53 offen lds
v_and_b32 v25, s63, v54
v_fmac_f32 v22, v24, v24
v_fmac_f32 v23, v25, v25
v_mfma_f32_32x32x16_bf16 v[120:135], v[80:83], v[52:55], v[120:135]
s_add_u32 m0, s57, 0
s_nop 0
buffer_load_dwordx4 v4, s[12:15], s54 offen lds
v_lshlrev_b32 v26, 16, v55
v_and_b32 v27, s63, v55
v_fmac_f32 v22, v26, v26
v_fmac_f32 v23, v27, v27
v_mfma_f32_16x16x32_bf16 v[32:35], v[28:31], v[72:75], v[32:35]
v_mfma_f32_16x16x32_bf16 v[36:39], v[28:31], v[52:55], v[36:39]
s_waitcnt lgkmcnt(0)
v_mfma_f32_32x32x16_bf16 v[88:103], v[56:59], v[48:51], v[88:103]
ds_read_b128 v[52:55], v9 offset:16384
ds_read_b64_tr_b16 v[72:73], v12 offset:15360
ds_read_b64_tr_b16 v[74:75], v12 offset:16128
ds_read_b64_tr_b16 v[76:77], v13 offset:15360
ds_read_b64_tr_b16 v[78:79], v13 offset:16128
v_lshlrev_b32 v24, 16, v50
v_mfma_f32_32x32x16_bf16 v[104:119], v[60:63], v[48:51], v[104:119]
ds_read_b64_tr_b16 v[80:81], v14 offset:15360
ds_read_b64_tr_b16 v[82:83], v14 offset:16128
s_add_u32 m0, s56, 1024
s_nop 0
buffer_load_dwordx4 v3, s[8:11], s53 offen lds
v_and_b32 v25, s63, v50
v_fmac_f32 v22, v24, v24
v_fmac_f32 v23, v25, v25
v_mfma_f32_32x32x16_bf16 v[120:135], v[64:67], v[48:51], v[120:135]
s_add_u32 m0, s57, 1024
s_nop 0
buffer_load_dwordx4 v5, s[12:15], s54 offen lds
v_lshlrev_b32 v26, 16, v51
v_and_b32 v27, s63, v51
v_fmac_f32 v22, v26, v26
v_fmac_f32 v23, v27, v27
v_mfma_f32_16x16x32_bf16 v[32:35], v[28:31], v[56:59], v[32:35]
v_mfma_f32_16x16x32_bf16 v[36:39], v[28:31], v[48:51], v[36:39]
s_waitcnt lgkmcnt(0)
v_mfma_f32_32x32x16_bf16 v[88:103], v[72:75], v[52:55], v[88:103]
ds_read_b128 v[48:51], v10 offset:16384
ds_read_b64_tr_b16 v[56:57], v12 offset:18432
ds_read_b64_tr_b16 v[58:59], v12 offset:19200
ds_read_b64_tr_b16 v[60:61], v13 offset:18432
ds_read_b64_tr_b16 v[62:63], v13 offset:19200
v_lshlrev_b32 v24, 16, v54
v_mfma_f32_32x32x16_bf16 v[104:119], v[76:79], v[52:55], v[104:119]
ds_read_b64_tr_b16 v[64:65], v14 offset:18432
ds_read_b64_tr_b16 v[66:67], v14 offset:19200
s_add_u32 m0, s58, 0
s_nop 0
buffer_load_dwordx4 v6, s[16:19], s55 offen lds
v_and_b32 v25, s63, v54
v_fmac_f32 v22, v24, v24
v_fmac_f32 v23, v25, v25
v_mfma_f32_32x32x16_bf16 v[120:135], v[80:83], v[52:55], v[120:135]
v_lshlrev_b32 v26, 16, v55
v_and_b32 v27, s63, v55
v_fmac_f32 v22, v26, v26
v_fmac_f32 v23, v27, v27
v_mfma_f32_16x16x32_bf16 v[32:35], v[28:31], v[72:75], v[32:35]
v_mfma_f32_16x16x32_bf16 v[36:39], v[28:31], v[52:55], v[36:39]
s_waitcnt lgkmcnt(0)
v_mfma_f32_32x32x16_bf16 v[88:103], v[56:59], v[48:51], v[88:103]
ds_read_b128 v[52:55], v11 offset:16384
ds_read_b64_tr_b16 v[72:73], v12 offset:21504
ds_read_b64_tr_b16 v[74:75], v12 offset:22272
ds_read_b64_tr_b16 v[76:77], v13 offset:21504
ds_read_b64_tr_b16 v[78:79], v13 offset:22272
v_lshlrev_b32 v24, 16, v50
v_mfma_f32_32x32x16_bf16 v[104:119], v[60:63], v[48:51], v[104:119]
ds_read_b64_tr_b16 v[80:81], v14 offset:21504
ds_read_b64_tr_b16 v[82:83], v14 offset:22272
s_add_u32 m0, s58, 1024
s_nop 0
buffer_load_dwordx4 v7, s[16:19], s55 offen lds
s_add_u32 s53, s53, 128
s_add_u32 s54, s54, 245760
s_add_u32 s55, s55, 196608
v_and_b32 v25, s63, v50
v_fmac_f32 v22, v24, v24
v_fmac_f32 v23, v25, v25
v_mfma_f32_32x32x16_bf16 v[120:135], v[64:67], v[48:51], v[120:135]
v_lshlrev_b32 v26, 16, v51
v_and_b32 v27, s63, v51
v_fmac_f32 v22, v26, v26
v_fmac_f32 v23, v27, v27
v_mfma_f32_16x16x32_bf16 v[32:35], v[28:31], v[56:59], v[32:35]
v_mfma_f32_16x16x32_bf16 v[36:39], v[28:31], v[48:51], v[36:39]
s_waitcnt lgkmcnt(0)
s_waitcnt vmcnt(6)
s_barrier
v_mfma_f32_32x32x16_bf16 v[88:103], v[72:75], v[52:55], v[88:103]
ds_read_b128 v[48:51], v8 offset:32768
ds_read_b64_tr_b16 v[56:57], v12 offset:24576
ds_read_b64_tr_b16 v[58:59], v12 offset:25344
ds_read_b64_tr_b16 v[60:61], v13 offset:24576
ds_read_b64_tr_b16 v[62:63], v13 offset:25344
v_lshlrev_b32 v24, 16, v54
v_mfma_f32_32x32x16_bf16 v[104:119], v[76:79], v[52:55], v[104:119]
ds_read_b64_tr_b16 v[64:65], v14 offset:24576
ds_read_b64_tr_b16 v[66:67], v14 offset:25344
s_add_u32 m0, s56, 16384
s_nop 0
buffer_load_dwordx4 v2, s[8:11], s53 offen lds
v_and_b32 v25, s63, v54
v_fmac_f32 v22, v24, v24
v_fmac_f32 v23, v25, v25
v_mfma_f32_32x32x16_bf16 v[120:135], v[80:83], v[52:55], v[120:135]
s_add_u32 m0, s57, 16384
s_nop 0
buffer_load_dwordx4 v4, s[12:15], s54 offen lds
v_lshlrev_b32 v26, 16, v55
v_and_b32 v27, s63, v55
v_fmac_f32 v22, v26, v26
v_fmac_f32 v23, v27, v27
v_mfma_f32_16x16x32_bf16 v[32:35], v[28:31], v[72:75], v[32:35]
v_mfma_f32_16x16x32_bf16 v[36:39], v[28:31], v[52:55], v[36:39]
s_waitcnt lgkmcnt(0)
v_mfma_f32_32x32x16_bf16 v[88:103], v[56:59], v[48:51], v[88:103]
ds_read_b128 v[52:55], v9 offset:32768
ds_read_b64_tr_b16 v[72:73], v12 offset:27648
ds_read_b64_tr_b16 v[74:75], v12 offset:28416
ds_read_b64_tr_b16 v[76:77], v13 offset:27648
ds_read_b64_tr_b16 v[78:79], v13 offset:28416
v_lshlrev_b32 v24, 16, v50
v_mfma_f32_32x32x16_bf16 v[104:119], v[60:63], v[48:51], v[104:119]
ds_read_b64_tr_b16 v[80:81], v14 offset:27648
ds_read_b64_tr_b16 v[82:83], v14 offset:28416
s_add_u32 m0, s56, 17408
s_nop 0
buffer_load_dwordx4 v3, s[8:11], s53 offen lds
v_and_b32 v25, s63, v50
v_fmac_f32 v22, v24, v24
v_fmac_f32 v23, v25, v25
v_mfma_f32_32x32x16_bf16 v[120:135], v[64:67], v[48:51], v[120:135]
s_add_u32 m0, s57, 17408
s_nop 0
buffer_load_dwordx4 v5, s[12:15], s54 offen lds
v_lshlrev_b32 v26, 16, v51
v_and_b32 v27, s63, v51
v_fmac_f32 v22, v26, v26
v_fmac_f32 v23, v27, v27
v_mfma_f32_16x16x32_bf16 v[32:35], v[28:31], v[56:59], v[32:35]
v_mfma_f32_16x16x32_bf16 v[36:39], v[28:31], v[48:51], v[36:39]
s_waitcnt lgkmcnt(0)
v_mfma_f32_32x32x16_bf16 v[88:103], v[72:75], v[52:55], v[88:103]
ds_read_b128 v[48:51], v10 offset:32768
ds_read_b64_tr_b16 v[56:57], v12 offset:30720
ds_read_b64_tr_b16 v[58:59], v12 offset:31488
ds_read_b64_tr_b16 v[60:61], v13 offset:30720
ds_read_b64_tr_b16 v[62:63], v13 offset:31488
v_lshlrev_b32 v24, 16, v54
v_mfma_f32_32x32x16_bf16 v[104:119], v[76:79], v[52:55], v[104:119]
ds_read_b64_tr_b16 v[64:65], v14 offset:30720
ds_read_b64_tr_b16 v[66:67], v14 offset:31488
s_add_u32 m0, s58, 12288
s_nop 0
buffer_load_dwordx4 v6, s[16:19], s55 offen lds
v_and_b32 v25, s63, v54
v_fmac_f32 v22, v24, v24
v_fmac_f32 v23, v25, v25
v_mfma_f32_32x32x16_bf16 v[120:135], v[80:83], v[52:55], v[120:135]
v_lshlrev_b32 v26, 16, v55
v_and_b32 v27, s63, v55
v_fmac_f32 v22, v26, v26
v_fmac_f32 v23, v27, v27
v_mfma_f32_16x16x32_bf16 v[32:35], v[28:31], v[72:75], v[32:35]
v_mfma_f32_16x16x32_bf16 v[36:39], v[28:31], v[52:55], v[36:39]
s_waitcnt lgkmcnt(0)
v_mfma_f32_32x32x16_bf16 v[88:103], v[56:59], v[48:51], v[88:103]
ds_read_b128 v[52:55], v11 offset:32768
ds_read_b64_tr_b16 v[72:73], v12 offset:33792
ds_read_b64_tr_b16 v[74:75], v12 offset:34560
ds_read_b64_tr_b16 v[76:77], v13 offset:33792
ds_read_b64_tr_b16 v[78:79], v13 offset:34560
v_lshlrev_b32 v24, 16, v50
v_mfma_f32_32x32x16_bf16 v[104:119], v[60:63], v[48:51], v[104:119]
ds_read_b64_tr_b16 v[80:81], v14 offset:33792
ds_read_b64_tr_b16 v[82:83], v14 offset:34560
s_add_u32 m0, s58, 13312
s_nop 0
buffer_load_dwordx4 v7, s[16:19], s55 offen lds
s_add_u32 s53, s53, 128
s_add_u32 s54, s54, 245760
s_add_u32 s55, s55, 196608
v_and_b32 v25, s63, v50
v_fmac_f32 v22, v24, v24
v_fmac_f32 v23, v25, v25
v_mfma_f32_32x32x16_bf16 v[120:135], v[64:67], v[48:51], v[120:135]
v_lshlrev_b32 v26, 16, v51
v_and_b32 v27, s63, v51
v_fmac_f32 v22, v26, v26
v_fmac_f32 v23, v27, v27
v_mfma_f32_16x16x32_bf16 v[32:35], v[28:31], v[56:59], v[32:35]
v_mfma_f32_16x16x32_bf16 v[36:39], v[28:31], v[48:51], v[36:39]
s_waitcnt lgkmcnt(0)
s_waitcnt vmcnt(6)
s_barrier
v_mfma_f32_32x32x16_bf16 v[88:103], v[72:75], v[52:55], v[88:103]
ds_read_b128 v[48:51], v8 offset:0
ds_read_b64_tr_b16 v[56:57], v12 offset:0
ds_read_b64_tr_b16 v[58:59], v12 offset:768
ds_read_b64_tr_b16 v[60:61], v13 offset:0
ds_read_b64_tr_b16 v[62:63], v13 offset:768
v_lshlrev_b32 v24, 16, v54
v_mfma_f32_32x32x16_bf16 v[104:119], v[76:79], v[52:55], v[104:119]
ds_read_b64_tr_b16 v[64:65], v14 offset:0
ds_read_b64_tr_b16 v[66:67], v14 offset:768
s_add_u32 m0, s56, 32768
s_nop 0
buffer_load_dwordx4 v2, s[8:11], s53 offen lds
v_and_b32 v25, s63, v54
v_fmac_f32 v22, v24, v24
v_fmac_f32 v23, v25, v25
v_mfma_f32_32x32x16_bf16 v[120:135], v[80:83], v[52:55], v[120:135]
s_add_u32 m0, s57, 32768
s_nop 0
buffer_load_dwordx4 v4, s[12:15], s54 offen lds
v_lshlrev_b32 v26, 16, v55
v_and_b32 v27, s63, v55
v_fmac_f32 v22, v26, v26
v_fmac_f32 v23, v27, v27
v_mfma_f32_16x16x32_bf16 v[32:35], v[28:31], v[72:75], v[32:35]
v_mfma_f32_16x16x32_bf16 v[36:39], v[28:31], v[52:55], v[36:39]
s_waitcnt lgkmcnt(0)
v_mfma_f32_32x32x16_bf16 v[88:103], v[56:59], v[48:51], v[88:103]
ds_read_b128 v[52:55], v9 offset:0
ds_read_b64_tr_b16 v[72:73], v12 offset:3072
ds_read_b64_tr_b16 v[74:75], v12 offset:3840
ds_read_b64_tr_b16 v[76:77], v13 offset:3072
ds_read_b64_tr_b16 v[78:79], v13 offset:3840
v_lshlrev_b32 v24, 16, v50
v_mfma_f32_32x32x16_bf16 v[104:119], v[60:63], v[48:51], v[104:119]
ds_read_b64_tr_b16 v[80:81], v14 offset:3072
ds_read_b64_tr_b16 v[82:83], v14 offset:3840
s_add_u32 m0, s56, 33792
s_nop 0
buffer_load_dwordx4 v3, s[8:11], s53 offen lds
v_and_b32 v25, s63, v50
v_fmac_f32 v22, v24, v24
v_fmac_f32 v23, v25, v25
v_mfma_f32_32x32x16_bf16 v[120:135], v[64:67], v[48:51], v[120:135]
s_add_u32 m0, s57, 33792
s_nop 0
buffer_load_dwordx4 v5, s[12:15], s54 offen lds
v_lshlrev_b32 v26, 16, v51
v_and_b32 v27, s63, v51
v_fmac_f32 v22, v26, v26
v_fmac_f32 v23, v27, v27
v_mfma_f32_16x16x32_bf16 v[32:35], v[28:31], v[56:59], v[32:35]
v_mfma_f32_16x16x32_bf16 v[36:39], v[28:31], v[48:51], v[36:39]
s_waitcnt lgkmcnt(0)
v_mfma_f32_32x32x16_bf16 v[88:103], v[72:75], v[52:55], v[88:103]
ds_read_b128 v[48:51], v10 offset:0
ds_read_b64_tr_b16 v[56:57], v12 offset:6144
ds_read_b64_tr_b16 v[58:59], v12 offset:6912
ds_read_b64_tr_b16 v[60:61], v13 offset:6144
ds_read_b64_tr_b16 v[62:63], v13 offset:6912
v_lshlrev_b32 v24, 16, v54
v_mfma_f32_32x32x16_bf16 v[104:119], v[76:79], v[52:55], v[104:119]
ds_read_b64_tr_b16 v[64:65], v14 offset:6144
ds_read_b64_tr_b16 v[66:67], v14 offset:6912
s_add_u32 m0, s58, 24576
s_nop 0
buffer_load_dwordx4 v6, s[16:19], s55 offen lds
v_and_b32 v25, s63, v54
v_fmac_f32 v22, v24, v24
v_fmac_f32 v23, v25, v25
v_mfma_f32_32x32x16_bf16 v[120:135], v[80:83], v[52:55], v[120:135]
v_lshlrev_b32 v26, 16, v55
v_and_b32 v27, s63, v55
v_fmac_f32 v22, v26, v26
v_fmac_f32 v23, v27, v27
v_mfma_f32_16x16x32_bf16 v[32:35], v[28:31], v[72:75], v[32:35]
v_mfma_f32_16x16x32_bf16 v[36:39], v[28:31], v[52:55], v[36:39]
s_waitcnt lgkmcnt(0)
v_mfma_f32_32x32x16_bf16 v[88:103], v[56:59], v[48:51], v[88:103]
ds_read_b128 v[52:55], v11 offset:0
ds_read_b64_tr_b16 v[72:73], v12 offset:9216
ds_read_b64_tr_b16 v[74:75], v12 offset:9984
ds_read_b64_tr_b16 v[76:77], v13 offset:9216
ds_read_b64_tr_b16 v[78:79], v13 offset:9984
v_lshlrev_b32 v24, 16, v50
v_mfma_f32_32x32x16_bf16 v[104:119], v[60:63], v[48:51], v[104:119]
ds_read_b64_tr_b16 v[80:81], v14 offset:9216
ds_read_b64_tr_b16 v[82:83], v14 offset:9984
s_add_u32 m0, s58, 25600
s_nop 0
buffer_load_dwordx4 v7, s[16:19], s55 offen lds
s_add_u32 s53, s53, 128
s_add_u32 s54, s54, 245760
s_add_u32 s55, s55, 196608
v_and_b32 v25, s63, v50
v_fmac_f32 v22, v24, v24
v_fmac_f32 v23, v25, v25
v_mfma_f32_32x32x16_bf16 v[120:135], v[64:67], v[48:51], v[120:135]
v_lshlrev_b32 v26, 16, v51
v_and_b32 v27, s63, v51
v_fmac_f32 v22, v26, v26
v_fmac_f32 v23, v27, v27
v_mfma_f32_16x16x32_bf16 v[32:35], v[28:31], v[56:59], v[32:35]
v_mfma_f32_16x16x32_bf16 v[36:39], v[28:31], v[48:51], v[36:39]
s_waitcnt lgkmcnt(0)
s_waitcnt vmcnt(6)
s_barrier
v_mfma_f32_32x32x16_bf16 v[88:103], v[72:75], v[52:55], v[88:103]
ds_read_b128 v[48:51], v8 offset:16384
ds_read_b64_tr_b16 v[56:57], v12 offset:12288
ds_read_b64_tr_b16 v[58:59], v12 offset:13056
ds_read_b64_tr_b16 v[60:61], v13 offset:12288
ds_read_b64_tr_b16 v[62:63], v13 offset:13056
v_lshlrev_b32 v24, 16, v54
v_mfma_f32_32x32x16_bf16 v[104:119], v[76:79], v[52:55], v[104:119]
ds_read_b64_tr_b16 v[64:65], v14 offset:12288
ds_read_b64_tr_b16 v[66:67], v14 offset:13056
s_add_u32 m0, s56, 0
s_nop 0
buffer_load_dwordx4 v2, s[8:11], s53 offen lds
v_and_b32 v25, s63, v54
v_fmac_f32 v22, v24, v24
v_fmac_f32 v23, v25, v25
v_mfma_f32_32x32x16_bf16 v[120:135], v[80:83], v[52:55], v[120:135]
s_add_u32 m0, s57, 0
s_nop 0
buffer_load_dwordx4 v4, s[12:15], s54 offen lds
v_lshlrev_b32 v26, 16, v55
v_and_b32 v27, s63, v55
v_fmac_f32 v22, v26, v26
v_fmac_f32 v23, v27, v27
v_mfma_f32_16x16x32_bf16 v[32:35], v[28:31], v[72:75], v[32:35]
v_mfma_f32_16x16x32_bf16 v[36:39], v[28:31], v[52:55], v[36:39]
s_waitcnt lgkmcnt(0)
v_mfma_f32_32x32x16_bf16 v[88:103], v[56:59], v[48:51], v[88:103]
ds_read_b128 v[52:55], v9 offset:16384
ds_read_b64_tr_b16 v[72:73], v12 offset:15360
ds_read_b64_tr_b16 v[74:75], v12 offset:16128
ds_read_b64_tr_b16 v[76:77], v13 offset:15360
ds_read_b64_tr_b16 v[78:79], v13 offset:16128
v_lshlrev_b32 v24, 16, v50
v_mfma_f32_32x32x16_bf16 v[104:119], v[60:63], v[48:51], v[104:119]
ds_read_b64_tr_b16 v[80:81], v14 offset:15360
ds_read_b64_tr_b16 v[82:83], v14 offset:16128
s_add_u32 m0, s56, 1024
s_nop 0
buffer_load_dwordx4 v3, s[8:11], s53 offen lds
v_and_b32 v25, s63, v50
v_fmac_f32 v22, v24, v24
v_fmac_f32 v23, v25, v25
v_mfma_f32_32x32x16_bf16 v[120:135], v[64:67], v[48:51], v[120:135]
s_add_u32 m0, s57, 1024
s_nop 0
buffer_load_dwordx4 v5, s[12:15], s54 offen lds
v_lshlrev_b32 v26, 16, v51
v_and_b32 v27, s63, v51
v_fmac_f32 v22, v26, v26
v_fmac_f32 v23, v27, v27
v_mfma_f32_16x16x32_bf16 v[32:35], v[28:31], v[56:59], v[32:35]
v_mfma_f32_16x16x32_bf16 v[36:39], v[28:31], v[48:51], v[36:39]
s_waitcnt lgkmcnt(0)
v_mfma_f32_32x32x16_bf16 v[88:103], v[72:75], v[52:55], v[88:103]
ds_read_b128 v[48:51], v10 offset:16384
ds_read_b64_tr_b16 v[56:57], v12 offset:18432
ds_read_b64_tr_b16 v[58:59], v12 offset:19200
ds_read_b64_tr_b16 v[60:61], v13 offset:18432
ds_read_b64_tr_b16 v[62:63], v13 offset:19200
v_lshlrev_b32 v24, 16, v54
v_mfma_f32_32x32x16_bf16 v[104:119], v[76:79], v[52:55], v[104:119]
ds_read_b64_tr_b16 v[64:65], v14 offset:18432
ds_read_b64_tr_b16 v[66:67], v14 offset:19200
s_add_u32 m0, s58, 0
s_nop 0
buffer_load_dwordx4 v6, s[16:19], s55 offen lds
v_and_b32 v25, s63, v54
v_fmac_f32 v22, v24, v24
v_fmac_f32 v23, v25, v25
v_mfma_f32_32x32x16_bf16 v[120:135], v[80:83], v[52:55], v[120:135]
v_lshlrev_b32 v26, 16, v55
v_and_b32 v27, s63, v55
v_fmac_f32 v22, v26, v26
v_fmac_f32 v23, v27, v27
v_mfma_f32_16x16x32_bf16 v[32:35], v[28:31], v[72:75], v[32:35]
v_mfma_f32_16x16x32_bf16 v[36:39], v[28:31], v[52:55], v[36:39]
s_waitcnt lgkmcnt(0)
v_mfma_f32_32x32x16_bf16 v[88:103], v[56:59], v[48:51], v[88:103]
ds_read_b128 v[52:55], v11 offset:16384
ds_read_b64_tr_b16 v[72:73], v12 offset:21504
ds_read_b64_tr_b16 v[74:75], v12 offset:22272
ds_read_b64_tr_b16 v[76:77], v13 offset:21504
ds_read_b64_tr_b16 v[78:79], v13 offset:22272
v_lshlrev_b32 v24, 16, v50
v_mfma_f32_32x32x16_bf16 v[104:119], v[60:63], v[48:51], v[104:119]
ds_read_b64_tr_b16 v[80:81], v14 offset:21504
ds_read_b64_tr_b16 v[82:83], v14 offset:22272
s_add_u32 m0, s58, 1024
s_nop 0
buffer_load_dwordx4 v7, s[16:19], s55 offen lds
s_add_u32 s53, s53, 128
s_add_u32 s54, s54, 245760
s_add_u32 s55, s55, 196608
v_and_b32 v25, s63, v50
v_fmac_f32 v22, v24, v24
v_fmac_f32 v23, v25, v25
v_mfma_f32_32x32x16_bf16 v[120:135], v[64:67], v[48:51], v[120:135]
v_lshlrev_b32 v26, 16, v51
v_and_b32 v27, s63, v51
v_fmac_f32 v22, v26, v26
v_fmac_f32 v23, v27, v27
v_mfma_f32_16x16x32_bf16 v[32:35], v[28:31], v[56:59], v[32:35]
v_mfma_f32_16x16x32_bf16 v[36:39], v[28:31], v[48:51], v[36:39]
s_waitcnt lgkmcnt(0)
s_waitcnt vmcnt(6)
s_barrier
v_mfma_f32_32x32x16_bf16 v[88:103], v[72:75], v[52:55], v[88:103]
ds_read_b128 v[48:51], v8 offset:32768
ds_read_b64_tr_b16 v[56:57], v12 offset:24576
ds_read_b64_tr_b16 v[58:59], v12 offset:25344
ds_read_b64_tr_b16 v[60:61], v13 offset:24576
ds_read_b64_tr_b16 v[62:63], v13 offset:25344
v_lshlrev_b32 v24, 16, v54
v_mfma_f32_32x32x16_bf16 v[104:119], v[76:79], v[52:55], v[104:119]
ds_read_b64_tr_b16 v[64:65], v14 offset:24576
ds_read_b64_tr_b16 v[66:67], v14 offset:25344
s_add_u32 m0, s56, 16384
s_nop 0
buffer_load_dwordx4 v2, s[8:11], s53 offen lds
v_and_b32 v25, s63, v54
v_fmac_f32 v22, v24, v24
v_fmac_f32 v23, v25, v25
v_mfma_f32_32x32x16_bf16 v[120:135], v[80:83], v[52:55], v[120:135]
s_add_u32 m0, s57, 16384
s_nop 0
buffer_load_dwordx4 v4, s[12:15], s54 offen lds
v_lshlrev_b32 v26, 16, v55
v_and_b32 v27, s63, v55
v_fmac_f32 v22, v26, v26
v_fmac_f32 v23, v27, v27
v_mfma_f32_16x16x32_bf16 v[32:35], v[28:31], v[72:75], v[32:35]
v_mfma_f32_16x16x32_bf16 v[36:39], v[28:31], v[52:55], v[36:39]
s_waitcnt lgkmcnt(0)
v_mfma_f32_32x32x16_bf16 v[88:103], v[56:59], v[48:51], v[88:103]
ds_read_b128 v[52:55], v9 offset:32768
ds_read_b64_tr_b16 v[72:73], v12 offset:27648
ds_read_b64_tr_b16 v[74:75], v12 offset:28416
ds_read_b64_tr_b16 v[76:77], v13 offset:27648
ds_read_b64_tr_b16 v[78:79], v13 offset:28416
v_lshlrev_b32 v24, 16, v50
v_mfma_f32_32x32x16_bf16 v[104:119], v[60:63], v[48:51], v[104:119]
ds_read_b64_tr_b16 v[80:81], v14 offset:27648
ds_read_b64_tr_b16 v[82:83], v14 offset:28416
s_add_u32 m0, s56, 17408
s_nop 0
buffer_load_dwordx4 v3, s[8:11], s53 offen lds
v_and_b32 v25, s63, v50
v_fmac_f32 v22, v24, v24
v_fmac_f32 v23, v25, v25
v_mfma_f32_32x32x16_bf16 v[120:135], v[64:67], v[48:51], v[120:135]
s_add_u32 m0, s57, 17408
s_nop 0
buffer_load_dwordx4 v5, s[12:15], s54 offen lds
v_lshlrev_b32 v26, 16, v51
v_and_b32 v27, s63, v51
v_fmac_f32 v22, v26, v26
v_fmac_f32 v23, v27, v27
v_mfma_f32_16x16x32_bf16 v[32:35], v[28:31], v[56:59], v[32:35]
v_mfma_f32_16x16x32_bf16 v[36:39], v[28:31], v[48:51], v[36:39]
s_waitcnt lgkmcnt(0)
v_mfma_f32_32x32x16_bf16 v[88:103], v[72:75], v[52:55], v[88:103]
ds_read_b128 v[48:51], v10 offset:32768
ds_read_b64_tr_b16 v[56:57], v12 offset:30720
ds_read_b64_tr_b16 v[58:59], v12 offset:31488
ds_read_b64_tr_b16 v[60:61], v13 offset:30720
ds_read_b64_tr_b16 v[62:63], v13 offset:31488
v_lshlrev_b32 v24, 16, v54
v_mfma_f32_32x32x16_bf16 v[104:119], v[76:79], v[52:55], v[104:119]
ds_read_b64_tr_b16 v[64:65], v14 offset:30720
ds_read_b64_tr_b16 v[66:67], v14 offset:31488
s_add_u32 m0, s58, 12288
s_nop 0
buffer_load_dwordx4 v6, s[16:19], s55 offen lds
v_and_b32 v25, s63, v54
v_fmac_f32 v22, v24, v24
v_fmac_f32 v23, v25, v25
v_mfma_f32_32x32x16_bf16 v[120:135], v[80:83], v[52:55], v[120:135]
v_lshlrev_b32 v26, 16, v55
v_and_b32 v27, s63, v55
v_fmac_f32 v22, v26, v26
v_fmac_f32 v23, v27, v27
v_mfma_f32_16x16x32_bf16 v[32:35], v[28:31], v[72:75], v[32:35]
v_mfma_f32_16x16x32_bf16 v[36:39], v[28:31], v[52:55], v[36:39]
s_waitcnt lgkmcnt(0)
v_mfma_f32_32x32x16_bf16 v[88:103], v[56:59], v[48:51], v[88:103]
ds_read_b128 v[52:55], v11 offset:32768
ds_read_b64_tr_b16 v[72:73], v12 offset:33792
ds_read_b64_tr_b16 v[74:75], v12 offset:34560
ds_read_b64_tr_b16 v[76:77], v13 offset:33792
ds_read_b64_tr_b16 v[78:79], v13 offset:34560
v_lshlrev_b32 v24, 16, v50
v_mfma_f32_32x32x16_bf16 v[104:119], v[60:63], v[48:51], v[104:119]
ds_read_b64_tr_b16 v[80:81], v14 offset:33792
ds_read_b64_tr_b16 v[82:83], v14 offset:34560
s_add_u32 m0, s58, 13312
s_nop 0
buffer_load_dwordx4 v7, s[16:19], s55 offen lds
s_add_u32 s53, s53, 128
s_add_u32 s54, s54, 245760
s_add_u32 s55, s55, 196608
v_and_b32 v25, s63, v50
v_fmac_f32 v22, v24, v24
v_fmac_f32 v23, v25, v25
v_mfma_f32_32x32x16_bf16 v[120:135], v[64:67], v[48:51], v[120:135]
v_lshlrev_b32 v26, 16, v51
v_and_b32 v27, s63, v51
v_fmac_f32 v22, v26, v26
v_fmac_f32 v23, v27, v27
v_mfma_f32_16x16x32_bf16 v[32:35], v[28:31], v[56:59], v[32:35]
v_mfma_f32_16x16x32_bf16 v[36:39], v[28:31], v[48:51], v[36:39]
s_waitcnt lgkmcnt(0)
s_waitcnt vmcnt(6)
s_barrier
v_mfma_f32_32x32x16_bf16 v[88:103], v[72:75], v[52:55], v[88:103]
ds_read_b128 v[48:51], v8 offset:0
ds_read_b64_tr_b16 v[56:57], v12 offset:0
ds_read_b64_tr_b16 v[58:59], v12 offset:768
ds_read_b64_tr_b16 v[60:61], v13 offset:0
ds_read_b64_tr_b16 v[62:63], v13 offset:768
v_lshlrev_b32 v24, 16, v54
v_mfma_f32_32x32x16_bf16 v[104:119], v[76:79], v[52:55], v[104:119]
ds_read_b64_tr_b16 v[64:65], v14 offset:0
ds_read_b64_tr_b16 v[66:67], v14 offset:768
s_add_u32 m0, s56, 32768
s_nop 0
buffer_load_dwordx4 v2, s[8:11], s53 offen lds
v_and_b32 v25, s63, v54
v_fmac_f32 v22, v24, v24
v_fmac_f32 v23, v25, v25
v_mfma_f32_32x32x16_bf16 v[120:135], v[80:83], v[52:55], v[120:135]
s_add_u32 m0, s57, 32768
s_nop 0
buffer_load_dwordx4 v4, s[12:15], s54 offen lds
v_lshlrev_b32 v26, 16, v55
v_and_b32 v27, s63, v55
v_fmac_f32 v22, v26, v26
v_fmac_f32 v23, v27, v27
v_mfma_f32_16x16x32_bf16 v[32:35], v[28:31], v[72:75], v[32:35]
v_mfma_f32_16x16x32_bf16 v[36:39], v[28:31], v[52:55], v[36:39]
s_waitcnt lgkmcnt(0)
v_mfma_f32_32x32x16_bf16 v[88:103], v[56:59], v[48:51], v[88:103]
ds_read_b128 v[52:55], v9 offset:0
ds_read_b64_tr_b16 v[72:73], v12 offset:3072
ds_read_b64_tr_b16 v[74:75], v12 offset:3840
ds_read_b64_tr_b16 v[76:77], v13 offset:3072
ds_read_b64_tr_b16 v[78:79], v13 offset:3840
v_lshlrev_b32 v24, 16, v50
v_mfma_f32_32x32x16_bf16 v[104:119], v[60:63], v[48:51], v[104:119]
ds_read_b64_tr_b16 v[80:81], v14 offset:3072
ds_read_b64_tr_b16 v[82:83], v14 offset:3840
s_add_u32 m0, s56, 33792
s_nop 0
buffer_load_dwordx4 v3, s[8:11], s53 offen lds
v_and_b32 v25, s63, v50
v_fmac_f32 v22, v24, v24
v_fmac_f32 v23, v25, v25
v_mfma_f32_32x32x16_bf16 v[120:135], v[64:67], v[48:51], v[120:135]
s_add_u32 m0, s57, 33792
s_nop 0
buffer_load_dwordx4 v5, s[12:15], s54 offen lds
v_lshlrev_b32 v26, 16, v51
v_and_b32 v27, s63, v51
v_fmac_f32 v22, v26, v26
v_fmac_f32 v23, v27, v27
v_mfma_f32_16x16x32_bf16 v[32:35], v[28:31], v[56:59], v[32:35]
v_mfma_f32_16x16x32_bf16 v[36:39], v[28:31], v[48:51], v[36:39]
s_waitcnt lgkmcnt(0)
v_mfma_f32_32x32x16_bf16 v[88:103], v[72:75], v[52:55], v[88:103]
ds_read_b128 v[48:51], v10 offset:0
ds_read_b64_tr_b16 v[56:57], v12 offset:6144
ds_read_b64_tr_b16 v[58:59], v12 offset:6912
ds_read_b64_tr_b16 v[60:61], v13 offset:6144
ds_read_b64_tr_b16 v[62:63], v13 offset:6912
v_lshlrev_b32 v24, 16, v54
v_mfma_f32_32x32x16_bf16 v[104:119], v[76:79], v[52:55], v[104:119]
ds_read_b64_tr_b16 v[64:65], v14 offset:6144
ds_read_b64_tr_b16 v[66:67], v14 offset:6912
s_add_u32 m0, s58, 24576
s_nop 0
buffer_load_dwordx4 v6, s[16:19], s55 offen lds
v_and_b32 v25, s63, v54
v_fmac_f32 v22, v24, v24
v_fmac_f32 v23, v25, v25
v_mfma_f32_32x32x16_bf16 v[120:135], v[80:83], v[52:55], v[120:135]
v_lshlrev_b32 v26, 16, v55
v_and_b32 v27, s63, v55
v_fmac_f32 v22, v26, v26
v_fmac_f32 v23, v27, v27
v_mfma_f32_16x16x32_bf16 v[32:35], v[28:31], v[72:75], v[32:35]
v_mfma_f32_16x16x32_bf16 v[36:39], v[28:31], v[52:55], v[36:39]
s_waitcnt lgkmcnt(0)
v_mfma_f32_32x32x16_bf16 v[88:103], v[56:59], v[48:51], v[88:103]
ds_read_b128 v[52:55], v11 offset:0
ds_read_b64_tr_b16 v[72:73], v12 offset:9216
ds_read_b64_tr_b16 v[74:75], v12 offset:9984
ds_read_b64_tr_b16 v[76:77], v13 offset:9216
ds_read_b64_tr_b16 v[78:79], v13 offset:9984
v_lshlrev_b32 v24, 16, v50
v_mfma_f32_32x32x16_bf16 v[104:119], v[60:63], v[48:51], v[104:119]
ds_read_b64_tr_b16 v[80:81], v14 offset:9216
ds_read_b64_tr_b16 v[82:83], v14 offset:9984
s_add_u32 m0, s58, 25600
s_nop 0
buffer_load_dwordx4 v7, s[16:19], s55 offen lds
s_add_u32 s53, s53, 128
s_add_u32 s54, s54, 245760
s_add_u32 s55, s55, 196608
v_and_b32 v25, s63, v50
v_fmac_f32 v22, v24, v24
v_fmac_f32 v23, v25, v25
v_mfma_f32_32x32x16_bf16 v[120:135], v[64:67], v[48:51], v[120:135]
v_lshlrev_b32 v26, 16, v51
v_and_b32 v27, s63, v51
v_fmac_f32 v22, v26, v26
v_fmac_f32 v23, v27, v27
v_mfma_f32_16x16x32_bf16 v[32:35], v[28:31], v[56:59], v[32:35]
v_mfma_f32_16x16x32_bf16 v[36:39], v[28:31], v[48:51], v[36:39]
s_waitcnt lgkmcnt(0)
s_waitcnt vmcnt(6)
s_barrier
v_mfma_f32_32x32x16_bf16 v[88:103], v[72:75], v[52:55], v[88:103]
ds_read_b128 v[48:51], v8 offset:16384
ds_read_b64_tr_b16 v[56:57], v12 offset:12288
ds_read_b64_tr_b16 v[58:59], v12 offset:13056
ds_read_b64_tr_b16 v[60:61], v13 offset:12288
ds_read_b64_tr_b16 v[62:63], v13 offset:13056
v_lshlrev_b32 v24, 16, v54
v_mfma_f32_32x32x16_bf16 v[104:119], v[76:79], v[52:55], v[104:119]
ds_read_b64_tr_b16 v[64:65], v14 offset:12288
ds_read_b64_tr_b16 v[66:67], v14 offset:13056
s_add_u32 m0, s56, 0
s_nop 0
buffer_load_dwordx4 v2, s[8:11], s53 offen lds
v_and_b32 v25, s63, v54
v_fmac_f32 v22, v24, v24
v_fmac_f32 v23, v25, v25
v_mfma_f32_32x32x16_bf16 v[120:135], v[80:83], v[52:55], v[120:135]
s_add_u32 m0, s57, 0
s_nop 0
buffer_load_dwordx4 v4, s[12:15], s54 offen lds
v_lshlrev_b32 v26, 16, v55
v_and_b32 v27, s63, v55
v_fmac_f32 v22, v26, v26
v_fmac_f32 v23, v27, v27
v_mfma_f32_16x16x32_bf16 v[32:35], v[28:31], v[72:75], v[32:35]
v_mfma_f32_16x16x32_bf16 v[36:39], v[28:31], v[52:55], v[36:39]
s_waitcnt lgkmcnt(0)
v_mfma_f32_32x32x16_bf16 v[88:103], v[56:59], v[48:51], v[88:103]
ds_read_b128 v[52:55], v9 offset:16384
ds_read_b64_tr_b16 v[72:73], v12 offset:15360
ds_read_b64_tr_b16 v[74:75], v12 offset:16128
ds_read_b64_tr_b16 v[76:77], v13 offset:15360
ds_read_b64_tr_b16 v[78:79], v13 offset:16128
v_lshlrev_b32 v24, 16, v50
v_mfma_f32_32x32x16_bf16 v[104:119], v[60:63], v[48:51], v[104:119]
ds_read_b64_tr_b16 v[80:81], v14 offset:15360
ds_read_b64_tr_b16 v[82:83], v14 offset:16128
s_add_u32 m0, s56, 1024
s_nop 0
buffer_load_dwordx4 v3, s[8:11], s53 offen lds
v_and_b32 v25, s63, v50
v_fmac_f32 v22, v24, v24
v_fmac_f32 v23, v25, v25
v_mfma_f32_32x32x16_bf16 v[120:135], v[64:67], v[48:51], v[120:135]
s_add_u32 m0, s57, 1024
s_nop 0
buffer_load_dwordx4 v5, s[12:15], s54 offen lds
v_lshlrev_b32 v26, 16, v51
v_and_b32 v27, s63, v51
v_fmac_f32 v22, v26, v26
v_fmac_f32 v23, v27, v27
v_mfma_f32_16x16x32_bf16 v[32:35], v[28:31], v[56:59], v[32:35]
v_mfma_f32_16x16x32_bf16 v[36:39], v[28:31], v[48:51], v[36:39]
s_waitcnt lgkmcnt(0)
v_mfma_f32_32x32x16_bf16 v[88:103], v[72:75], v[52:55], v[88:103]
ds_read_b128 v[48:51], v10 offset:16384
ds_read_b64_tr_b16 v[56:57], v12 offset:18432
ds_read_b64_tr_b16 v[58:59], v12 offset:19200
ds_read_b64_tr_b16 v[60:61], v13 offset:18432
ds_read_b64_tr_b16 v[62:63], v13 offset:19200
v_lshlrev_b32 v24, 16, v54
v_mfma_f32_32x32x16_bf16 v[104:119], v[76:79], v[52:55], v[104:119]
ds_read_b64_tr_b16 v[64:65], v14 offset:18432
ds_read_b64_tr_b16 v[66:67], v14 offset:19200
s_add_u32 m0, s58, 0
s_nop 0
buffer_load_dwordx4 v6, s[16:19], s55 offen lds
v_and_b32 v25, s63, v54
v_fmac_f32 v22, v24, v24
v_fmac_f32 v23, v25, v25
v_mfma_f32_32x32x16_bf16 v[120:135], v[80:83], v[52:55], v[120:135]
v_lshlrev_b32 v26, 16, v55
v_and_b32 v27, s63, v55
v_fmac_f32 v22, v26, v26
v_fmac_f32 v23, v27, v27
v_mfma_f32_16x16x32_bf16 v[32:35], v[28:31], v[72:75], v[32:35]
v_mfma_f32_16x16x32_bf16 v[36:39], v[28:31], v[52:55], v[36:39]
s_waitcnt lgkmcnt(0)
v_mfma_f32_32x32x16_bf16 v[88:103], v[56:59], v[48:51], v[88:103]
ds_read_b128 v[52:55], v11 offset:16384
ds_read_b64_tr_b16 v[72:73], v12 offset:21504
ds_read_b64_tr_b16 v[74:75], v12 offset:22272
ds_read_b64_tr_b16 v[76:77], v13 offset:21504
ds_read_b64_tr_b16 v[78:79], v13 offset:22272
v_lshlrev_b32 v24, 16, v50
v_mfma_f32_32x32x16_bf16 v[104:119], v[60:63], v[48:51], v[104:119]
ds_read_b64_tr_b16 v[80:81], v14 offset:21504
ds_read_b64_tr_b16 v[82:83], v14 offset:22272
s_add_u32 m0, s58, 1024
s_nop 0
buffer_load_dwordx4 v7, s[16:19], s55 offen lds
s_add_u32 s53, s53, 128
s_add_u32 s54, s54, 245760
s_add_u32 s55, s55, 196608
v_and_b32 v25, s63, v50
v_fmac_f32 v22, v24, v24
v_fmac_f32 v23, v25, v25
v_mfma_f32_32x32x16_bf16 v[120:135], v[64:67], v[48:51], v[120:135]
v_lshlrev_b32 v26, 16, v51
v_and_b32 v27, s63, v51
v_fmac_f32 v22, v26, v26
v_fmac_f32 v23, v27, v27
v_mfma_f32_16x16x32_bf16 v[32:35], v[28:31], v[56:59], v[32:35]
v_mfma_f32_16x16x32_bf16 v[36:39], v[28:31], v[48:51], v[36:39]
s_waitcnt lgkmcnt(0)
s_waitcnt vmcnt(6)
s_barrier
v_mfma_f32_32x32x16_bf16 v[88:103], v[72:75], v[52:55], v[88:103]
ds_read_b128 v[48:51], v8 offset:32768
ds_read_b64_tr_b16 v[56:57], v12 offset:24576
ds_read_b64_tr_b16 v[58:59], v12 offset:25344
ds_read_b64_tr_b16 v[60:61], v13 offset:24576
ds_read_b64_tr_b16 v[62:63], v13 offset:25344
v_lshlrev_b32 v24, 16, v54
v_mfma_f32_32x32x16_bf16 v[104:119], v[76:79], v[52:55], v[104:119]
ds_read_b64_tr_b16 v[64:65], v14 offset:24576
ds_read_b64_tr_b16 v[66:67], v14 offset:25344
v_and_b32 v25, s63, v54
v_fmac_f32 v22, v24, v24
v_fmac_f32 v23, v25, v25
v_mfma_f32_32x32x16_bf16 v[120:135], v[80:83], v[52:55], v[120:135]
v_lshlrev_b32 v26, 16, v55
v_and_b32 v27, s63, v55
v_fmac_f32 v22, v26, v26
v_fmac_f32 v23, v27, v27
v_mfma_f32_16x16x32_bf16 v[32:35], v[28:31], v[72:75], v[32:35]
v_mfma_f32_16x16x32_bf16 v[36:39], v[28:31], v[52:55], v[36:39]
s_waitcnt lgkmcnt(0)
v_mfma_f32_32x32x16_bf16 v[88:103], v[56:59], v[48:51], v[88:103]
ds_read_b128 v[52:55], v9 offset:32768
ds_read_b64_tr_b16 v[72:73], v12 offset:27648
ds_read_b64_tr_b16 v[74:75], v12 offset:28416
ds_read_b64_tr_b16 v[76:77], v13 offset:27648
ds_read_b64_tr_b16 v[78:79], v13 offset:28416
v_lshlrev_b32 v24, 16, v50
v_mfma_f32_32x32x16_bf16 v[104:119], v[60:63], v[48:51], v[104:119]
ds_read_b64_tr_b16 v[80:81], v14 offset:27648
ds_read_b64_tr_b16 v[82:83], v14 offset:28416
v_and_b32 v25, s63, v50
v_fmac_f32 v22, v24, v24
v_fmac_f32 v23, v25, v25
v_mfma_f32_32x32x16_bf16 v[120:135], v[64:67], v[48:51], v[120:135]
v_lshlrev_b32 v26, 16, v51
v_and_b32 v27, s63, v51
v_fmac_f32 v22, v26, v26
v_fmac_f32 v23, v27, v27
v_mfma_f32_16x16x32_bf16 v[32:35], v[28:31], v[56:59], v[32:35]
v_mfma_f32_16x16x32_bf16 v[36:39], v[28:31], v[48:51], v[36:39]
s_waitcnt lgkmcnt(0)
v_mfma_f32_32x32x16_bf16 v[88:103], v[72:75], v[52:55], v[88:103]
ds_read_b128 v[48:51], v10 offset:32768
ds_read_b64_tr_b16 v[56:57], v12 offset:30720
ds_read_b64_tr_b16 v[58:59], v12 offset:31488
ds_read_b64_tr_b16 v[60:61], v13 offset:30720
ds_read_b64_tr_b16 v[62:63], v13 offset:31488
v_lshlrev_b32 v24, 16, v54
v_mfma_f32_32x32x16_bf16 v[104:119], v[76:79], v[52:55], v[104:119]
ds_read_b64_tr_b16 v[64:65], v14 offset:30720
ds_read_b64_tr_b16 v[66:67], v14 offset:31488
v_and_b32 v25, s63, v54
v_fmac_f32 v22, v24, v24
v_fmac_f32 v23, v25, v25
v_mfma_f32_32x32x16_bf16 v[120:135], v[80:83], v[52:55], v[120:135]
v_lshlrev_b32 v26, 16, v55
v_and_b32 v27, s63, v55
v_fmac_f32 v22, v26, v26
v_fmac_f32 v23, v27, v27
v_mfma_f32_16x16x32_bf16 v[32:35], v[28:31], v[72:75], v[32:35]
v_mfma_f32_16x16x32_bf16 v[36:39], v[28:31], v[52:55], v[36:39]
s_waitcnt lgkmcnt(0)
v_mfma_f32_32x32x16_bf16 v[88:103], v[56:59], v[48:51], v[88:103]
ds_read_b128 v[52:55], v11 offset:32768
ds_read_b64_tr_b16 v[72:73], v12 offset:33792
ds_read_b64_tr_b16 v[74:75], v12 offset:34560
ds_read_b64_tr_b16 v[76:77], v13 offset:33792
ds_read_b64_tr_b16 v[78:79], v13 offset:34560
v_lshlrev_b32 v24, 16, v50
v_mfma_f32_32x32x16_bf16 v[104:119], v[60:63], v[48:51], v[104:119]
ds_read_b64_tr_b16 v[80:81], v14 offset:33792
ds_read_b64_tr_b16 v[82:83], v14 offset:34560
v_and_b32 v25, s63, v50
v_fmac_f32 v22, v24, v24
v_fmac_f32 v23, v25, v25
v_mfma_f32_32x32x16_bf16 v[120:135], v[64:67], v[48:51], v[120:135]
v_lshlrev_b32 v26, 16, v51
v_and_b32 v27, s63, v51
v_fmac_f32 v22, v26, v26
v_fmac_f32 v23, v27, v27
v_mfma_f32_16x16x32_bf16 v[32:35], v[28:31], v[56:59], v[32:35]
v_mfma_f32_16x16x32_bf16 v[36:39], v[28:31], v[48:51], v[36:39]
s_waitcnt lgkmcnt(0)
s_waitcnt vmcnt(0)
s_barrier
v_mfma_f32_32x32x16_bf16 v[88:103], v[72:75], v[52:55], v[88:103]
ds_read_b128 v[48:51], v8 offset:0
ds_read_b64_tr_b16 v[56:57], v12 offset:0
ds_read_b64_tr_b16 v[58:59], v12 offset:768
ds_read_b64_tr_b16 v[60:61], v13 offset:0
ds_read_b64_tr_b16 v[62:63], v13 offset:768
v_lshlrev_b32 v24, 16, v54
v_mfma_f32_32x32x16_bf16 v[104:119], v[76:79], v[52:55], v[104:119]
ds_read_b64_tr_b16 v[64:65], v14 offset:0
ds_read_b64_tr_b16 v[66:67], v14 offset:768
v_and_b32 v25, s63, v54
v_fmac_f32 v22, v24, v24
v_fmac_f32 v23, v25, v25
v_mfma_f32_32x32x16_bf16 v[120:135], v[80:83], v[52:55], v[120:135]
v_lshlrev_b32 v26, 16, v55
v_and_b32 v27, s63, v55
v_fmac_f32 v22, v26, v26
v_fmac_f32 v23, v27, v27
v_mfma_f32_16x16x32_bf16 v[32:35], v[28:31], v[72:75], v[32:35]
v_mfma_f32_16x16x32_bf16 v[36:39], v[28:31], v[52:55], v[36:39]
s_waitcnt lgkmcnt(0)
v_mfma_f32_32x32x16_bf16 v[88:103], v[56:59], v[48:51], v[88:103]
ds_read_b128 v[52:55], v9 offset:0
ds_read_b64_tr_b16 v[72:73], v12 offset:3072
ds_read_b64_tr_b16 v[74:75], v12 offset:3840
ds_read_b64_tr_b16 v[76:77], v13 offset:3072
ds_read_b64_tr_b16 v[78:79], v13 offset:3840
v_lshlrev_b32 v24, 16, v50
v_mfma_f32_32x32x16_bf16 v[104:119], v[60:63], v[48:51], v[104:119]
ds_read_b64_tr_b16 v[80:81], v14 offset:3072
ds_read_b64_tr_b16 v[82:83], v14 offset:3840
v_and_b32 v25, s63, v50
v_fmac_f32 v22, v24, v24
v_fmac_f32 v23, v25, v25
v_mfma_f32_32x32x16_bf16 v[120:135], v[64:67], v[48:51], v[120:135]
v_lshlrev_b32 v26, 16, v51
v_and_b32 v27, s63, v51
v_fmac_f32 v22, v26, v26
v_fmac_f32 v23, v27, v27
v_mfma_f32_16x16x32_bf16 v[32:35], v[28:31], v[56:59], v[32:35]
v_mfma_f32_16x16x32_bf16 v[36:39], v[28:31], v[48:51], v[36:39]
s_waitcnt lgkmcnt(0)
v_mfma_f32_32x32x16_bf16 v[88:103], v[72:75], v[52:55], v[88:103]
ds_read_b128 v[48:51], v10 offset:0
ds_read_b64_tr_b16 v[56:57], v12 offset:6144
ds_read_b64_tr_b16 v[58:59], v12 offset:6912
ds_read_b64_tr_b16 v[60:61], v13 offset:6144
ds_read_b64_tr_b16 v[62:63], v13 offset:6912
v_lshlrev_b32 v24, 16, v54
v_mfma_f32_32x32x16_bf16 v[104:119], v[76:79], v[52:55], v[104:119]
ds_read_b64_tr_b16 v[64:65], v14 offset:6144
ds_read_b64_tr_b16 v[66:67], v14 offset:6912
v_and_b32 v25, s63, v54
v_fmac_f32 v22, v24, v24
v_fmac_f32 v23, v25, v25
v_mfma_f32_32x32x16_bf16 v[120:135], v[80:83], v[52:55], v[120:135]
v_lshlrev_b32 v26, 16, v55
v_and_b32 v27, s63, v55
v_fmac_f32 v22, v26, v26
v_fmac_f32 v23, v27, v27
v_mfma_f32_16x16x32_bf16 v[32:35], v[28:31], v[72:75], v[32:35]
v_mfma_f32_16x16x32_bf16 v[36:39], v[28:31], v[52:55], v[36:39]
s_waitcnt lgkmcnt(0)
v_mfma_f32_32x32x16_bf16 v[88:103], v[56:59], v[48:51], v[88:103]
ds_read_b128 v[52:55], v11 offset:0
ds_read_b64_tr_b16 v[72:73], v12 offset:9216
ds_read_b64_tr_b16 v[74:75], v12 offset:9984
ds_read_b64_tr_b16 v[76:77], v13 offset:9216
ds_read_b64_tr_b16 v[78:79], v13 offset:9984
v_lshlrev_b32 v24, 16, v50
v_mfma_f32_32x32x16_bf16 v[104:119], v[60:63], v[48:51], v[104:119]
ds_read_b64_tr_b16 v[80:81], v14 offset:9216
ds_read_b64_tr_b16 v[82:83], v14 offset:9984
v_and_b32 v25, s63, v50
v_fmac_f32 v22, v24, v24
v_fmac_f32 v23, v25, v25
v_mfma_f32_32x32x16_bf16 v[120:135], v[64:67], v[48:51], v[120:135]
v_lshlrev_b32 v26, 16, v51
v_and_b32 v27, s63, v51
v_fmac_f32 v22, v26, v26
v_fmac_f32 v23, v27, v27
v_mfma_f32_16x16x32_bf16 v[32:35], v[28:31], v[56:59], v[32:35]
v_mfma_f32_16x16x32_bf16 v[36:39], v[28:31], v[48:51], v[36:39]
s_waitcnt lgkmcnt(0)
v_mfma_f32_32x32x16_bf16 v[88:103], v[72:75], v[52:55], v[88:103]
v_lshlrev_b32 v24, 16, v54
v_mfma_f32_32x32x16_bf16 v[104:119], v[76:79], v[52:55], v[104:119]
v_and_b32 v25, s63, v54
v_fmac_f32 v22, v24, v24
v_fmac_f32 v23, v25, v25
v_mfma_f32_32x32x16_bf16 v[120:135], v[80:83], v[52:55], v[120:135]
v_lshlrev_b32 v26, 16, v55
v_and_b32 v27, s63, v55
v_fmac_f32 v22, v26, v26
v_fmac_f32 v23, v27, v27
v_mfma_f32_16x16x32_bf16 v[32:35], v[28:31], v[72:75], v[32:35]
v_mfma_f32_16x16x32_bf16 v[36:39], v[28:31], v[52:55], v[36:39]
v_lshlrev_b32 v40, 16, v16
v_and_b32 v41, s63, v16
v_lshlrev_b32 v42, 3, v1
v_add_u32 v42, 150528, v42
v_cmp_gt_u32 vcc, 48, v1
s_nop 0
s_and_saveexec_b64 s[74:75], vcc
ds_write_b64 v42, v[40:41]
s_mov_b64 exec, s[74:75]
v_add_f32 v22, v22, v23
v_mov_b32 v23, v22
v_and_b32 v40, 31, v1
v_lshlrev_b32 v40, 2, v40
v_permlane32_swap_b32 v22, v23
s_lshl_b32 s59, s47, 7
s_add_u32 s60, s59, 148480
v_add_u32 v41, s60, v40
v_add_f32 v22, v22, v23
ds_write_b32 v41, v22
s_lshl_b32 s60, s65, 7
s_add_u32 s60, s60, 150016
v_add_u32 v41, s60, v40
s_mov_b64 exec, 0xffff
ds_write2_b32 v41, v32, v33 offset0:0 offset1:16
s_add_u32 s60, s59, 147456
v_add_u32 v41, s60, v40
ds_write2_b32 v41, v36, v37 offset0:0 offset1:16
s_mov_b64 exec, -1
s_add_u32 s59, s59, 147456
v_add_u32 v41, s59, v40
s_waitcnt lgkmcnt(0)
s_barrier
ds_read_b32 v42, v41
ds_read2st64_b32 v[24:25], v41 offset0:2 offset1:4
v_lshrrev_b32 v46, 5, v1
v_lshlrev_b32 v46, 4, v46
v_add_u32 v46, 150016, v46
s_lshl_b32 s59, s65, 7
v_add_u32 v47, s59, v46
ds_read_b128 v[152:155], v47 offset:0
ds_read_b128 v[200:203], v47 offset:512
ds_read_b128 v[156:159], v47 offset:32
ds_read_b128 v[204:207], v47 offset:544
ds_read_b128 v[160:163], v47 offset:64
ds_read_b128 v[208:211], v47 offset:576
ds_read_b128 v[164:167], v47 offset:96
ds_read_b128 v[212:215], v47 offset:608
s_lshl_b32 s59, s66, 7
v_add_u32 v47, s59, v46
ds_read_b128 v[168:171], v47 offset:0
ds_read_b128 v[216:219], v47 offset:512
ds_read_b128 v[172:175], v47 offset:32
ds_read_b128 v[220:223], v47 offset:544
ds_read_b128 v[176:179], v47 offset:64
ds_read_b128 v[224:227], v47 offset:576
ds_read_b128 v[180:183], v47 offset:96
ds_read_b128 v[228:231], v47 offset:608
s_lshl_b32 s59, s67, 7
v_add_u32 v47, s59, v46
ds_read_b128 v[184:187], v47 offset:0
ds_read_b128 v[232:235], v47 offset:512
ds_read_b128 v[188:191], v47 offset:32
ds_read_b128 v[236:239], v47 offset:544
ds_read_b128 v[192:195], v47 offset:64
ds_read_b128 v[240:243], v47 offset:576
ds_read_b128 v[196:199], v47 offset:96
ds_read_b128 v[244:247], v47 offset:608
s_waitcnt lgkmcnt(15)
s_waitcnt lgkmcnt(0)
v_add_f32 v44, v24, v25
v_mul_f32 v42, 0x3acccccd, v42
v_mul_f32 v44, 0x3acccccd, v44
v_fma_f32 v44, -v42, v42, v44
v_max_f32 v44, 0, v44
v_cvt_pk_bf16_f32 v44, v44, v42
v_and_b32 v42, s63, v44
v_lshlrev_b32 v44, 16, v44
v_add_f32 v44, 0x3727c5ac, v44
v_cvt_pk_bf16_f32 v44, v44, v44
v_lshlrev_b32 v44, 16, v44
v_sqrt_f32 v44, v44
s_nop 0
v_cvt_pk_bf16_f32 v44, v44, v44
v_lshlrev_b32 v44, 16, v44
v_rcp_f32 v44, v44
s_nop 0
v_mul_f32 v42, v42, v44
v_bfe_u32 v40, v1, 4, 1
v_lshlrev_b32 v40, 10, v40
v_lshrrev_b32 v41, 5, v1
v_lshlrev_b32 v41, 4, v41
v_and_b32 v46, 15, v1
v_add_u32 v46, v46, v41
v_lshl_add_u32 v40, v46, 4, v40
s_lshl_b32 s61, s49, 2
s_add_u32 s61, s61, s47
s_lshr_b32 s62, s61, 1
s_mul_i32 s62, s62, 68
s_mul_i32 s60, s50, 3
s_add_u32 s62, s62, s60
s_lshl_b32 s62, s62, 12
s_and_b32 s61, s61, 1
s_lshl_b32 s61, s61, 11
s_add_u32 s62, s62, s61
s_add_u32 s60, s62, 7864320
v_mov_b32 v28, 0xc0135761
v_mov_b32 v30, 0xbdd2d3e8
v_pk_fma_f32 v[200:201], v[152:153], v[42:43], v[200:201] op_sel_hi:[1,0,1] neg_lo:[0,1,0] neg_hi:[0,1,0]
v_pk_fma_f32 v[202:203], v[154:155], v[42:43], v[202:203] op_sel_hi:[1,0,1] neg_lo:[0,1,0] neg_hi:[0,1,0]
v_pk_fma_f32 v[204:205], v[156:157], v[42:43], v[204:205] op_sel_hi:[1,0,1] neg_lo:[0,1,0] neg_hi:[0,1,0]
v_pk_fma_f32 v[206:207], v[158:159], v[42:43], v[206:207] op_sel_hi:[1,0,1] neg_lo:[0,1,0] neg_hi:[0,1,0]
v_pk_fma_f32 v[208:209], v[160:161], v[42:43], v[208:209] op_sel_hi:[1,0,1] neg_lo:[0,1,0] neg_hi:[0,1,0]
v_pk_fma_f32 v[210:211], v[162:163], v[42:43], v[210:211] op_sel_hi:[1,0,1] neg_lo:[0,1,0] neg_hi:[0,1,0]
v_pk_fma_f32 v[212:213], v[164:165], v[42:43], v[212:213] op_sel_hi:[1,0,1] neg_lo:[0,1,0] neg_hi:[0,1,0]
v_pk_fma_f32 v[214:215], v[166:167], v[42:43], v[214:215] op_sel_hi:[1,0,1] neg_lo:[0,1,0] neg_hi:[0,1,0]
v_pk_fma_f32 v[88:89], v[88:89], v[44:45], v[200:201] op_sel_hi:[1,0,1]
v_pk_fma_f32 v[90:91], v[90:91], v[44:45], v[202:203] op_sel_hi:[1,0,1]
v_pk_fma_f32 v[92:93], v[92:93], v[44:45], v[204:205] op_sel_hi:[1,0,1]
v_pk_fma_f32 v[94:95], v[94:95], v[44:45], v[206:207] op_sel_hi:[1,0,1]
v_pk_fma_f32 v[96:97], v[96:97], v[44:45], v[208:209] op_sel_hi:[1,0,1]
v_pk_fma_f32 v[98:99], v[98:99], v[44:45], v[210:211] op_sel_hi:[1,0,1]
v_pk_fma_f32 v[100:101], v[100:101], v[44:45], v[212:213] op_sel_hi:[1,0,1]
v_pk_fma_f32 v[102:103], v[102:103], v[44:45], v[214:215] op_sel_hi:[1,0,1]
v_pk_mul_f32 v[56:57], v[88:89], v[88:89]
v_pk_mul_f32 v[58:59], v[90:91], v[90:91]
v_pk_mul_f32 v[60:61], v[92:93], v[92:93]
v_pk_mul_f32 v[62:63], v[94:95], v[94:95]
v_pk_mul_f32 v[64:65], v[96:97], v[96:97]
v_pk_mul_f32 v[66:67], v[98:99], v[98:99]
v_pk_mul_f32 v[68:69], v[100:101], v[100:101]
v_pk_mul_f32 v[70:71], v[102:103], v[102:103]
v_pk_fma_f32 v[56:57], v[56:57], v[30:31], v[28:29] op_sel_hi:[1,0,0]
v_pk_fma_f32 v[58:59], v[58:59], v[30:31], v[28:29] op_sel_hi:[1,0,0]
v_pk_fma_f32 v[60:61], v[60:61], v[30:31], v[28:29] op_sel_hi:[1,0,0]
v_pk_fma_f32 v[62:63], v[62:63], v[30:31], v[28:29] op_sel_hi:[1,0,0]
v_pk_fma_f32 v[64:65], v[64:65], v[30:31], v[28:29] op_sel_hi:[1,0,0]
v_pk_fma_f32 v[66:67], v[66:67], v[30:31], v[28:29] op_sel_hi:[1,0,0]
v_pk_fma_f32 v[68:69], v[68:69], v[30:31], v[28:29] op_sel_hi:[1,0,0]
v_pk_fma_f32 v[70:71], v[70:71], v[30:31], v[28:29] op_sel_hi:[1,0,0]
v_pk_mul_f32 v[56:57], v[56:57], v[88:89]
v_pk_mul_f32 v[58:59], v[58:59], v[90:91]
v_pk_mul_f32 v[60:61], v[60:61], v[92:93]
v_pk_mul_f32 v[62:63], v[62:63], v[94:95]
v_pk_mul_f32 v[64:65], v[64:65], v[96:97]
v_pk_mul_f32 v[66:67], v[66:67], v[98:99]
v_pk_mul_f32 v[68:69], v[68:69], v[100:101]
v_pk_mul_f32 v[70:71], v[70:71], v[102:103]
v_exp_f32 v56, v56
v_exp_f32 v57, v57
v_exp_f32 v58, v58
v_exp_f32 v59, v59
v_exp_f32 v60, v60
v_exp_f32 v61, v61
v_exp_f32 v62, v62
v_exp_f32 v63, v63
v_exp_f32 v64, v64
v_exp_f32 v65, v65
v_exp_f32 v66, v66
v_exp_f32 v67, v67
v_exp_f32 v68, v68
v_exp_f32 v69, v69
v_exp_f32 v70, v70
v_exp_f32 v71, v71
v_pk_add_f32 v[56:57], v[56:57], 1.0 op_sel_hi:[1,0]
v_pk_add_f32 v[58:59], v[58:59], 1.0 op_sel_hi:[1,0]
v_pk_add_f32 v[60:61], v[60:61], 1.0 op_sel_hi:[1,0]
v_pk_add_f32 v[62:63], v[62:63], 1.0 op_sel_hi:[1,0]
v_pk_add_f32 v[64:65], v[64:65], 1.0 op_sel_hi:[1,0]
v_pk_add_f32 v[66:67], v[66:67], 1.0 op_sel_hi:[1,0]
v_pk_add_f32 v[68:69], v[68:69], 1.0 op_sel_hi:[1,0]
v_pk_add_f32 v[70:71], v[70:71], 1.0 op_sel_hi:[1,0]
v_rcp_f32 v56, v56
v_rcp_f32 v57, v57
v_rcp_f32 v58, v58
v_rcp_f32 v59, v59
v_rcp_f32 v60, v60
v_rcp_f32 v61, v61
v_rcp_f32 v62, v62
v_rcp_f32 v63, v63
v_rcp_f32 v64, v64
v_rcp_f32 v65, v65
v_rcp_f32 v66, v66
v_rcp_f32 v67, v67
v_rcp_f32 v68, v68
v_rcp_f32 v69, v69
v_rcp_f32 v70, v70
v_rcp_f32 v71, v71
v_pk_mul_f32 v[88:89], v[88:89], v[56:57]
v_pk_mul_f32 v[90:91], v[90:91], v[58:59]
v_pk_mul_f32 v[92:93], v[92:93], v[60:61]
v_pk_mul_f32 v[94:95], v[94:95], v[62:63]
v_pk_mul_f32 v[96:97], v[96:97], v[64:65]
v_pk_mul_f32 v[98:99], v[98:99], v[66:67]
v_pk_mul_f32 v[100:101], v[100:101], v[68:69]
v_pk_mul_f32 v[102:103], v[102:103], v[70:71]
v_cvt_pk_bf16_f32 v72, v88, v89
v_cvt_pk_bf16_f32 v73, v90, v91
v_cvt_pk_bf16_f32 v74, v92, v93
v_cvt_pk_bf16_f32 v75, v94, v95
v_cvt_pk_bf16_f32 v76, v96, v97
v_cvt_pk_bf16_f32 v77, v98, v99
v_cvt_pk_bf16_f32 v78, v100, v101
v_cvt_pk_bf16_f32 v79, v102, v103
s_lshl_b32 s59, s65, 12
s_add_u32 s59, s59, s60
buffer_store_dwordx4 v[72:75], v40, s[20:23], s59 offen sc1
buffer_store_dwordx4 v[76:79], v40, s[20:23], s59 offen offset:512 sc1
v_pk_fma_f32 v[216:217], v[168:169], v[42:43], v[216:217] op_sel_hi:[1,0,1] neg_lo:[0,1,0] neg_hi:[0,1,0]
v_pk_fma_f32 v[218:219], v[170:171], v[42:43], v[218:219] op_sel_hi:[1,0,1] neg_lo:[0,1,0] neg_hi:[0,1,0]
v_pk_fma_f32 v[220:221], v[172:173], v[42:43], v[220:221] op_sel_hi:[1,0,1] neg_lo:[0,1,0] neg_hi:[0,1,0]
v_pk_fma_f32 v[222:223], v[174:175], v[42:43], v[222:223] op_sel_hi:[1,0,1] neg_lo:[0,1,0] neg_hi:[0,1,0]
v_pk_fma_f32 v[224:225], v[176:177], v[42:43], v[224:225] op_sel_hi:[1,0,1] neg_lo:[0,1,0] neg_hi:[0,1,0]
v_pk_fma_f32 v[226:227], v[178:179], v[42:43], v[226:227] op_sel_hi:[1,0,1] neg_lo:[0,1,0] neg_hi:[0,1,0]
v_pk_fma_f32 v[228:229], v[180:181], v[42:43], v[228:229] op_sel_hi:[1,0,1] neg_lo:[0,1,0] neg_hi:[0,1,0]
v_pk_fma_f32 v[230:231], v[182:183], v[42:43], v[230:231] op_sel_hi:[1,0,1] neg_lo:[0,1,0] neg_hi:[0,1,0]
v_pk_fma_f32 v[104:105], v[104:105], v[44:45], v[216:217] op_sel_hi:[1,0,1]
v_pk_fma_f32 v[106:107], v[106:107], v[44:45], v[218:219] op_sel_hi:[1,0,1]
v_pk_fma_f32 v[108:109], v[108:109], v[44:45], v[220:221] op_sel_hi:[1,0,1]
v_pk_fma_f32 v[110:111], v[110:111], v[44:45], v[222:223] op_sel_hi:[1,0,1]
v_pk_fma_f32 v[112:113], v[112:113], v[44:45], v[224:225] op_sel_hi:[1,0,1]
v_pk_fma_f32 v[114:115], v[114:115], v[44:45], v[226:227] op_sel_hi:[1,0,1]
v_pk_fma_f32 v[116:117], v[116:117], v[44:45], v[228:229] op_sel_hi:[1,0,1]
v_pk_fma_f32 v[118:119], v[118:119], v[44:45], v[230:231] op_sel_hi:[1,0,1]
v_pk_mul_f32 v[56:57], v[104:105], v[104:105]
v_pk_mul_f32 v[58:59], v[106:107], v[106:107]
v_pk_mul_f32 v[60:61], v[108:109], v[108:109]
v_pk_mul_f32 v[62:63], v[110:111], v[110:111]
v_pk_mul_f32 v[64:65], v[112:113], v[112:113]
v_pk_mul_f32 v[66:67], v[114:115], v[114:115]
v_pk_mul_f32 v[68:69], v[116:117], v[116:117]
v_pk_mul_f32 v[70:71], v[118:119], v[118:119]
v_pk_fma_f32 v[56:57], v[56:57], v[30:31], v[28:29] op_sel_hi:[1,0,0]
v_pk_fma_f32 v[58:59], v[58:59], v[30:31], v[28:29] op_sel_hi:[1,0,0]
v_pk_fma_f32 v[60:61], v[60:61], v[30:31], v[28:29] op_sel_hi:[1,0,0]
v_pk_fma_f32 v[62:63], v[62:63], v[30:31], v[28:29] op_sel_hi:[1,0,0]
v_pk_fma_f32 v[64:65], v[64:65], v[30:31], v[28:29] op_sel_hi:[1,0,0]
v_pk_fma_f32 v[66:67], v[66:67], v[30:31], v[28:29] op_sel_hi:[1,0,0]
v_pk_fma_f32 v[68:69], v[68:69], v[30:31], v[28:29] op_sel_hi:[1,0,0]
v_pk_fma_f32 v[70:71], v[70:71], v[30:31], v[28:29] op_sel_hi:[1,0,0]
v_pk_mul_f32 v[56:57], v[56:57], v[104:105]
v_pk_mul_f32 v[58:59], v[58:59], v[106:107]
v_pk_mul_f32 v[60:61], v[60:61], v[108:109]
v_pk_mul_f32 v[62:63], v[62:63], v[110:111]
v_pk_mul_f32 v[64:65], v[64:65], v[112:113]
v_pk_mul_f32 v[66:67], v[66:67], v[114:115]
v_pk_mul_f32 v[68:69], v[68:69], v[116:117]
v_pk_mul_f32 v[70:71], v[70:71], v[118:119]
v_exp_f32 v56, v56
v_exp_f32 v57, v57
v_exp_f32 v58, v58
v_exp_f32 v59, v59
v_exp_f32 v60, v60
v_exp_f32 v61, v61
v_exp_f32 v62, v62
v_exp_f32 v63, v63
v_exp_f32 v64, v64
v_exp_f32 v65, v65
v_exp_f32 v66, v66
v_exp_f32 v67, v67
v_exp_f32 v68, v68
v_exp_f32 v69, v69
v_exp_f32 v70, v70
v_exp_f32 v71, v71
v_pk_add_f32 v[56:57], v[56:57], 1.0 op_sel_hi:[1,0]
v_pk_add_f32 v[58:59], v[58:59], 1.0 op_sel_hi:[1,0]
v_pk_add_f32 v[60:61], v[60:61], 1.0 op_sel_hi:[1,0]
v_pk_add_f32 v[62:63], v[62:63], 1.0 op_sel_hi:[1,0]
v_pk_add_f32 v[64:65], v[64:65], 1.0 op_sel_hi:[1,0]
v_pk_add_f32 v[66:67], v[66:67], 1.0 op_sel_hi:[1,0]
v_pk_add_f32 v[68:69], v[68:69], 1.0 op_sel_hi:[1,0]
v_pk_add_f32 v[70:71], v[70:71], 1.0 op_sel_hi:[1,0]
v_rcp_f32 v56, v56
v_rcp_f32 v57, v57
v_rcp_f32 v58, v58
v_rcp_f32 v59, v59
v_rcp_f32 v60, v60
v_rcp_f32 v61, v61
v_rcp_f32 v62, v62
v_rcp_f32 v63, v63
v_rcp_f32 v64, v64
v_rcp_f32 v65, v65
v_rcp_f32 v66, v66
v_rcp_f32 v67, v67
v_rcp_f32 v68, v68
v_rcp_f32 v69, v69
v_rcp_f32 v70, v70
v_rcp_f32 v71, v71
v_pk_mul_f32 v[104:105], v[104:105], v[56:57]
v_pk_mul_f32 v[106:107], v[106:107], v[58:59]
v_pk_mul_f32 v[108:109], v[108:109], v[60:61]
v_pk_mul_f32 v[110:111], v[110:111], v[62:63]
v_pk_mul_f32 v[112:113], v[112:113], v[64:65]
v_pk_mul_f32 v[114:115], v[114:115], v[66:67]
v_pk_mul_f32 v[116:117], v[116:117], v[68:69]
v_pk_mul_f32 v[118:119], v[118:119], v[70:71]
v_cvt_pk_bf16_f32 v80, v104, v105
v_cvt_pk_bf16_f32 v81, v106, v107
v_cvt_pk_bf16_f32 v82, v108, v109
v_cvt_pk_bf16_f32 v83, v110, v111
v_cvt_pk_bf16_f32 v84, v112, v113
v_cvt_pk_bf16_f32 v85, v114, v115
v_cvt_pk_bf16_f32 v86, v116, v117
v_cvt_pk_bf16_f32 v87, v118, v119
s_lshl_b32 s59, s66, 12
s_add_u32 s59, s59, s60
buffer_store_dwordx4 v[80:83], v40, s[20:23], s59 offen sc1
buffer_store_dwordx4 v[84:87], v40, s[20:23], s59 offen offset:512 sc1
v_pk_fma_f32 v[232:233], v[184:185], v[42:43], v[232:233] op_sel_hi:[1,0,1] neg_lo:[0,1,0] neg_hi:[0,1,0]
v_pk_fma_f32 v[234:235], v[186:187], v[42:43], v[234:235] op_sel_hi:[1,0,1] neg_lo:[0,1,0] neg_hi:[0,1,0]
v_pk_fma_f32 v[236:237], v[188:189], v[42:43], v[236:237] op_sel_hi:[1,0,1] neg_lo:[0,1,0] neg_hi:[0,1,0]
v_pk_fma_f32 v[238:239], v[190:191], v[42:43], v[238:239] op_sel_hi:[1,0,1] neg_lo:[0,1,0] neg_hi:[0,1,0]
v_pk_fma_f32 v[240:241], v[192:193], v[42:43], v[240:241] op_sel_hi:[1,0,1] neg_lo:[0,1,0] neg_hi:[0,1,0]
v_pk_fma_f32 v[242:243], v[194:195], v[42:43], v[242:243] op_sel_hi:[1,0,1] neg_lo:[0,1,0] neg_hi:[0,1,0]
v_pk_fma_f32 v[244:245], v[196:197], v[42:43], v[244:245] op_sel_hi:[1,0,1] neg_lo:[0,1,0] neg_hi:[0,1,0]
v_pk_fma_f32 v[246:247], v[198:199], v[42:43], v[246:247] op_sel_hi:[1,0,1] neg_lo:[0,1,0] neg_hi:[0,1,0]
v_pk_fma_f32 v[120:121], v[120:121], v[44:45], v[232:233] op_sel_hi:[1,0,1]
v_pk_fma_f32 v[122:123], v[122:123], v[44:45], v[234:235] op_sel_hi:[1,0,1]
v_pk_fma_f32 v[124:125], v[124:125], v[44:45], v[236:237] op_sel_hi:[1,0,1]
v_pk_fma_f32 v[126:127], v[126:127], v[44:45], v[238:239] op_sel_hi:[1,0,1]
v_pk_fma_f32 v[128:129], v[128:129], v[44:45], v[240:241] op_sel_hi:[1,0,1]
v_pk_fma_f32 v[130:131], v[130:131], v[44:45], v[242:243] op_sel_hi:[1,0,1]
v_pk_fma_f32 v[132:133], v[132:133], v[44:45], v[244:245] op_sel_hi:[1,0,1]
v_pk_fma_f32 v[134:135], v[134:135], v[44:45], v[246:247] op_sel_hi:[1,0,1]
v_pk_mul_f32 v[56:57], v[120:121], v[120:121]
v_pk_mul_f32 v[58:59], v[122:123], v[122:123]
v_pk_mul_f32 v[60:61], v[124:125], v[124:125]
v_pk_mul_f32 v[62:63], v[126:127], v[126:127]
v_pk_mul_f32 v[64:65], v[128:129], v[128:129]
v_pk_mul_f32 v[66:67], v[130:131], v[130:131]
v_pk_mul_f32 v[68:69], v[132:133], v[132:133]
v_pk_mul_f32 v[70:71], v[134:135], v[134:135]
v_pk_fma_f32 v[56:57], v[56:57], v[30:31], v[28:29] op_sel_hi:[1,0,0]
v_pk_fma_f32 v[58:59], v[58:59], v[30:31], v[28:29] op_sel_hi:[1,0,0]
v_pk_fma_f32 v[60:61], v[60:61], v[30:31], v[28:29] op_sel_hi:[1,0,0]
v_pk_fma_f32 v[62:63], v[62:63], v[30:31], v[28:29] op_sel_hi:[1,0,0]
v_pk_fma_f32 v[64:65], v[64:65], v[30:31], v[28:29] op_sel_hi:[1,0,0]
v_pk_fma_f32 v[66:67], v[66:67], v[30:31], v[28:29] op_sel_hi:[1,0,0]
v_pk_fma_f32 v[68:69], v[68:69], v[30:31], v[28:29] op_sel_hi:[1,0,0]
v_pk_fma_f32 v[70:71], v[70:71], v[30:31], v[28:29] op_sel_hi:[1,0,0]
v_pk_mul_f32 v[56:57], v[56:57], v[120:121]
v_pk_mul_f32 v[58:59], v[58:59], v[122:123]
v_pk_mul_f32 v[60:61], v[60:61], v[124:125]
v_pk_mul_f32 v[62:63], v[62:63], v[126:127]
v_pk_mul_f32 v[64:65], v[64:65], v[128:129]
v_pk_mul_f32 v[66:67], v[66:67], v[130:131]
v_pk_mul_f32 v[68:69], v[68:69], v[132:133]
v_pk_mul_f32 v[70:71], v[70:71], v[134:135]
v_exp_f32 v56, v56
v_exp_f32 v57, v57
v_exp_f32 v58, v58
v_exp_f32 v59, v59
v_exp_f32 v60, v60
v_exp_f32 v61, v61
v_exp_f32 v62, v62
v_exp_f32 v63, v63
v_exp_f32 v64, v64
v_exp_f32 v65, v65
v_exp_f32 v66, v66
v_exp_f32 v67, v67
v_exp_f32 v68, v68
v_exp_f32 v69, v69
v_exp_f32 v70, v70
v_exp_f32 v71, v71
v_pk_add_f32 v[56:57], v[56:57], 1.0 op_sel_hi:[1,0]
v_pk_add_f32 v[58:59], v[58:59], 1.0 op_sel_hi:[1,0]
v_pk_add_f32 v[60:61], v[60:61], 1.0 op_sel_hi:[1,0]
v_pk_add_f32 v[62:63], v[62:63], 1.0 op_sel_hi:[1,0]
v_pk_add_f32 v[64:65], v[64:65], 1.0 op_sel_hi:[1,0]
v_pk_add_f32 v[66:67], v[66:67], 1.0 op_sel_hi:[1,0]
v_pk_add_f32 v[68:69], v[68:69], 1.0 op_sel_hi:[1,0]
v_pk_add_f32 v[70:71], v[70:71], 1.0 op_sel_hi:[1,0]
v_rcp_f32 v56, v56
v_rcp_f32 v57, v57
v_rcp_f32 v58, v58
v_rcp_f32 v59, v59
v_rcp_f32 v60, v60
v_rcp_f32 v61, v61
v_rcp_f32 v62, v62
v_rcp_f32 v63, v63
v_rcp_f32 v64, v64
v_rcp_f32 v65, v65
v_rcp_f32 v66, v66
v_rcp_f32 v67, v67
v_rcp_f32 v68, v68
v_rcp_f32 v69, v69
v_rcp_f32 v70, v70
v_rcp_f32 v71, v71
v_pk_mul_f32 v[120:121], v[120:121], v[56:57]
v_pk_mul_f32 v[122:123], v[122:123], v[58:59]
v_pk_mul_f32 v[124:125], v[124:125], v[60:61]
v_pk_mul_f32 v[126:127], v[126:127], v[62:63]
v_pk_mul_f32 v[128:129], v[128:129], v[64:65]
v_pk_mul_f32 v[130:131], v[130:131], v[66:67]
v_pk_mul_f32 v[132:133], v[132:133], v[68:69]
v_pk_mul_f32 v[134:135], v[134:135], v[70:71]
v_cvt_pk_bf16_f32 v72, v120, v121
v_cvt_pk_bf16_f32 v73, v122, v123
v_cvt_pk_bf16_f32 v74, v124, v125
v_cvt_pk_bf16_f32 v75, v126, v127
v_cvt_pk_bf16_f32 v76, v128, v129
v_cvt_pk_bf16_f32 v77, v130, v131
v_cvt_pk_bf16_f32 v78, v132, v133
v_cvt_pk_bf16_f32 v79, v134, v135
s_lshl_b32 s59, s67, 12
s_add_u32 s59, s59, s60
buffer_store_dwordx4 v[72:75], v40, s[20:23], s59 offen sc1
buffer_store_dwordx4 v[76:79], v40, s[20:23], s59 offen offset:512 sc1
L_g1_fin:
L_g1_done:
s_endpgm
.text
.globl k2_kernel
.p2align 8
.type k2_kernel,@function
k2_kernel:
s_load_dwordx2 s[12:13], s[0:1], 80
s_cmp_ge_u32 s2, 256
s_cbranch_scc1 L_k2_done
s_load_dwordx2 s[14:15], s[0:1], 0
s_load_dwordx2 s[16:17], s[0:1], 56
s_load_dwordx2 s[18:19], s[0:1], 64
v_lshrrev_b32 v1, 6, v0
s_nop 0
v_readfirstlane_b32 s20, v1
v_and_b32 v1, 63, v0
s_bfe_u32 s21, s2, 0x20001
s_lshl_b32 s21, s21, 3
s_lshr_b32 s23, s2, 5
s_add_u32 s21, s21, s23
s_and_b32 s22, s2, 1
s_lshl_b32 s22, s22, 2
s_bfe_u32 s23, s2, 0x20003
s_add_u32 s22, s22, s23
s_waitcnt lgkmcnt(0)
s_mov_b32 s8, s12
s_and_b32 s9, s13, 0xffff
s_mov_b32 s10, 20611072
s_mov_b32 s11, 0x20000
s_cmp_ge_u32 s20, 4
s_cbranch_scc1 L_k2_g3
s_lshl_b32 s24, s22, 2
s_add_u32 s24, s24, s20
s_and_b32 s53, s24, 1
s_lshr_b32 s36, s24, 1
s_mul_i32 s36, s36, 5
s_add_u32 s55, s36, 2
s_mul_i32 s54, s53, 3
s_add_u32 s54, s54, s36
s_lshl_b32 s37, s21, 1
s_mul_i32 s51, s37, 40960
s_add_u32 s52, s51, 40960
s_sub_i32 s50, 8, s37
s_max_i32 s50, s50, 0
s_mov_b32 s56, 0
s_mov_b32 s57, -1
s_mov_b32 s60, -1
s_mov_b32 s61, 0
s_mov_b32 s58, 0xfffff
s_mov_b32 s59, 0xfffff
v_lshlrev_b32 v168, 4, v1
v_and_b32 v169, 31, v1
v_lshlrev_b32 v169, 4, v169
s_lshl_b32 s36, s53, 3
v_add_u32 v169, s36, v169
s_lshl_b32 s36, s54, 9
s_lshl_b32 s37, s55, 9
v_add_u32 v168, s36, v168
v_add_u32 v169, s37, v169
buffer_load_dwordx4 v[88:91], v168, s[8:11], s51 offen
buffer_load_dwordx4 v[92:95], v168, s[8:11], s52 offen
buffer_load_dwordx2 v[96:97], v169, s[8:11], s51 offen
buffer_load_dwordx2 v[98:99], v169, s[8:11], s52 offen
v_add_u32 v172, 2621440, v168
v_lshrrev_b32 v170, 5, v1
v_mul_u32_u24 v171, 40960, v170
v_add_u32 v173, 2621440, v169
v_add_u32 v173, v173, v171
s_lshl_b32 s37, s21, 1
s_sub_i32 s37, s37, 8
s_add_i32 s49, s37, 9
s_max_i32 s49, s49, 0
s_mul_i32 s49, s49, 40960
s_add_i32 s48, s37, 8
s_max_i32 s48, s48, 0
s_mul_i32 s48, s48, 40960
buffer_load_dwordx2 v[52:53], v173, s[8:11], s48 offen
buffer_load_dwordx4 v[40:43], v172, s[8:11], s49 offen
buffer_load_dwordx4 v[36:39], v172, s[8:11], s48 offen
s_add_i32 s47, s37, 7
s_max_i32 s47, s47, 0
s_mul_i32 s47, s47, 40960
s_add_i32 s46, s37, 6
s_max_i32 s46, s46, 0
s_mul_i32 s46, s46, 40960
buffer_load_dwordx2 v[50:51], v173, s[8:11], s46 offen
buffer_load_dwordx4 v[32:35], v172, s[8:11], s47 offen
buffer_load_dwordx4 v[28:31], v172, s[8:11], s46 offen
s_add_i32 s45, s37, 5
s_max_i32 s45, s45, 0
s_mul_i32 s45, s45, 40960
s_add_i32 s44, s37, 4
s_max_i32 s44, s44, 0
s_mul_i32 s44, s44, 40960
buffer_load_dwordx2 v[48:49], v173, s[8:11], s44 offen
buffer_load_dwordx4 v[24:27], v172, s[8:11], s45 offen
buffer_load_dwordx4 v[20:23], v172, s[8:11], s44 offen
s_add_i32 s43, s37, 3
s_max_i32 s43, s43, 0
s_mul_i32 s43, s43, 40960
s_add_i32 s42, s37, 2
s_max_i32 s42, s42, 0
s_mul_i32 s42, s42, 40960
buffer_load_dwordx2 v[46:47], v173, s[8:11], s42 offen
buffer_load_dwordx4 v[16:19], v172, s[8:11], s43 offen
buffer_load_dwordx4 v[12:15], v172, s[8:11], s42 offen
s_add_i32 s41, s37, 1
s_max_i32 s41, s41, 0
s_mul_i32 s41, s41, 40960
s_add_i32 s40, s37, 0
s_max_i32 s40, s40, 0
s_mul_i32 s40, s40, 40960
buffer_load_dwordx2 v[44:45], v173, s[8:11], s40 offen
buffer_load_dwordx4 v[8:11], v172, s[8:11], s41 offen
buffer_load_dwordx4 v[4:7], v172, s[8:11], s40 offen
v_and_b32 v168, 31, v1
v_add_u32 v169, 4, v168
v_add_u32 v171, -16, v168
v_cmp_gt_u32 vcc, 16, v168
s_nop 1
v_cndmask_b32_e64 v169, v171, v169, vcc
s_cmp_eq_u32 s53, 1
s_cselect_b64 s[62:63], -1, 0
v_cndmask_b32_e64 v168, v168, v169, s[62:63]
s_mul_i32 s36, s24, 320
s_add_u32 s36, s36, 5242880
v_lshlrev_b32 v168, 4, v168
v_mul_u32_u24 v170, 10240, v170
v_add_u32 v168, v168, v170
v_add_u32 v252, s36, v168
v_add_u32 v253, 20480, v252
s_mov_b32 s38, 0x3f803f80
s_mov_b32 s39, 0x3f803f80
v_pk_mov_b32 v[56:57], s[38:39], s[38:39] op_sel:[0,1]
v_pk_mov_b32 v[58:59], s[38:39], s[38:39] op_sel:[0,1]
v_pk_mov_b32 v[60:61], s[38:39], s[38:39] op_sel:[0,1]
v_pk_mov_b32 v[62:63], s[38:39], s[38:39] op_sel:[0,1]
v_pk_mov_b32 v[64:65], s[38:39], s[38:39] op_sel:[0,1]
v_pk_mov_b32 v[66:67], s[38:39], s[38:39] op_sel:[0,1]
v_pk_mov_b32 v[68:69], s[38:39], s[38:39] op_sel:[0,1]
v_pk_mov_b32 v[70:71], s[38:39], s[38:39] op_sel:[0,1]
v_pk_mov_b32 v[72:73], s[38:39], s[38:39] op_sel:[0,1]
v_pk_mov_b32 v[74:75], s[38:39], s[38:39] op_sel:[0,1]
v_pk_mov_b32 v[76:77], s[38:39], s[38:39] op_sel:[0,1]
v_pk_mov_b32 v[78:79], s[38:39], s[38:39] op_sel:[0,1]
v_pk_mov_b32 v[80:81], s[38:39], s[38:39] op_sel:[0,1]
v_pk_mov_b32 v[82:83], s[38:39], s[38:39] op_sel:[0,1]
v_pk_mov_b32 v[84:85], s[38:39], s[38:39] op_sel:[0,1]
v_pk_mov_b32 v[86:87], s[38:39], s[38:39] op_sel:[0,1]
s_mov_b64 exec, s[58:59]
buffer_load_dwordx4 v[64:67], v252, s[8:11], s49 offen
buffer_load_dwordx4 v[68:71], v253, s[8:11], s49 offen
s_mov_b64 exec, -1
s_mov_b64 exec, s[58:59]
buffer_load_dwordx4 v[56:59], v252, s[8:11], s48 offen
buffer_load_dwordx4 v[60:63], v253, s[8:11], s48 offen
s_mov_b64 exec, -1
s_mov_b64 exec, s[58:59]
buffer_load_dwordx4 v[80:83], v252, s[8:11], s47 offen
buffer_load_dwordx4 v[84:87], v253, s[8:11], s47 offen
s_mov_b64 exec, -1
s_mov_b64 exec, s[58:59]
buffer_load_dwordx4 v[72:75], v252, s[8:11], s46 offen
buffer_load_dwordx4 v[76:79], v253, s[8:11], s46 offen
s_mov_b64 exec, -1
v_and_b32 v168, 31, v1
v_lshrrev_b32 v169, 5, v1
v_lshlrev_b32 v169, 2, v169
v_sub_u32 v168, v168, v169
v_mov_b32 v169, 0xf149f2ca
v_cmp_le_i32 s[62:63], 0, v168
v_cmp_le_i32 s[64:65], 1, v168
v_cmp_le_i32 s[66:67], 2, v168
v_cmp_le_i32 s[68:69], 3, v168
v_cmp_le_i32 s[70:71], 8, v168
v_cmp_le_i32 s[72:73], 9, v168
v_cmp_le_i32 s[74:75], 10, v168
v_cmp_le_i32 s[76:77], 11, v168
v_cndmask_b32_e64 v200, v169, 0, s[62:63]
v_cndmask_b32_e64 v216, 0, v169, s[62:63]
v_cndmask_b32_e64 v201, v169, 0, s[64:65]
v_cndmask_b32_e64 v217, 0, v169, s[64:65]
v_cndmask_b32_e64 v202, v169, 0, s[66:67]
v_cndmask_b32_e64 v218, 0, v169, s[66:67]
v_cndmask_b32_e64 v203, v169, 0, s[68:69]
v_cndmask_b32_e64 v219, 0, v169, s[68:69]
v_cndmask_b32_e64 v204, v169, 0, s[70:71]
v_cndmask_b32_e64 v220, 0, v169, s[70:71]
v_cndmask_b32_e64 v205, v169, 0, s[72:73]
v_cndmask_b32_e64 v221, 0, v169, s[72:73]
v_cndmask_b32_e64 v206, v169, 0, s[74:75]
v_cndmask_b32_e64 v222, 0, v169, s[74:75]
v_cndmask_b32_e64 v207, v169, 0, s[76:77]
v_cndmask_b32_e64 v223, 0, v169, s[76:77]
v_cmp_le_i32 s[62:63], 16, v168
v_cmp_le_i32 s[64:65], 17, v168
v_cmp_le_i32 s[66:67], 18, v168
v_cmp_le_i32 s[68:69], 19, v168
v_cmp_le_i32 s[70:71], 24, v168
v_cmp_le_i32 s[72:73], 25, v168
v_cmp_le_i32 s[74:75], 26, v168
v_cmp_le_i32 s[76:77], 27, v168
v_cndmask_b32_e64 v208, v169, 0, s[62:63]
v_cndmask_b32_e64 v224, 0, v169, s[62:63]
v_cndmask_b32_e64 v209, v169, 0, s[64:65]
v_cndmask_b32_e64 v225, 0, v169, s[64:65]
v_cndmask_b32_e64 v210, v169, 0, s[66:67]
v_cndmask_b32_e64 v226, 0, v169, s[66:67]
v_cndmask_b32_e64 v211, v169, 0, s[68:69]
v_cndmask_b32_e64 v227, 0, v169, s[68:69]
v_cndmask_b32_e64 v212, v169, 0, s[70:71]
v_cndmask_b32_e64 v228, 0, v169, s[70:71]
v_cndmask_b32_e64 v213, v169, 0, s[72:73]
v_cndmask_b32_e64 v229, 0, v169, s[72:73]
v_cndmask_b32_e64 v214, v169, 0, s[74:75]
v_cndmask_b32_e64 v230, 0, v169, s[74:75]
v_cndmask_b32_e64 v215, v169, 0, s[76:77]
v_cndmask_b32_e64 v231, 0, v169, s[76:77]
s_waitcnt vmcnt(23)
v_cndmask_b32_e64 v100, 0, v96, s[56:57]
v_cndmask_b32_e64 v96, v96, 0, s[56:57]
v_cndmask_b32_e64 v101, 0, v97, s[56:57]
v_cndmask_b32_e64 v97, v97, 0, s[56:57]
v_cndmask_b32_e64 v102, 0, v98, s[56:57]
v_cndmask_b32_e64 v98, v98, 0, s[56:57]
v_cndmask_b32_e64 v103, 0, v99, s[56:57]
v_cndmask_b32_e64 v99, v99, 0, s[56:57]
v_mov_b32 v248, 0xff61b1e6
s_waitcnt vmcnt(22)
s_waitcnt vmcnt(21)
v_mfma_f32_32x32x16_bf16 v[120:135], v[40:43], v[92:95], v[200:215]
v_mfma_f32_32x32x8_bf16 v[120:135], v[52:53], v[102:103], v[120:135]
s_waitcnt vmcnt(20)
v_mfma_f32_32x32x16_bf16 v[104:119], v[36:39], v[88:91], v[200:215]
v_mfma_f32_32x32x8_bf16 v[104:119], v[52:53], v[96:97], v[104:119]
v_mfma_f32_32x32x16_bf16 v[136:151], v[36:39], v[92:95], 0
s_nop 7
v_max3_f32 v250, v120, v121, v122
v_max3_f32 v250, v250, v123, v124
v_max3_f32 v250, v250, v125, v126
v_max3_f32 v250, v250, v127, v128
v_mfma_f32_32x32x8_bf16 v[136:151], v[52:53], v[98:99], v[136:151]
v_max3_f32 v250, v250, v129, v130
v_max3_f32 v250, v250, v131, v132
v_max3_f32 v250, v250, v133, v134
v_max_f32 v250, v250, v135
s_cmp_gt_u32 s50, 7
s_cbranch_scc1 L_k2a_p1exit
s_waitcnt vmcnt(19)
s_waitcnt vmcnt(18)
v_mfma_f32_32x32x16_bf16 v[152:167], v[32:35], v[88:91], 0
v_max3_f32 v248, v104, v105, v106
v_max3_f32 v248, v248, v107, v108
v_max3_f32 v248, v248, v109, v110
v_max3_f32 v248, v248, v111, v112
v_mfma_f32_32x32x8_bf16 v[152:167], v[50:51], v[100:101], v[152:167]
v_max3_f32 v248, v248, v113, v114
v_max3_f32 v248, v248, v115, v116
v_max3_f32 v248, v248, v117, v118
v_max_f32 v248, v248, v119
v_mfma_f32_32x32x16_bf16 v[120:135], v[32:35], v[92:95], 0
v_max3_f32 v250, v250, v136, v137
v_max3_f32 v250, v250, v138, v139
v_max3_f32 v250, v250, v140, v141
v_max3_f32 v250, v250, v142, v143
v_mfma_f32_32x32x8_bf16 v[120:135], v[50:51], v[102:103], v[120:135]
v_max3_f32 v250, v250, v144, v145
v_max3_f32 v250, v250, v146, v147
v_max3_f32 v250, v250, v148, v149
v_max3_f32 v250, v250, v150, v151
s_waitcnt vmcnt(17)
v_mfma_f32_32x32x16_bf16 v[104:119], v[28:31], v[88:91], 0
v_max3_f32 v248, v248, v152, v153
v_max3_f32 v248, v248, v154, v155
v_max3_f32 v248, v248, v156, v157
v_max3_f32 v248, v248, v158, v159
v_mfma_f32_32x32x8_bf16 v[104:119], v[50:51], v[96:97], v[104:119]
v_max3_f32 v248, v248, v160, v161
v_max3_f32 v248, v248, v162, v163
v_max3_f32 v248, v248, v164, v165
v_max3_f32 v248, v248, v166, v167
v_mfma_f32_32x32x16_bf16 v[136:151], v[28:31], v[92:95], 0
v_max3_f32 v250, v250, v120, v121
v_max3_f32 v250, v250, v122, v123
v_max3_f32 v250, v250, v124, v125
v_max3_f32 v250, v250, v126, v127
v_mfma_f32_32x32x8_bf16 v[136:151], v[50:51], v[98:99], v[136:151]
v_max3_f32 v250, v250, v128, v129
v_max3_f32 v250, v250, v130, v131
v_max3_f32 v250, v250, v132, v133
v_max3_f32 v250, v250, v134, v135
s_cmp_gt_u32 s50, 5
s_cbranch_scc1 L_k2a_p1exit
s_waitcnt vmcnt(16)
s_waitcnt vmcnt(15)
v_mfma_f32_32x32x16_bf16 v[152:167], v[24:27], v[88:91], 0
v_max3_f32 v248, v248, v104, v105
v_max3_f32 v248, v248, v106, v107
v_max3_f32 v248, v248, v108, v109
v_max3_f32 v248, v248, v110, v111
v_mfma_f32_32x32x8_bf16 v[152:167], v[48:49], v[100:101], v[152:167]
v_max3_f32 v248, v248, v112, v113
v_max3_f32 v248, v248, v114, v115
v_max3_f32 v248, v248, v116, v117
v_max3_f32 v248, v248, v118, v119
v_mfma_f32_32x32x16_bf16 v[120:135], v[24:27], v[92:95], 0
v_max3_f32 v250, v250, v136, v137
v_max3_f32 v250, v250, v138, v139
v_max3_f32 v250, v250, v140, v141
v_max3_f32 v250, v250, v142, v143
v_mfma_f32_32x32x8_bf16 v[120:135], v[48:49], v[102:103], v[120:135]
v_max3_f32 v250, v250, v144, v145
v_max3_f32 v250, v250, v146, v147
v_max3_f32 v250, v250, v148, v149
v_max3_f32 v250, v250, v150, v151
s_waitcnt vmcnt(14)
v_mfma_f32_32x32x16_bf16 v[104:119], v[20:23], v[88:91], 0
v_max3_f32 v248, v248, v152, v153
v_max3_f32 v248, v248, v154, v155
v_max3_f32 v248, v248, v156, v157
v_max3_f32 v248, v248, v158, v159
v_mfma_f32_32x32x8_bf16 v[104:119], v[48:49], v[96:97], v[104:119]
v_max3_f32 v248, v248, v160, v161
v_max3_f32 v248, v248, v162, v163
v_max3_f32 v248, v248, v164, v165
v_max3_f32 v248, v248, v166, v167
v_mfma_f32_32x32x16_bf16 v[136:151], v[20:23], v[92:95], 0
v_max3_f32 v250, v250, v120, v121
v_max3_f32 v250, v250, v122, v123
v_max3_f32 v250, v250, v124, v125
v_max3_f32 v250, v250, v126, v127
v_mfma_f32_32x32x8_bf16 v[136:151], v[48:49], v[98:99], v[136:151]
v_max3_f32 v250, v250, v128, v129
v_max3_f32 v250, v250, v130, v131
v_max3_f32 v250, v250, v132, v133
v_max3_f32 v250, v250, v134, v135
s_cmp_gt_u32 s50, 3
s_cbranch_scc1 L_k2a_p1exit
s_waitcnt vmcnt(13)
s_waitcnt vmcnt(12)
v_mfma_f32_32x32x16_bf16 v[152:167], v[16:19], v[88:91], 0
v_max3_f32 v248, v248, v104, v105
v_max3_f32 v248, v248, v106, v107
v_max3_f32 v248, v248, v108, v109
v_max3_f32 v248, v248, v110, v111
v_mfma_f32_32x32x8_bf16 v[152:167], v[46:47], v[100:101], v[152:167]
v_max3_f32 v248, v248, v112, v113
v_max3_f32 v248, v248, v114, v115
v_max3_f32 v248, v248, v116, v117
v_max3_f32 v248, v248, v118, v119
v_mfma_f32_32x32x16_bf16 v[120:135], v[16:19], v[92:95], 0
v_max3_f32 v250, v250, v136, v137
v_max3_f32 v250, v250, v138, v139
v_max3_f32 v250, v250, v140, v141
v_max3_f32 v250, v250, v142, v143
v_mfma_f32_32x32x8_bf16 v[120:135], v[46:47], v[102:103], v[120:135]
v_max3_f32 v250, v250, v144, v145
v_max3_f32 v250, v250, v146, v147
v_max3_f32 v250, v250, v148, v149
v_max3_f32 v250, v250, v150, v151
s_waitcnt vmcnt(11)
v_mfma_f32_32x32x16_bf16 v[104:119], v[12:15], v[88:91], 0
v_max3_f32 v248, v248, v152, v153
v_max3_f32 v248, v248, v154, v155
v_max3_f32 v248, v248, v156, v157
v_max3_f32 v248, v248, v158, v159
v_mfma_f32_32x32x8_bf16 v[104:119], v[46:47], v[96:97], v[104:119]
v_max3_f32 v248, v248, v160, v161
v_max3_f32 v248, v248, v162, v163
v_max3_f32 v248, v248, v164, v165
v_max3_f32 v248, v248, v166, v167
v_mfma_f32_32x32x16_bf16 v[136:151], v[12:15], v[92:95], 0
v_max3_f32 v250, v250, v120, v121
v_max3_f32 v250, v250, v122, v123
v_max3_f32 v250, v250, v124, v125
v_max3_f32 v250, v250, v126, v127
v_mfma_f32_32x32x8_bf16 v[136:151], v[46:47], v[98:99], v[136:151]
v_max3_f32 v250, v250, v128, v129
v_max3_f32 v250, v250, v130, v131
v_max3_f32 v250, v250, v132, v133
v_max3_f32 v250, v250, v134, v135
s_cmp_gt_u32 s50, 1
s_cbranch_scc1 L_k2a_p1exit
s_waitcnt vmcnt(10)
s_waitcnt vmcnt(9)
v_mfma_f32_32x32x16_bf16 v[152:167], v[8:11], v[88:91], 0
v_max3_f32 v248, v248, v104, v105
v_max3_f32 v248, v248, v106, v107
v_max3_f32 v248, v248, v108, v109
v_max3_f32 v248, v248, v110, v111
v_mfma_f32_32x32x8_bf16 v[152:167], v[44:45], v[100:101], v[152:167]
v_max3_f32 v248, v248, v112, v113
v_max3_f32 v248, v248, v114, v115
v_max3_f32 v248, v248, v116, v117
v_max3_f32 v248, v248, v118, v119
v_mfma_f32_32x32x16_bf16 v[120:135], v[8:11], v[92:95], v[216:231]
v_max3_f32 v250, v250, v136, v137
v_max3_f32 v250, v250, v138, v139
v_max3_f32 v250, v250, v140, v141
v_max3_f32 v250, v250, v142, v143
v_mfma_f32_32x32x8_bf16 v[120:135], v[44:45], v[102:103], v[120:135]
v_max3_f32 v250, v250, v144, v145
v_max3_f32 v250, v250, v146, v147
v_max3_f32 v250, v250, v148, v149
v_max3_f32 v250, v250, v150, v151
s_waitcnt vmcnt(8)
v_mfma_f32_32x32x16_bf16 v[104:119], v[4:7], v[88:91], v[216:231]
v_max3_f32 v248, v248, v152, v153
v_max3_f32 v248, v248, v154, v155
v_max3_f32 v248, v248, v156, v157
v_max3_f32 v248, v248, v158, v159
v_mfma_f32_32x32x8_bf16 v[104:119], v[44:45], v[96:97], v[104:119]
v_max3_f32 v248, v248, v160, v161
v_max3_f32 v248, v248, v162, v163
v_max3_f32 v248, v248, v164, v165
v_max3_f32 v248, v248, v166, v167
v_max3_f32 v250, v250, v120, v121
v_max3_f32 v250, v250, v122, v123
v_max3_f32 v250, v250, v124, v125
v_max3_f32 v250, v250, v126, v127
v_max3_f32 v250, v250, v128, v129
v_max3_f32 v250, v250, v130, v131
v_max3_f32 v250, v250, v132, v133
v_max3_f32 v250, v250, v134, v135
v_max3_f32 v248, v248, v104, v105
v_max3_f32 v248, v248, v106, v107
v_max3_f32 v248, v248, v108, v109
v_max3_f32 v248, v248, v110, v111
v_max3_f32 v248, v248, v112, v113
v_max3_f32 v248, v248, v114, v115
v_max3_f32 v248, v248, v116, v117
v_max3_f32 v248, v248, v118, v119
s_branch L_k2a_p1done
L_k2a_p1exit:
v_max3_f32 v248, v248, v104, v105
v_max3_f32 v248, v248, v106, v107
v_max3_f32 v248, v248, v108, v109
v_max3_f32 v248, v248, v110, v111
v_max3_f32 v248, v248, v112, v113
v_max3_f32 v248, v248, v114, v115
v_max3_f32 v248, v248, v116, v117
v_max3_f32 v248, v248, v118, v119
v_max3_f32 v250, v250, v136, v137
v_max3_f32 v250, v250, v138, v139
v_max3_f32 v250, v250, v140, v141
v_max3_f32 v250, v250, v142, v143
v_max3_f32 v250, v250, v144, v145
v_max3_f32 v250, v250, v146, v147
v_max3_f32 v250, v250, v148, v149
v_max3_f32 v250, v250, v150, v151
L_k2a_p1done:
v_mov_b32 v249, v248
v_mov_b32 v251, v250
s_nop 0
v_permlane32_swap_b32 v248, v249
v_permlane32_swap_b32 v250, v251
v_max_f32 v248, v248, v249
v_max_f32 v250, v250, v251
v_pk_add_f32 v[184:185], v[250:251], 0 op_sel_hi:[0,0] neg_lo:[1,0] neg_hi:[1,0]
v_pk_add_f32 v[186:187], v[250:251], 0 op_sel_hi:[0,0] neg_lo:[1,0] neg_hi:[1,0]
v_pk_add_f32 v[188:189], v[250:251], 0 op_sel_hi:[0,0] neg_lo:[1,0] neg_hi:[1,0]
v_pk_add_f32 v[190:191], v[250:251], 0 op_sel_hi:[0,0] neg_lo:[1,0] neg_hi:[1,0]
v_pk_add_f32 v[192:193], v[250:251], 0 op_sel_hi:[0,0] neg_lo:[1,0] neg_hi:[1,0]
v_pk_add_f32 v[194:195], v[250:251], 0 op_sel_hi:[0,0] neg_lo:[1,0] neg_hi:[1,0]
v_pk_add_f32 v[196:197], v[250:251], 0 op_sel_hi:[0,0] neg_lo:[1,0] neg_hi:[1,0]
v_pk_add_f32 v[198:199], v[250:251], 0 op_sel_hi:[0,0] neg_lo:[1,0] neg_hi:[1,0]
v_pk_add_f32 v[168:169], v[248:249], 0 op_sel_hi:[0,0] neg_lo:[1,0] neg_hi:[1,0]
v_pk_add_f32 v[170:171], v[248:249], 0 op_sel_hi:[0,0] neg_lo:[1,0] neg_hi:[1,0]
v_pk_add_f32 v[172:173], v[248:249], 0 op_sel_hi:[0,0] neg_lo:[1,0] neg_hi:[1,0]
v_pk_add_f32 v[174:175], v[248:249], 0 op_sel_hi:[0,0] neg_lo:[1,0] neg_hi:[1,0]
v_pk_add_f32 v[176:177], v[248:249], 0 op_sel_hi:[0,0] neg_lo:[1,0] neg_hi:[1,0]
v_pk_add_f32 v[178:179], v[248:249], 0 op_sel_hi:[0,0] neg_lo:[1,0] neg_hi:[1,0]
v_pk_add_f32 v[180:181], v[248:249], 0 op_sel_hi:[0,0] neg_lo:[1,0] neg_hi:[1,0]
v_pk_add_f32 v[182:183], v[248:249], 0 op_sel_hi:[0,0] neg_lo:[1,0] neg_hi:[1,0]
v_pk_add_f32 v[120:121], v[200:201], v[184:185]
v_pk_add_f32 v[122:123], v[202:203], v[186:187]
v_pk_add_f32 v[124:125], v[204:205], v[188:189]
v_pk_add_f32 v[126:127], v[206:207], v[190:191]
v_pk_add_f32 v[128:129], v[208:209], v[192:193]
v_pk_add_f32 v[130:131], v[210:211], v[194:195]
v_pk_add_f32 v[132:133], v[212:213], v[196:197]
v_pk_add_f32 v[134:135], v[214:215], v[198:199]
s_nop 1
v_mfma_f32_32x32x16_bf16 v[120:135], v[40:43], v[92:95], v[120:135]
v_mfma_f32_32x32x8_bf16 v[120:135], v[52:53], v[102:103], v[120:135]
v_pk_add_f32 v[104:105], v[200:201], v[168:169]
v_pk_add_f32 v[106:107], v[202:203], v[170:171]
v_pk_add_f32 v[108:109], v[204:205], v[172:173]
v_pk_add_f32 v[110:111], v[206:207], v[174:175]
v_pk_add_f32 v[112:113], v[208:209], v[176:177]
v_pk_add_f32 v[114:115], v[210:211], v[178:179]
v_pk_add_f32 v[116:117], v[212:213], v[180:181]
v_pk_add_f32 v[118:119], v[214:215], v[182:183]
s_nop 1
v_mfma_f32_32x32x16_bf16 v[104:119], v[36:39], v[88:91], v[104:119]
s_nop 0
v_exp_f32 v120, v120
v_exp_f32 v121, v121
v_exp_f32 v122, v122
v_exp_f32 v123, v123
v_mfma_f32_32x32x8_bf16 v[104:119], v[52:53], v[96:97], v[104:119]
v_exp_f32 v124, v124
v_exp_f32 v125, v125
v_exp_f32 v126, v126
v_exp_f32 v127, v127
v_exp_f32 v128, v128
v_exp_f32 v129, v129
v_exp_f32 v130, v130
v_exp_f32 v131, v131
v_exp_f32 v132, v132
v_exp_f32 v133, v133
v_exp_f32 v134, v134
v_exp_f32 v135, v135
v_cvt_pk_bf16_f32 v240, v120, v121
v_cvt_pk_bf16_f32 v241, v122, v123
v_cvt_pk_bf16_f32 v242, v124, v125
v_cvt_pk_bf16_f32 v243, v126, v127
v_cvt_pk_bf16_f32 v244, v128, v129
v_cvt_pk_bf16_f32 v245, v130, v131
v_cvt_pk_bf16_f32 v246, v132, v133
v_cvt_pk_bf16_f32 v247, v134, v135
v_mfma_f32_32x32x16_bf16 v[120:135], v[36:39], v[92:95], v[184:199]
v_exp_f32 v104, v104
v_exp_f32 v105, v105
v_exp_f32 v106, v106
v_exp_f32 v107, v107
v_mfma_f32_32x32x8_bf16 v[120:135], v[52:53], v[98:99], v[120:135]
v_exp_f32 v108, v108
v_exp_f32 v109, v109
v_exp_f32 v110, v110
v_exp_f32 v111, v111
s_waitcnt vmcnt(6)
v_mfma_f32_32x32x16_bf16 v[152:167], v[64:67], v[240:243], 0
v_exp_f32 v112, v112
v_exp_f32 v113, v113
v_exp_f32 v114, v114
v_exp_f32 v115, v115
v_mfma_f32_32x32x16_bf16 v[152:167], v[68:71], v[244:247], v[152:167]
s_mov_b64 exec, s[58:59]
buffer_load_dwordx4 v[64:67], v252, s[8:11], s45 offen
buffer_load_dwordx4 v[68:71], v253, s[8:11], s45 offen
s_mov_b64 exec, -1
v_exp_f32 v116, v116
v_exp_f32 v117, v117
v_exp_f32 v118, v118
v_exp_f32 v119, v119
v_cvt_pk_bf16_f32 v232, v104, v105
v_cvt_pk_bf16_f32 v233, v106, v107
v_cvt_pk_bf16_f32 v234, v108, v109
v_cvt_pk_bf16_f32 v235, v110, v111
v_cvt_pk_bf16_f32 v236, v112, v113
v_cvt_pk_bf16_f32 v237, v114, v115
v_cvt_pk_bf16_f32 v238, v116, v117
v_cvt_pk_bf16_f32 v239, v118, v119
s_cmp_gt_u32 s50, 7
s_cbranch_scc1 L_k2a_p2exit7
v_mfma_f32_32x32x16_bf16 v[104:119], v[32:35], v[88:91], v[168:183]
v_exp_f32 v120, v120
v_exp_f32 v121, v121
v_exp_f32 v122, v122
v_exp_f32 v123, v123
v_mfma_f32_32x32x8_bf16 v[104:119], v[50:51], v[100:101], v[104:119]
v_exp_f32 v124, v124
v_exp_f32 v125, v125
v_exp_f32 v126, v126
v_exp_f32 v127, v127
s_waitcnt vmcnt(6)
v_mfma_f32_32x32x16_bf16 v[136:151], v[56:59], v[232:235], 0
v_exp_f32 v128, v128
v_exp_f32 v129, v129
v_exp_f32 v130, v130
v_exp_f32 v131, v131
v_mfma_f32_32x32x16_bf16 v[136:151], v[60:63], v[236:239], v[136:151]
v_exp_f32 v132, v132
v_exp_f32 v133, v133
v_exp_f32 v134, v134
v_exp_f32 v135, v135
v_cvt_pk_bf16_f32 v240, v120, v121
v_cvt_pk_bf16_f32 v241, v122, v123
v_cvt_pk_bf16_f32 v242, v124, v125
v_cvt_pk_bf16_f32 v243, v126, v127
v_cvt_pk_bf16_f32 v244, v128, v129
v_cvt_pk_bf16_f32 v245, v130, v131
v_cvt_pk_bf16_f32 v246, v132, v133
v_cvt_pk_bf16_f32 v247, v134, v135
v_mfma_f32_32x32x16_bf16 v[120:135], v[32:35], v[92:95], v[184:199]
v_exp_f32 v104, v104
v_exp_f32 v105, v105
v_exp_f32 v106, v106
v_exp_f32 v107, v107
v_mfma_f32_32x32x8_bf16 v[120:135], v[50:51], v[102:103], v[120:135]
v_exp_f32 v108, v108
v_exp_f32 v109, v109
v_exp_f32 v110, v110
v_exp_f32 v111, v111
v_mfma_f32_32x32x16_bf16 v[152:167], v[56:59], v[240:243], v[152:167]
v_exp_f32 v112, v112
v_exp_f32 v113, v113
v_exp_f32 v114, v114
v_exp_f32 v115, v115
v_mfma_f32_32x32x16_bf16 v[152:167], v[60:63], v[244:247], v[152:167]
s_mov_b64 exec, s[58:59]
buffer_load_dwordx4 v[56:59], v252, s[8:11], s44 offen
buffer_load_dwordx4 v[60:63], v253, s[8:11], s44 offen
s_mov_b64 exec, -1
v_exp_f32 v116, v116
v_exp_f32 v117, v117
v_exp_f32 v118, v118
v_exp_f32 v119, v119
v_cvt_pk_bf16_f32 v232, v104, v105
v_cvt_pk_bf16_f32 v233, v106, v107
v_cvt_pk_bf16_f32 v234, v108, v109
v_cvt_pk_bf16_f32 v235, v110, v111
v_cvt_pk_bf16_f32 v236, v112, v113
v_cvt_pk_bf16_f32 v237, v114, v115
v_cvt_pk_bf16_f32 v238, v116, v117
v_cvt_pk_bf16_f32 v239, v118, v119
v_mfma_f32_32x32x16_bf16 v[104:119], v[28:31], v[88:91], v[168:183]
v_exp_f32 v120, v120
v_exp_f32 v121, v121
v_exp_f32 v122, v122
v_exp_f32 v123, v123
v_mfma_f32_32x32x8_bf16 v[104:119], v[50:51], v[96:97], v[104:119]
v_exp_f32 v124, v124
v_exp_f32 v125, v125
v_exp_f32 v126, v126
v_exp_f32 v127, v127
s_waitcnt vmcnt(6)
v_mfma_f32_32x32x16_bf16 v[136:151], v[80:83], v[232:235], v[136:151]
v_exp_f32 v128, v128
v_exp_f32 v129, v129
v_exp_f32 v130, v130
v_exp_f32 v131, v131
v_mfma_f32_32x32x16_bf16 v[136:151], v[84:87], v[236:239], v[136:151]
v_exp_f32 v132, v132
v_exp_f32 v133, v133
v_exp_f32 v134, v134
v_exp_f32 v135, v135
v_cvt_pk_bf16_f32 v240, v120, v121
v_cvt_pk_bf16_f32 v241, v122, v123
v_cvt_pk_bf16_f32 v242, v124, v125
v_cvt_pk_bf16_f32 v243, v126, v127
v_cvt_pk_bf16_f32 v244, v128, v129
v_cvt_pk_bf16_f32 v245, v130, v131
v_cvt_pk_bf16_f32 v246, v132, v133
v_cvt_pk_bf16_f32 v247, v134, v135
v_mfma_f32_32x32x16_bf16 v[120:135], v[28:31], v[92:95], v[184:199]
v_exp_f32 v104, v104
v_exp_f32 v105, v105
v_exp_f32 v106, v106
v_exp_f32 v107, v107
v_mfma_f32_32x32x8_bf16 v[120:135], v[50:51], v[98:99], v[120:135]
v_exp_f32 v108, v108
v_exp_f32 v109, v109
v_exp_f32 v110, v110
v_exp_f32 v111, v111
v_mfma_f32_32x32x16_bf16 v[152:167], v[80:83], v[240:243], v[152:167]
v_exp_f32 v112, v112
v_exp_f32 v113, v113
v_exp_f32 v114, v114
v_exp_f32 v115, v115
v_mfma_f32_32x32x16_bf16 v[152:167], v[84:87], v[244:247], v[152:167]
s_mov_b64 exec, s[58:59]
buffer_load_dwordx4 v[80:83], v252, s[8:11], s43 offen
buffer_load_dwordx4 v[84:87], v253, s[8:11], s43 offen
s_mov_b64 exec, -1
v_exp_f32 v116, v116
v_exp_f32 v117, v117
v_exp_f32 v118, v118
v_exp_f32 v119, v119
v_cvt_pk_bf16_f32 v232, v104, v105
v_cvt_pk_bf16_f32 v233, v106, v107
v_cvt_pk_bf16_f32 v234, v108, v109
v_cvt_pk_bf16_f32 v235, v110, v111
v_cvt_pk_bf16_f32 v236, v112, v113
v_cvt_pk_bf16_f32 v237, v114, v115
v_cvt_pk_bf16_f32 v238, v116, v117
v_cvt_pk_bf16_f32 v239, v118, v119
s_cmp_gt_u32 s50, 5
s_cbranch_scc1 L_k2a_p2exit5
v_mfma_f32_32x32x16_bf16 v[104:119], v[24:27], v[88:91], v[168:183]
v_exp_f32 v120, v120
v_exp_f32 v121, v121
v_exp_f32 v122, v122
v_exp_f32 v123, v123
v_mfma_f32_32x32x8_bf16 v[104:119], v[48:49], v[100:101], v[104:119]
v_exp_f32 v124, v124
v_exp_f32 v125, v125
v_exp_f32 v126, v126
v_exp_f32 v127, v127
s_waitcnt vmcnt(6)
v_mfma_f32_32x32x16_bf16 v[136:151], v[72:75], v[232:235], v[136:151]
v_exp_f32 v128, v128
v_exp_f32 v129, v129
v_exp_f32 v130, v130
v_exp_f32 v131, v131
v_mfma_f32_32x32x16_bf16 v[136:151], v[76:79], v[236:239], v[136:151]
v_exp_f32 v132, v132
v_exp_f32 v133, v133
v_exp_f32 v134, v134
v_exp_f32 v135, v135
v_cvt_pk_bf16_f32 v240, v120, v121
v_cvt_pk_bf16_f32 v241, v122, v123
v_cvt_pk_bf16_f32 v242, v124, v125
v_cvt_pk_bf16_f32 v243, v126, v127
v_cvt_pk_bf16_f32 v244, v128, v129
v_cvt_pk_bf16_f32 v245, v130, v131
v_cvt_pk_bf16_f32 v246, v132, v133
v_cvt_pk_bf16_f32 v247, v134, v135
v_mfma_f32_32x32x16_bf16 v[120:135], v[24:27], v[92:95], v[184:199]
v_exp_f32 v104, v104
v_exp_f32 v105, v105
v_exp_f32 v106, v106
v_exp_f32 v107, v107
v_mfma_f32_32x32x8_bf16 v[120:135], v[48:49], v[102:103], v[120:135]
v_exp_f32 v108, v108
v_exp_f32 v109, v109
v_exp_f32 v110, v110
v_exp_f32 v111, v111
v_mfma_f32_32x32x16_bf16 v[152:167], v[72:75], v[240:243], v[152:167]
v_exp_f32 v112, v112
v_exp_f32 v113, v113
v_exp_f32 v114, v114
v_exp_f32 v115, v115
v_mfma_f32_32x32x16_bf16 v[152:167], v[76:79], v[244:247], v[152:167]
s_mov_b64 exec, s[58:59]
buffer_load_dwordx4 v[72:75], v252, s[8:11], s42 offen
buffer_load_dwordx4 v[76:79], v253, s[8:11], s42 offen
s_mov_b64 exec, -1
v_exp_f32 v116, v116
v_exp_f32 v117, v117
v_exp_f32 v118, v118
v_exp_f32 v119, v119
v_cvt_pk_bf16_f32 v232, v104, v105
v_cvt_pk_bf16_f32 v233, v106, v107
v_cvt_pk_bf16_f32 v234, v108, v109
v_cvt_pk_bf16_f32 v235, v110, v111
v_cvt_pk_bf16_f32 v236, v112, v113
v_cvt_pk_bf16_f32 v237, v114, v115
v_cvt_pk_bf16_f32 v238, v116, v117
v_cvt_pk_bf16_f32 v239, v118, v119
v_mfma_f32_32x32x16_bf16 v[104:119], v[20:23], v[88:91], v[168:183]
v_exp_f32 v120, v120
v_exp_f32 v121, v121
v_exp_f32 v122, v122
v_exp_f32 v123, v123
v_mfma_f32_32x32x8_bf16 v[104:119], v[48:49], v[96:97], v[104:119]
v_exp_f32 v124, v124
v_exp_f32 v125, v125
v_exp_f32 v126, v126
v_exp_f32 v127, v127
s_waitcnt vmcnt(6)
v_mfma_f32_32x32x16_bf16 v[136:151], v[64:67], v[232:235], v[136:151]
v_exp_f32 v128, v128
v_exp_f32 v129, v129
v_exp_f32 v130, v130
v_exp_f32 v131, v131
v_mfma_f32_32x32x16_bf16 v[136:151], v[68:71], v[236:239], v[136:151]
v_exp_f32 v132, v132
v_exp_f32 v133, v133
v_exp_f32 v134, v134
v_exp_f32 v135, v135
v_cvt_pk_bf16_f32 v240, v120, v121
v_cvt_pk_bf16_f32 v241, v122, v123
v_cvt_pk_bf16_f32 v242, v124, v125
v_cvt_pk_bf16_f32 v243, v126, v127
v_cvt_pk_bf16_f32 v244, v128, v129
v_cvt_pk_bf16_f32 v245, v130, v131
v_cvt_pk_bf16_f32 v246, v132, v133
v_cvt_pk_bf16_f32 v247, v134, v135
v_mfma_f32_32x32x16_bf16 v[120:135], v[20:23], v[92:95], v[184:199]
v_exp_f32 v104, v104
v_exp_f32 v105, v105
v_exp_f32 v106, v106
v_exp_f32 v107, v107
v_mfma_f32_32x32x8_bf16 v[120:135], v[48:49], v[98:99], v[120:135]
v_exp_f32 v108, v108
v_exp_f32 v109, v109
v_exp_f32 v110, v110
v_exp_f32 v111, v111
v_mfma_f32_32x32x16_bf16 v[152:167], v[64:67], v[240:243], v[152:167]
v_exp_f32 v112, v112
v_exp_f32 v113, v113
v_exp_f32 v114, v114
v_exp_f32 v115, v115
v_mfma_f32_32x32x16_bf16 v[152:167], v[68:71], v[244:247], v[152:167]
s_mov_b64 exec, s[58:59]
buffer_load_dwordx4 v[64:67], v252, s[8:11], s41 offen
buffer_load_dwordx4 v[68:71], v253, s[8:11], s41 offen
s_mov_b64 exec, -1
v_exp_f32 v116, v116
v_exp_f32 v117, v117
v_exp_f32 v118, v118
v_exp_f32 v119, v119
v_cvt_pk_bf16_f32 v232, v104, v105
v_cvt_pk_bf16_f32 v233, v106, v107
v_cvt_pk_bf16_f32 v234, v108, v109
v_cvt_pk_bf16_f32 v235, v110, v111
v_cvt_pk_bf16_f32 v236, v112, v113
v_cvt_pk_bf16_f32 v237, v114, v115
v_cvt_pk_bf16_f32 v238, v116, v117
v_cvt_pk_bf16_f32 v239, v118, v119
s_cmp_gt_u32 s50, 3
s_cbranch_scc1 L_k2a_p2exit3
v_mfma_f32_32x32x16_bf16 v[104:119], v[16:19], v[88:91], v[168:183]
v_exp_f32 v120, v120
v_exp_f32 v121, v121
v_exp_f32 v122, v122
v_exp_f32 v123, v123
v_mfma_f32_32x32x8_bf16 v[104:119], v[46:47], v[100:101], v[104:119]
v_exp_f32 v124, v124
v_exp_f32 v125, v125
v_exp_f32 v126, v126
v_exp_f32 v127, v127
s_waitcnt vmcnt(6)
v_mfma_f32_32x32x16_bf16 v[136:151], v[56:59], v[232:235], v[136:151]
v_exp_f32 v128, v128
v_exp_f32 v129, v129
v_exp_f32 v130, v130
v_exp_f32 v131, v131
v_mfma_f32_32x32x16_bf16 v[136:151], v[60:63], v[236:239], v[136:151]
v_exp_f32 v132, v132
v_exp_f32 v133, v133
v_exp_f32 v134, v134
v_exp_f32 v135, v135
v_cvt_pk_bf16_f32 v240, v120, v121
v_cvt_pk_bf16_f32 v241, v122, v123
v_cvt_pk_bf16_f32 v242, v124, v125
v_cvt_pk_bf16_f32 v243, v126, v127
v_cvt_pk_bf16_f32 v244, v128, v129
v_cvt_pk_bf16_f32 v245, v130, v131
v_cvt_pk_bf16_f32 v246, v132, v133
v_cvt_pk_bf16_f32 v247, v134, v135
v_mfma_f32_32x32x16_bf16 v[120:135], v[16:19], v[92:95], v[184:199]
v_exp_f32 v104, v104
v_exp_f32 v105, v105
v_exp_f32 v106, v106
v_exp_f32 v107, v107
v_mfma_f32_32x32x8_bf16 v[120:135], v[46:47], v[102:103], v[120:135]
v_exp_f32 v108, v108
v_exp_f32 v109, v109
v_exp_f32 v110, v110
v_exp_f32 v111, v111
v_mfma_f32_32x32x16_bf16 v[152:167], v[56:59], v[240:243], v[152:167]
v_exp_f32 v112, v112
v_exp_f32 v113, v113
v_exp_f32 v114, v114
v_exp_f32 v115, v115
v_mfma_f32_32x32x16_bf16 v[152:167], v[60:63], v[244:247], v[152:167]
s_mov_b64 exec, s[58:59]
buffer_load_dwordx4 v[56:59], v252, s[8:11], s40 offen
buffer_load_dwordx4 v[60:63], v253, s[8:11], s40 offen
s_mov_b64 exec, -1
v_exp_f32 v116, v116
v_exp_f32 v117, v117
v_exp_f32 v118, v118
v_exp_f32 v119, v119
v_cvt_pk_bf16_f32 v232, v104, v105
v_cvt_pk_bf16_f32 v233, v106, v107
v_cvt_pk_bf16_f32 v234, v108, v109
v_cvt_pk_bf16_f32 v235, v110, v111
v_cvt_pk_bf16_f32 v236, v112, v113
v_cvt_pk_bf16_f32 v237, v114, v115
v_cvt_pk_bf16_f32 v238, v116, v117
v_cvt_pk_bf16_f32 v239, v118, v119
v_mfma_f32_32x32x16_bf16 v[104:119], v[12:15], v[88:91], v[168:183]
v_exp_f32 v120, v120
v_exp_f32 v121, v121
v_exp_f32 v122, v122
v_exp_f32 v123, v123
v_mfma_f32_32x32x8_bf16 v[104:119], v[46:47], v[96:97], v[104:119]
v_exp_f32 v124, v124
v_exp_f32 v125, v125
v_exp_f32 v126, v126
v_exp_f32 v127, v127
s_waitcnt vmcnt(6)
v_mfma_f32_32x32x16_bf16 v[136:151], v[80:83], v[232:235], v[136:151]
v_exp_f32 v128, v128
v_exp_f32 v129, v129
v_exp_f32 v130, v130
v_exp_f32 v131, v131
v_mfma_f32_32x32x16_bf16 v[136:151], v[84:87], v[236:239], v[136:151]
v_exp_f32 v132, v132
v_exp_f32 v133, v133
v_exp_f32 v134, v134
v_exp_f32 v135, v135
v_cvt_pk_bf16_f32 v240, v120, v121
v_cvt_pk_bf16_f32 v241, v122, v123
v_cvt_pk_bf16_f32 v242, v124, v125
v_cvt_pk_bf16_f32 v243, v126, v127
v_cvt_pk_bf16_f32 v244, v128, v129
v_cvt_pk_bf16_f32 v245, v130, v131
v_cvt_pk_bf16_f32 v246, v132, v133
v_cvt_pk_bf16_f32 v247, v134, v135
v_mfma_f32_32x32x16_bf16 v[120:135], v[12:15], v[92:95], v[184:199]
v_exp_f32 v104, v104
v_exp_f32 v105, v105
v_exp_f32 v106, v106
v_exp_f32 v107, v107
v_mfma_f32_32x32x8_bf16 v[120:135], v[46:47], v[98:99], v[120:135]
v_exp_f32 v108, v108
v_exp_f32 v109, v109
v_exp_f32 v110, v110
v_exp_f32 v111, v111
v_mfma_f32_32x32x16_bf16 v[152:167], v[80:83], v[240:243], v[152:167]
v_exp_f32 v112, v112
v_exp_f32 v113, v113
v_exp_f32 v114, v114
v_exp_f32 v115, v115
v_mfma_f32_32x32x16_bf16 v[152:167], v[84:87], v[244:247], v[152:167]
v_exp_f32 v116, v116
v_exp_f32 v117, v117
v_exp_f32 v118, v118
v_exp_f32 v119, v119
v_cvt_pk_bf16_f32 v232, v104, v105
v_cvt_pk_bf16_f32 v233, v106, v107
v_cvt_pk_bf16_f32 v234, v108, v109
v_cvt_pk_bf16_f32 v235, v110, v111
v_cvt_pk_bf16_f32 v236, v112, v113
v_cvt_pk_bf16_f32 v237, v114, v115
v_cvt_pk_bf16_f32 v238, v116, v117
v_cvt_pk_bf16_f32 v239, v118, v119
s_cmp_gt_u32 s50, 1
s_cbranch_scc1 L_k2a_p2exit1
v_mfma_f32_32x32x16_bf16 v[104:119], v[8:11], v[88:91], v[168:183]
v_exp_f32 v120, v120
v_exp_f32 v121, v121
v_exp_f32 v122, v122
v_exp_f32 v123, v123
v_mfma_f32_32x32x8_bf16 v[104:119], v[44:45], v[100:101], v[104:119]
v_exp_f32 v124, v124
v_exp_f32 v125, v125
v_exp_f32 v126, v126
v_exp_f32 v127, v127
s_waitcnt vmcnt(4)
v_mfma_f32_32x32x16_bf16 v[136:151], v[72:75], v[232:235], v[136:151]
v_exp_f32 v128, v128
v_exp_f32 v129, v129
v_exp_f32 v130, v130
v_exp_f32 v131, v131
v_mfma_f32_32x32x16_bf16 v[136:151], v[76:79], v[236:239], v[136:151]
v_exp_f32 v132, v132
v_exp_f32 v133, v133
v_exp_f32 v134, v134
v_exp_f32 v135, v135
v_cvt_pk_bf16_f32 v240, v120, v121
v_cvt_pk_bf16_f32 v241, v122, v123
v_cvt_pk_bf16_f32 v242, v124, v125
v_cvt_pk_bf16_f32 v243, v126, v127
v_cvt_pk_bf16_f32 v244, v128, v129
v_cvt_pk_bf16_f32 v245, v130, v131
v_cvt_pk_bf16_f32 v246, v132, v133
v_cvt_pk_bf16_f32 v247, v134, v135
v_pk_add_f32 v[120:121], v[216:217], v[184:185]
v_pk_add_f32 v[122:123], v[218:219], v[186:187]
v_pk_add_f32 v[124:125], v[220:221], v[188:189]
v_pk_add_f32 v[126:127], v[222:223], v[190:191]
v_pk_add_f32 v[128:129], v[224:225], v[192:193]
v_pk_add_f32 v[130:131], v[226:227], v[194:195]
v_pk_add_f32 v[132:133], v[228:229], v[196:197]
v_pk_add_f32 v[134:135], v[230:231], v[198:199]
s_nop 1
v_mfma_f32_32x32x16_bf16 v[120:135], v[8:11], v[92:95], v[120:135]
v_exp_f32 v104, v104
v_exp_f32 v105, v105
v_exp_f32 v106, v106
v_exp_f32 v107, v107
v_mfma_f32_32x32x8_bf16 v[120:135], v[44:45], v[102:103], v[120:135]
v_exp_f32 v108, v108
v_exp_f32 v109, v109
v_exp_f32 v110, v110
v_exp_f32 v111, v111
v_mfma_f32_32x32x16_bf16 v[152:167], v[72:75], v[240:243], v[152:167]
v_exp_f32 v112, v112
v_exp_f32 v113, v113
v_exp_f32 v114, v114
v_exp_f32 v115, v115
v_mfma_f32_32x32x16_bf16 v[152:167], v[76:79], v[244:247], v[152:167]
v_exp_f32 v116, v116
v_exp_f32 v117, v117
v_exp_f32 v118, v118
v_exp_f32 v119, v119
v_cvt_pk_bf16_f32 v232, v104, v105
v_cvt_pk_bf16_f32 v233, v106, v107
v_cvt_pk_bf16_f32 v234, v108, v109
v_cvt_pk_bf16_f32 v235, v110, v111
v_cvt_pk_bf16_f32 v236, v112, v113
v_cvt_pk_bf16_f32 v237, v114, v115
v_cvt_pk_bf16_f32 v238, v116, v117
v_cvt_pk_bf16_f32 v239, v118, v119
v_pk_add_f32 v[104:105], v[216:217], v[168:169]
v_pk_add_f32 v[106:107], v[218:219], v[170:171]
v_pk_add_f32 v[108:109], v[220:221], v[172:173]
v_pk_add_f32 v[110:111], v[222:223], v[174:175]
v_pk_add_f32 v[112:113], v[224:225], v[176:177]
v_pk_add_f32 v[114:115], v[226:227], v[178:179]
v_pk_add_f32 v[116:117], v[228:229], v[180:181]
v_pk_add_f32 v[118:119], v[230:231], v[182:183]
s_nop 1
v_mfma_f32_32x32x16_bf16 v[104:119], v[4:7], v[88:91], v[104:119]
v_exp_f32 v120, v120
v_exp_f32 v121, v121
v_exp_f32 v122, v122
v_exp_f32 v123, v123
v_mfma_f32_32x32x8_bf16 v[104:119], v[44:45], v[96:97], v[104:119]
v_exp_f32 v124, v124
v_exp_f32 v125, v125
v_exp_f32 v126, v126
v_exp_f32 v127, v127
s_waitcnt vmcnt(2)
v_mfma_f32_32x32x16_bf16 v[136:151], v[64:67], v[232:235], v[136:151]
v_exp_f32 v128, v128
v_exp_f32 v129, v129
v_exp_f32 v130, v130
v_exp_f32 v131, v131
v_mfma_f32_32x32x16_bf16 v[136:151], v[68:71], v[236:239], v[136:151]
v_exp_f32 v132, v132
v_exp_f32 v133, v133
v_exp_f32 v134, v134
v_exp_f32 v135, v135
v_cvt_pk_bf16_f32 v240, v120, v121
v_cvt_pk_bf16_f32 v241, v122, v123
v_cvt_pk_bf16_f32 v242, v124, v125
v_cvt_pk_bf16_f32 v243, v126, v127
v_cvt_pk_bf16_f32 v244, v128, v129
v_cvt_pk_bf16_f32 v245, v130, v131
v_cvt_pk_bf16_f32 v246, v132, v133
v_cvt_pk_bf16_f32 v247, v134, v135
v_exp_f32 v104, v104
v_exp_f32 v105, v105
v_exp_f32 v106, v106
v_exp_f32 v107, v107
v_exp_f32 v108, v108
v_exp_f32 v109, v109
v_exp_f32 v110, v110
v_exp_f32 v111, v111
v_mfma_f32_32x32x16_bf16 v[152:167], v[64:67], v[240:243], v[152:167]
v_exp_f32 v112, v112
v_exp_f32 v113, v113
v_exp_f32 v114, v114
v_exp_f32 v115, v115
v_mfma_f32_32x32x16_bf16 v[152:167], v[68:71], v[244:247], v[152:167]
v_exp_f32 v116, v116
v_exp_f32 v117, v117
v_exp_f32 v118, v118
v_exp_f32 v119, v119
v_cvt_pk_bf16_f32 v232, v104, v105
v_cvt_pk_bf16_f32 v233, v106, v107
v_cvt_pk_bf16_f32 v234, v108, v109
v_cvt_pk_bf16_f32 v235, v110, v111
v_cvt_pk_bf16_f32 v236, v112, v113
v_cvt_pk_bf16_f32 v237, v114, v115
v_cvt_pk_bf16_f32 v238, v116, v117
v_cvt_pk_bf16_f32 v239, v118, v119
s_waitcnt vmcnt(0)
v_mfma_f32_32x32x16_bf16 v[136:151], v[56:59], v[232:235], v[136:151]
v_mfma_f32_32x32x16_bf16 v[136:151], v[60:63], v[236:239], v[136:151]
s_branch L_k2a_fin
L_k2a_p2exit7:
v_exp_f32 v120, v120
v_exp_f32 v121, v121
v_exp_f32 v122, v122
v_exp_f32 v123, v123
v_exp_f32 v124, v124
v_exp_f32 v125, v125
v_exp_f32 v126, v126
v_exp_f32 v127, v127
s_waitcnt vmcnt(6)
v_mfma_f32_32x32x16_bf16 v[136:151], v[56:59], v[232:235], 0
v_exp_f32 v128, v128
v_exp_f32 v129, v129
v_exp_f32 v130, v130
v_exp_f32 v131, v131
v_mfma_f32_32x32x16_bf16 v[136:151], v[60:63], v[236:239], v[136:151]
v_exp_f32 v132, v132
v_exp_f32 v133, v133
v_exp_f32 v134, v134
v_exp_f32 v135, v135
v_cvt_pk_bf16_f32 v240, v120, v121
v_cvt_pk_bf16_f32 v241, v122, v123
v_cvt_pk_bf16_f32 v242, v124, v125
v_cvt_pk_bf16_f32 v243, v126, v127
v_cvt_pk_bf16_f32 v244, v128, v129
v_cvt_pk_bf16_f32 v245, v130, v131
v_cvt_pk_bf16_f32 v246, v132, v133
v_cvt_pk_bf16_f32 v247, v134, v135
v_mfma_f32_32x32x16_bf16 v[152:167], v[56:59], v[240:243], v[152:167]
s_nop 0
v_mfma_f32_32x32x16_bf16 v[152:167], v[60:63], v[244:247], v[152:167]
s_waitcnt vmcnt(0)
s_branch L_k2a_fin
L_k2a_p2exit5:
v_exp_f32 v120, v120
v_exp_f32 v121, v121
v_exp_f32 v122, v122
v_exp_f32 v123, v123
v_exp_f32 v124, v124
v_exp_f32 v125, v125
v_exp_f32 v126, v126
v_exp_f32 v127, v127
s_waitcnt vmcnt(6)
v_mfma_f32_32x32x16_bf16 v[136:151], v[72:75], v[232:235], v[136:151]
v_exp_f32 v128, v128
v_exp_f32 v129, v129
v_exp_f32 v130, v130
v_exp_f32 v131, v131
v_mfma_f32_32x32x16_bf16 v[136:151], v[76:79], v[236:239], v[136:151]
v_exp_f32 v132, v132
v_exp_f32 v133, v133
v_exp_f32 v134, v134
v_exp_f32 v135, v135
v_cvt_pk_bf16_f32 v240, v120, v121
v_cvt_pk_bf16_f32 v241, v122, v123
v_cvt_pk_bf16_f32 v242, v124, v125
v_cvt_pk_bf16_f32 v243, v126, v127
v_cvt_pk_bf16_f32 v244, v128, v129
v_cvt_pk_bf16_f32 v245, v130, v131
v_cvt_pk_bf16_f32 v246, v132, v133
v_cvt_pk_bf16_f32 v247, v134, v135
v_mfma_f32_32x32x16_bf16 v[152:167], v[72:75], v[240:243], v[152:167]
s_nop 0
v_mfma_f32_32x32x16_bf16 v[152:167], v[76:79], v[244:247], v[152:167]
s_waitcnt vmcnt(0)
s_branch L_k2a_fin
L_k2a_p2exit3:
v_exp_f32 v120, v120
v_exp_f32 v121, v121
v_exp_f32 v122, v122
v_exp_f32 v123, v123
v_exp_f32 v124, v124
v_exp_f32 v125, v125
v_exp_f32 v126, v126
v_exp_f32 v127, v127
s_waitcnt vmcnt(6)
v_mfma_f32_32x32x16_bf16 v[136:151], v[56:59], v[232:235], v[136:151]
v_exp_f32 v128, v128
v_exp_f32 v129, v129
v_exp_f32 v130, v130
v_exp_f32 v131, v131
v_mfma_f32_32x32x16_bf16 v[136:151], v[60:63], v[236:239], v[136:151]
v_exp_f32 v132, v132
v_exp_f32 v133, v133
v_exp_f32 v134, v134
v_exp_f32 v135, v135
v_cvt_pk_bf16_f32 v240, v120, v121
v_cvt_pk_bf16_f32 v241, v122, v123
v_cvt_pk_bf16_f32 v242, v124, v125
v_cvt_pk_bf16_f32 v243, v126, v127
v_cvt_pk_bf16_f32 v244, v128, v129
v_cvt_pk_bf16_f32 v245, v130, v131
v_cvt_pk_bf16_f32 v246, v132, v133
v_cvt_pk_bf16_f32 v247, v134, v135
v_mfma_f32_32x32x16_bf16 v[152:167], v[56:59], v[240:243], v[152:167]
s_nop 0
v_mfma_f32_32x32x16_bf16 v[152:167], v[60:63], v[244:247], v[152:167]
s_waitcnt vmcnt(0)
s_branch L_k2a_fin
L_k2a_p2exit1:
v_exp_f32 v120, v120
v_exp_f32 v121, v121
v_exp_f32 v122, v122
v_exp_f32 v123, v123
v_exp_f32 v124, v124
v_exp_f32 v125, v125
v_exp_f32 v126, v126
v_exp_f32 v127, v127
s_waitcnt vmcnt(4)
v_mfma_f32_32x32x16_bf16 v[136:151], v[72:75], v[232:235], v[136:151]
v_exp_f32 v128, v128
v_exp_f32 v129, v129
v_exp_f32 v130, v130
v_exp_f32 v131, v131
v_mfma_f32_32x32x16_bf16 v[136:151], v[76:79], v[236:239], v[136:151]
v_exp_f32 v132, v132
v_exp_f32 v133, v133
v_exp_f32 v134, v134
v_exp_f32 v135, v135
v_cvt_pk_bf16_f32 v240, v120, v121
v_cvt_pk_bf16_f32 v241, v122, v123
v_cvt_pk_bf16_f32 v242, v124, v125
v_cvt_pk_bf16_f32 v243, v126, v127
v_cvt_pk_bf16_f32 v244, v128, v129
v_cvt_pk_bf16_f32 v245, v130, v131
v_cvt_pk_bf16_f32 v246, v132, v133
v_cvt_pk_bf16_f32 v247, v134, v135
v_mfma_f32_32x32x16_bf16 v[152:167], v[72:75], v[240:243], v[152:167]
s_nop 0
v_mfma_f32_32x32x16_bf16 v[152:167], v[76:79], v[244:247], v[152:167]
s_waitcnt vmcnt(0)
s_branch L_k2a_fin
L_k2a_fin:
v_lshrrev_b32 v104, 5, v1
v_add_u32 v104, s54, v104
v_lshrrev_b32 v105, 2, v104
v_and_b32 v104, 3, v104
v_lshlrev_b32 v104, 8, v104
v_lshl_add_u32 v104, v105, 12, v104
v_bfe_u32 v105, v1, 4, 1
v_and_b32 v106, 15, v1
v_lshlrev_b32 v106, 4, v106
v_lshl_add_u32 v106, v105, 10, v106
v_add_u32 v104, v104, v106
s_lshr_b32 s36, s55, 2
s_lshl_b32 s36, s36, 12
s_and_b32 s37, s55, 3
s_lshl_b32 s37, s37, 8
s_add_u32 s36, s36, s37
s_lshl_b32 s37, s53, 3
s_add_u32 s36, s36, s37
v_add_u32 v105, s36, v106
s_mul_i32 s36, s21, 278528
s_add_u32 s36, s36, 8060928
s_add_u32 s37, s36, 2048
v_mov_b32 v248, v144
v_mov_b32 v249, v144
v_mov_b32 v250, v160
v_mov_b32 v251, v160
v_permlane32_swap_b32 v248, v249
s_nop 0
v_permlane32_swap_b32 v250, v251
v_rcp_f32 v249, v249
v_rcp_f32 v251, v251
v_mul_f32 v136, v136, v249
v_mul_f32 v137, v137, v249
v_mul_f32 v138, v138, v249
v_mul_f32 v139, v139, v249
v_mul_f32 v140, v140, v249
v_mul_f32 v141, v141, v249
v_mul_f32 v142, v142, v249
v_mul_f32 v143, v143, v249
v_mul_f32 v144, v144, v249
v_mul_f32 v145, v145, v249
v_mul_f32 v146, v146, v249
v_mul_f32 v147, v147, v249
v_cvt_pk_bf16_f32 v232, v136, v137
v_cvt_pk_bf16_f32 v233, v138, v139
v_cvt_pk_bf16_f32 v234, v140, v141
v_cvt_pk_bf16_f32 v235, v142, v143
v_cvt_pk_bf16_f32 v236, v144, v145
v_cvt_pk_bf16_f32 v237, v146, v147
v_min_u32 v232, -2, v232
v_min_u32 v233, -2, v233
v_min_u32 v234, -2, v234
v_min_u32 v235, -2, v235
v_min_u32 v236, -2, v236
v_min_u32 v237, -2, v237
v_permlane32_swap_b32 v232, v234
v_permlane32_swap_b32 v233, v235
buffer_store_dwordx4 v[232:235], v104, s[8:11], s36 offen sc1
s_mov_b64 exec, s[60:61]
buffer_store_dwordx2 v[236:237], v105, s[8:11], s36 offen sc1
s_mov_b64 exec, -1
v_mul_f32 v152, v152, v251
v_mul_f32 v153, v153, v251
v_mul_f32 v154, v154, v251
v_mul_f32 v155, v155, v251
v_mul_f32 v156, v156, v251
v_mul_f32 v157, v157, v251
v_mul_f32 v158, v158, v251
v_mul_f32 v159, v159, v251
v_mul_f32 v160, v160, v251
v_mul_f32 v161, v161, v251
v_mul_f32 v162, v162, v251
v_mul_f32 v163, v163, v251
v_cvt_pk_bf16_f32 v240, v152, v153
v_cvt_pk_bf16_f32 v241, v154, v155
v_cvt_pk_bf16_f32 v242, v156, v157
v_cvt_pk_bf16_f32 v243, v158, v159
v_cvt_pk_bf16_f32 v244, v160, v161
v_cvt_pk_bf16_f32 v245, v162, v163
v_min_u32 v240, -2, v240
v_min_u32 v241, -2, v241
v_min_u32 v242, -2, v242
v_min_u32 v243, -2, v243
v_min_u32 v244, -2, v244
v_min_u32 v245, -2, v245
v_permlane32_swap_b32 v240, v242
v_permlane32_swap_b32 v241, v243
buffer_store_dwordx4 v[240:243], v104, s[8:11], s37 offen sc1
s_mov_b64 exec, s[60:61]
buffer_store_dwordx2 v[244:245], v105, s[8:11], s37 offen sc1
s_mov_b64 exec, -1
s_endpgm
L_k2_g3:
s_sub_u32 s36, s20, 4
v_lshlrev_b32 v6, 4, v1
v_add_u32 v7, 4096, v6
s_add_u32 s53, s36, 0
s_and_b32 s53, s53, 3
s_lshl_b32 s54, s53, 10
v_add_u32 v2, s54, v6
s_add_u32 s53, s36, 1
s_and_b32 s53, s53, 3
s_lshl_b32 s54, s53, 10
v_add_u32 v3, s54, v6
s_mul_i32 s54, s53, 15360
s_add_u32 s54, s54, 0
v_add_u32 v9, s54, v6
s_add_u32 s53, s36, 2
s_and_b32 s53, s53, 3
s_lshl_b32 s54, s53, 10
v_add_u32 v4, s54, v6
s_mul_i32 s54, s53, 15360
s_add_u32 s54, s54, 5120
v_add_u32 v10, s54, v6
s_add_u32 s53, s36, 3
s_and_b32 s53, s53, 3
s_lshl_b32 s54, s53, 10
v_add_u32 v5, s54, v6
s_mul_i32 s54, s53, 15360
s_add_u32 s54, s54, 10240
v_add_u32 v11, s54, v6
s_mov_b32 s60, 0
s_mul_i32 s61, s21, 68
s_add_u32 s61, s61, s36
s_lshl_b32 s61, s61, 12
s_add_u32 s61, s61, 7864320
s_mul_i32 s62, s22, 68
s_add_u32 s62, s62, s36
s_mul_i32 s62, s62, 5120
s_add_u32 s62, s62, 16777216
s_lshl_b32 s53, s60, 14
s_add_u32 s57, s61, s53
s_mul_i32 s53, s60, 20480
s_add_u32 s58, s62, s53
buffer_load_dwordx4 v[96:99], v2, s[8:11], s57 offen
buffer_load_dwordx4 v[100:103], v3, s[8:11], s57 offen
buffer_load_dwordx4 v[104:107], v4, s[8:11], s57 offen
buffer_load_dwordx4 v[108:111], v5, s[8:11], s57 offen
buffer_load_dwordx4 v[112:115], v6, s[8:11], s58 offen offset:0
buffer_load_dwordx4 v[116:119], v6, s[8:11], s58 offen offset:1024
buffer_load_dwordx4 v[120:123], v6, s[8:11], s58 offen offset:2048
buffer_load_dwordx4 v[124:127], v6, s[8:11], s58 offen offset:3072
buffer_load_dwordx4 v[128:131], v7, s[8:11], s58 offen
s_add_u32 s57, s57, 16384
s_add_u32 s58, s58, 20480
s_add_u32 s60, s60, 1
s_cmp_eq_u32 s60, 12
s_cselect_b32 s53, 196608, 0
s_cselect_b32 s54, 245760, 0
s_sub_u32 s57, s57, s53
s_sub_u32 s58, s58, s54
buffer_load_dwordx4 v[132:135], v2, s[8:11], s57 offen
buffer_load_dwordx4 v[136:139], v3, s[8:11], s57 offen
buffer_load_dwordx4 v[140:143], v4, s[8:11], s57 offen
buffer_load_dwordx4 v[144:147], v5, s[8:11], s57 offen
buffer_load_dwordx4 v[148:151], v6, s[8:11], s58 offen offset:0
buffer_load_dwordx4 v[152:155], v6, s[8:11], s58 offen offset:1024
buffer_load_dwordx4 v[156:159], v6, s[8:11], s58 offen offset:2048
buffer_load_dwordx4 v[160:163], v6, s[8:11], s58 offen offset:3072
buffer_load_dwordx4 v[164:167], v7, s[8:11], s58 offen
s_add_u32 s57, s57, 16384
s_add_u32 s58, s58, 20480
s_add_u32 s60, s60, 1
s_cmp_eq_u32 s60, 12
s_cselect_b32 s53, 196608, 0
s_cselect_b32 s54, 245760, 0
s_sub_u32 s57, s57, s53
s_sub_u32 s58, s58, s54
buffer_load_dwordx4 v[168:171], v2, s[8:11], s57 offen
buffer_load_dwordx4 v[172:175], v3, s[8:11], s57 offen
buffer_load_dwordx4 v[176:179], v4, s[8:11], s57 offen
buffer_load_dwordx4 v[180:183], v5, s[8:11], s57 offen
buffer_load_dwordx4 v[184:187], v6, s[8:11], s58 offen offset:0
buffer_load_dwordx4 v[188:191], v6, s[8:11], s58 offen offset:1024
buffer_load_dwordx4 v[192:195], v6, s[8:11], s58 offen offset:2048
buffer_load_dwordx4 v[196:199], v6, s[8:11], s58 offen offset:3072
buffer_load_dwordx4 v[200:203], v7, s[8:11], s58 offen
s_add_u32 s57, s57, 16384
s_add_u32 s58, s58, 20480
s_add_u32 s60, s60, 1
s_cmp_eq_u32 s60, 12
s_cselect_b32 s53, 196608, 0
s_cselect_b32 s54, 245760, 0
s_sub_u32 s57, s57, s53
s_sub_u32 s58, s58, s54
s_lshl_b32 s59, s21, 2
s_add_u32 s59, s59, s36
s_mul_i32 s59, s59, 20480
s_mul_i32 s56, s22, 160
s_add_u32 s59, s59, s56
s_mov_b32 s40, s14
s_and_b32 s41, s15, 0xffff
s_mov_b32 s42, 2621440
s_mov_b32 s43, 0x20000
s_mov_b32 s44, s16
s_and_b32 s45, s17, 0xffff
s_mov_b32 s46, 1280
s_mov_b32 s47, 0x20000
s_mov_b32 s48, s18
s_and_b32 s49, s19, 0xffff
s_mov_b32 s50, 2621440
s_mov_b32 s51, 0x20000
v_add_u32 v15, 0, v1
v_mul_u32_u24 v12, 6554, v15
v_lshrrev_b32 v12, 16, v12
v_mul_u32_u24 v8, 10, v12
v_sub_u32 v15, v15, v8
v_lshlrev_b32 v15, 4, v15
v_mul_u32_u24 v12, 1280, v12
v_add_u32 v12, v12, v15
v_add_u32 v15, 64, v1
v_mul_u32_u24 v13, 6554, v15
v_lshrrev_b32 v13, 16, v13
v_mul_u32_u24 v8, 10, v13
v_sub_u32 v15, v15, v8
v_lshlrev_b32 v15, 4, v15
v_mul_u32_u24 v13, 1280, v13
v_add_u32 v13, v13, v15
v_add_u32 v15, 128, v1
v_mul_u32_u24 v14, 6554, v15
v_lshrrev_b32 v14, 16, v14
v_mul_u32_u24 v8, 10, v14
v_sub_u32 v15, v15, v8
v_lshlrev_b32 v15, 4, v15
v_mul_u32_u24 v14, 1280, v14
v_add_u32 v14, v14, v15
s_mul_i32 s63, s36, 2816
s_add_u32 s63, s63, 61504
s_mov_b32 s52, s56
v_and_b32 v8, 15, v1
v_mul_u32_u24 v8, 160, v8
v_lshrrev_b32 v15, 4, v1
v_lshl_add_u32 v8, v15, 3, v8
v_add_u32 v8, s63, v8
v_add_u32 v15, s63, v6
v_lshrrev_b32 v250, 4, v1
v_lshlrev_b32 v250, 3, v250
v_add_u32 v250, s63, v250
s_waitcnt vmcnt(18)
buffer_load_dwordx4 v[204:207], v2, s[8:11], s57 offen
buffer_load_dwordx4 v[208:211], v3, s[8:11], s57 offen
buffer_load_dwordx4 v[212:215], v4, s[8:11], s57 offen
buffer_load_dwordx4 v[216:219], v5, s[8:11], s57 offen
v_mfma_f32_16x16x32_bf16 v[16:19], v[112:115], v[96:99], 0
v_mfma_f32_16x16x32_bf16 v[36:39], v[112:115], v[100:103], 0
buffer_load_dwordx4 v[220:223], v6, s[8:11], s58 offen offset:0
v_mfma_f32_16x16x32_bf16 v[56:59], v[112:115], v[104:107], 0
v_mfma_f32_16x16x32_bf16 v[76:79], v[112:115], v[108:111], 0
buffer_load_dwordx4 v[224:227], v6, s[8:11], s58 offen offset:1024
v_mfma_f32_16x16x32_bf16 v[20:23], v[116:119], v[96:99], 0
v_mfma_f32_16x16x32_bf16 v[40:43], v[116:119], v[100:103], 0
buffer_load_dwordx4 v[228:231], v6, s[8:11], s58 offen offset:2048
v_mfma_f32_16x16x32_bf16 v[60:63], v[116:119], v[104:107], 0
v_mfma_f32_16x16x32_bf16 v[80:83], v[116:119], v[108:111], 0
buffer_load_dwordx4 v[232:235], v6, s[8:11], s58 offen offset:3072
v_mfma_f32_16x16x32_bf16 v[24:27], v[120:123], v[96:99], 0
v_mfma_f32_16x16x32_bf16 v[44:47], v[120:123], v[100:103], 0
buffer_load_dwordx4 v[236:239], v7, s[8:11], s58 offen
v_mfma_f32_16x16x32_bf16 v[64:67], v[120:123], v[104:107], 0
v_mfma_f32_16x16x32_bf16 v[84:87], v[120:123], v[108:111], 0
v_mfma_f32_16x16x32_bf16 v[28:31], v[124:127], v[96:99], 0
v_mfma_f32_16x16x32_bf16 v[48:51], v[124:127], v[100:103], 0
v_mfma_f32_16x16x32_bf16 v[68:71], v[124:127], v[104:107], 0
v_mfma_f32_16x16x32_bf16 v[88:91], v[124:127], v[108:111], 0
v_mfma_f32_16x16x32_bf16 v[32:35], v[128:131], v[96:99], 0
v_mfma_f32_16x16x32_bf16 v[52:55], v[128:131], v[100:103], 0
v_mfma_f32_16x16x32_bf16 v[72:75], v[128:131], v[104:107], 0
v_mfma_f32_16x16x32_bf16 v[92:95], v[128:131], v[108:111], 0
s_add_u32 s57, s57, 16384
s_add_u32 s58, s58, 20480
s_add_u32 s60, s60, 1
s_cmp_eq_u32 s60, 12
s_cselect_b32 s53, 196608, 0
s_cselect_b32 s54, 245760, 0
s_sub_u32 s57, s57, s53
s_sub_u32 s58, s58, s54
s_waitcnt vmcnt(18)
s_add_u32 m0, s63, 0
s_nop 0
buffer_load_dwordx4 v12, s[40:43], s59 offen lds
s_add_u32 m0, s63, 1024
s_nop 0
buffer_load_dwordx4 v13, s[40:43], s59 offen lds
s_add_u32 m0, s63, 2048
s_mov_b32 exec_hi, 0
buffer_load_dwordx4 v14, s[40:43], s59 offen lds
s_mov_b64 exec, 0x3ff
s_add_u32 m0, s63, 2560
s_nop 0
buffer_load_dwordx4 v6, s[44:47], s52 offen lds
s_mov_b64 exec, -1
buffer_load_dwordx4 v[96:99], v2, s[8:11], s57 offen
buffer_load_dwordx4 v[100:103], v3, s[8:11], s57 offen
buffer_load_dwordx4 v[104:107], v4, s[8:11], s57 offen
buffer_load_dwordx4 v[108:111], v5, s[8:11], s57 offen
v_mfma_f32_16x16x32_bf16 v[16:19], v[148:151], v[132:135], v[16:19]
v_mfma_f32_16x16x32_bf16 v[36:39], v[148:151], v[136:139], v[36:39]
buffer_load_dwordx4 v[112:115], v6, s[8:11], s58 offen offset:0
v_mfma_f32_16x16x32_bf16 v[56:59], v[148:151], v[140:143], v[56:59]
v_mfma_f32_16x16x32_bf16 v[76:79], v[148:151], v[144:147], v[76:79]
buffer_load_dwordx4 v[116:119], v6, s[8:11], s58 offen offset:1024
v_mfma_f32_16x16x32_bf16 v[20:23], v[152:155], v[132:135], v[20:23]
v_mfma_f32_16x16x32_bf16 v[40:43], v[152:155], v[136:139], v[40:43]
buffer_load_dwordx4 v[120:123], v6, s[8:11], s58 offen offset:2048
v_mfma_f32_16x16x32_bf16 v[60:63], v[152:155], v[140:143], v[60:63]
v_mfma_f32_16x16x32_bf16 v[80:83], v[152:155], v[144:147], v[80:83]
buffer_load_dwordx4 v[124:127], v6, s[8:11], s58 offen offset:3072
v_mfma_f32_16x16x32_bf16 v[24:27], v[156:159], v[132:135], v[24:27]
v_mfma_f32_16x16x32_bf16 v[44:47], v[156:159], v[136:139], v[44:47]
buffer_load_dwordx4 v[128:131], v7, s[8:11], s58 offen
v_mfma_f32_16x16x32_bf16 v[64:67], v[156:159], v[140:143], v[64:67]
v_mfma_f32_16x16x32_bf16 v[84:87], v[156:159], v[144:147], v[84:87]
v_mfma_f32_16x16x32_bf16 v[28:31], v[160:163], v[132:135], v[28:31]
v_mfma_f32_16x16x32_bf16 v[48:51], v[160:163], v[136:139], v[48:51]
v_mfma_f32_16x16x32_bf16 v[68:71], v[160:163], v[140:143], v[68:71]
v_mfma_f32_16x16x32_bf16 v[88:91], v[160:163], v[144:147], v[88:91]
v_mfma_f32_16x16x32_bf16 v[32:35], v[164:167], v[132:135], v[32:35]
v_mfma_f32_16x16x32_bf16 v[52:55], v[164:167], v[136:139], v[52:55]
v_mfma_f32_16x16x32_bf16 v[72:75], v[164:167], v[140:143], v[72:75]
v_mfma_f32_16x16x32_bf16 v[92:95], v[164:167], v[144:147], v[92:95]
s_add_u32 s57, s57, 16384
s_add_u32 s58, s58, 20480
s_add_u32 s60, s60, 1
s_cmp_eq_u32 s60, 12
s_cselect_b32 s53, 196608, 0
s_cselect_b32 s54, 245760, 0
s_sub_u32 s57, s57, s53
s_sub_u32 s58, s58, s54
s_waitcnt vmcnt(22)
buffer_load_dwordx4 v[132:135], v2, s[8:11], s57 offen
buffer_load_dwordx4 v[136:139], v3, s[8:11], s57 offen
buffer_load_dwordx4 v[140:143], v4, s[8:11], s57 offen
buffer_load_dwordx4 v[144:147], v5, s[8:11], s57 offen
v_mfma_f32_16x16x32_bf16 v[16:19], v[184:187], v[168:171], v[16:19]
v_mfma_f32_16x16x32_bf16 v[36:39], v[184:187], v[172:175], v[36:39]
buffer_load_dwordx4 v[148:151], v6, s[8:11], s58 offen offset:0
v_mfma_f32_16x16x32_bf16 v[56:59], v[184:187], v[176:179], v[56:59]
v_mfma_f32_16x16x32_bf16 v[76:79], v[184:187], v[180:183], v[76:79]
buffer_load_dwordx4 v[152:155], v6, s[8:11], s58 offen offset:1024
v_mfma_f32_16x16x32_bf16 v[20:23], v[188:191], v[168:171], v[20:23]
v_mfma_f32_16x16x32_bf16 v[40:43], v[188:191], v[172:175], v[40:43]
buffer_load_dwordx4 v[156:159], v6, s[8:11], s58 offen offset:2048
v_mfma_f32_16x16x32_bf16 v[60:63], v[188:191], v[176:179], v[60:63]
v_mfma_f32_16x16x32_bf16 v[80:83], v[188:191], v[180:183], v[80:83]
buffer_load_dwordx4 v[160:163], v6, s[8:11], s58 offen offset:3072
v_mfma_f32_16x16x32_bf16 v[24:27], v[192:195], v[168:171], v[24:27]
v_mfma_f32_16x16x32_bf16 v[44:47], v[192:195], v[172:175], v[44:47]
buffer_load_dwordx4 v[164:167], v7, s[8:11], s58 offen
v_mfma_f32_16x16x32_bf16 v[64:67], v[192:195], v[176:179], v[64:67]
v_mfma_f32_16x16x32_bf16 v[84:87], v[192:195], v[180:183], v[84:87]
v_mfma_f32_16x16x32_bf16 v[28:31], v[196:199], v[168:171], v[28:31]
v_mfma_f32_16x16x32_bf16 v[48:51], v[196:199], v[172:175], v[48:51]
v_mfma_f32_16x16x32_bf16 v[68:71], v[196:199], v[176:179], v[68:71]
v_mfma_f32_16x16x32_bf16 v[88:91], v[196:199], v[180:183], v[88:91]
v_mfma_f32_16x16x32_bf16 v[32:35], v[200:203], v[168:171], v[32:35]
v_mfma_f32_16x16x32_bf16 v[52:55], v[200:203], v[172:175], v[52:55]
v_mfma_f32_16x16x32_bf16 v[72:75], v[200:203], v[176:179], v[72:75]
v_mfma_f32_16x16x32_bf16 v[92:95], v[200:203], v[180:183], v[92:95]
s_add_u32 s57, s57, 16384
s_add_u32 s58, s58, 20480
s_add_u32 s60, s60, 1
s_cmp_eq_u32 s60, 12
s_cselect_b32 s53, 196608, 0
s_cselect_b32 s54, 245760, 0
s_sub_u32 s57, s57, s53
s_sub_u32 s58, s58, s54
s_waitcnt vmcnt(22)
buffer_load_dwordx4 v[168:171], v2, s[8:11], s57 offen
buffer_load_dwordx4 v[172:175], v3, s[8:11], s57 offen
buffer_load_dwordx4 v[176:179], v4, s[8:11], s57 offen
buffer_load_dwordx4 v[180:183], v5, s[8:11], s57 offen
v_mfma_f32_16x16x32_bf16 v[16:19], v[220:223], v[204:207], v[16:19]
v_mfma_f32_16x16x32_bf16 v[36:39], v[220:223], v[208:211], v[36:39]
buffer_load_dwordx4 v[184:187], v6, s[8:11], s58 offen offset:0
v_mfma_f32_16x16x32_bf16 v[56:59], v[220:223], v[212:215], v[56:59]
v_mfma_f32_16x16x32_bf16 v[76:79], v[220:223], v[216:219], v[76:79]
buffer_load_dwordx4 v[188:191], v6, s[8:11], s58 offen offset:1024
v_mfma_f32_16x16x32_bf16 v[20:23], v[224:227], v[204:207], v[20:23]
v_mfma_f32_16x16x32_bf16 v[40:43], v[224:227], v[208:211], v[40:43]
buffer_load_dwordx4 v[192:195], v6, s[8:11], s58 offen offset:2048
v_mfma_f32_16x16x32_bf16 v[60:63], v[224:227], v[212:215], v[60:63]
v_mfma_f32_16x16x32_bf16 v[80:83], v[224:227], v[216:219], v[80:83]
buffer_load_dwordx4 v[196:199], v6, s[8:11], s58 offen offset:3072
v_mfma_f32_16x16x32_bf16 v[24:27], v[228:231], v[204:207], v[24:27]
v_mfma_f32_16x16x32_bf16 v[44:47], v[228:231], v[208:211], v[44:47]
buffer_load_dwordx4 v[200:203], v7, s[8:11], s58 offen
v_mfma_f32_16x16x32_bf16 v[64:67], v[228:231], v[212:215], v[64:67]
v_mfma_f32_16x16x32_bf16 v[84:87], v[228:231], v[216:219], v[84:87]
v_mfma_f32_16x16x32_bf16 v[28:31], v[232:235], v[204:207], v[28:31]
v_mfma_f32_16x16x32_bf16 v[48:51], v[232:235], v[208:211], v[48:51]
v_mfma_f32_16x16x32_bf16 v[68:71], v[232:235], v[212:215], v[68:71]
v_mfma_f32_16x16x32_bf16 v[88:91], v[232:235], v[216:219], v[88:91]
v_mfma_f32_16x16x32_bf16 v[32:35], v[236:239], v[204:207], v[32:35]
v_mfma_f32_16x16x32_bf16 v[52:55], v[236:239], v[208:211], v[52:55]
v_mfma_f32_16x16x32_bf16 v[72:75], v[236:239], v[212:215], v[72:75]
v_mfma_f32_16x16x32_bf16 v[92:95], v[236:239], v[216:219], v[92:95]
s_add_u32 s57, s57, 16384
s_add_u32 s58, s58, 20480
s_add_u32 s60, s60, 1
s_cmp_eq_u32 s60, 12
s_cselect_b32 s53, 196608, 0
s_cselect_b32 s54, 245760, 0
s_sub_u32 s57, s57, s53
s_sub_u32 s58, s58, s54
s_waitcnt vmcnt(18)
buffer_load_dwordx4 v[204:207], v2, s[8:11], s57 offen
buffer_load_dwordx4 v[208:211], v3, s[8:11], s57 offen
buffer_load_dwordx4 v[212:215], v4, s[8:11], s57 offen
buffer_load_dwordx4 v[216:219], v5, s[8:11], s57 offen
v_mfma_f32_16x16x32_bf16 v[16:19], v[112:115], v[96:99], v[16:19]
v_mfma_f32_16x16x32_bf16 v[36:39], v[112:115], v[100:103], v[36:39]
buffer_load_dwordx4 v[220:223], v6, s[8:11], s58 offen offset:0
v_mfma_f32_16x16x32_bf16 v[56:59], v[112:115], v[104:107], v[56:59]
v_mfma_f32_16x16x32_bf16 v[76:79], v[112:115], v[108:111], v[76:79]
buffer_load_dwordx4 v[224:227], v6, s[8:11], s58 offen offset:1024
v_mfma_f32_16x16x32_bf16 v[20:23], v[116:119], v[96:99], v[20:23]
v_mfma_f32_16x16x32_bf16 v[40:43], v[116:119], v[100:103], v[40:43]
buffer_load_dwordx4 v[228:231], v6, s[8:11], s58 offen offset:2048
v_mfma_f32_16x16x32_bf16 v[60:63], v[116:119], v[104:107], v[60:63]
v_mfma_f32_16x16x32_bf16 v[80:83], v[116:119], v[108:111], v[80:83]
buffer_load_dwordx4 v[232:235], v6, s[8:11], s58 offen offset:3072
v_mfma_f32_16x16x32_bf16 v[24:27], v[120:123], v[96:99], v[24:27]
v_mfma_f32_16x16x32_bf16 v[44:47], v[120:123], v[100:103], v[44:47]
buffer_load_dwordx4 v[236:239], v7, s[8:11], s58 offen
v_mfma_f32_16x16x32_bf16 v[64:67], v[120:123], v[104:107], v[64:67]
v_mfma_f32_16x16x32_bf16 v[84:87], v[120:123], v[108:111], v[84:87]
v_mfma_f32_16x16x32_bf16 v[28:31], v[124:127], v[96:99], v[28:31]
v_mfma_f32_16x16x32_bf16 v[48:51], v[124:127], v[100:103], v[48:51]
v_mfma_f32_16x16x32_bf16 v[68:71], v[124:127], v[104:107], v[68:71]
v_mfma_f32_16x16x32_bf16 v[88:91], v[124:127], v[108:111], v[88:91]
v_mfma_f32_16x16x32_bf16 v[32:35], v[128:131], v[96:99], v[32:35]
v_mfma_f32_16x16x32_bf16 v[52:55], v[128:131], v[100:103], v[52:55]
v_mfma_f32_16x16x32_bf16 v[72:75], v[128:131], v[104:107], v[72:75]
v_mfma_f32_16x16x32_bf16 v[92:95], v[128:131], v[108:111], v[92:95]
s_add_u32 s57, s57, 16384
s_add_u32 s58, s58, 20480
s_add_u32 s60, s60, 1
s_cmp_eq_u32 s60, 12
s_cselect_b32 s53, 196608, 0
s_cselect_b32 s54, 245760, 0
s_sub_u32 s57, s57, s53
s_sub_u32 s58, s58, s54
s_waitcnt vmcnt(18)
ds_read_b64 v[242:243], v8 offset:0
ds_read_b64 v[244:245], v250 offset:2560
buffer_load_dwordx4 v[96:99], v2, s[8:11], s57 offen
buffer_load_dwordx4 v[100:103], v3, s[8:11], s57 offen
buffer_load_dwordx4 v[104:107], v4, s[8:11], s57 offen
buffer_load_dwordx4 v[108:111], v5, s[8:11], s57 offen
v_mfma_f32_16x16x32_bf16 v[16:19], v[148:151], v[132:135], v[16:19]
v_mfma_f32_16x16x32_bf16 v[36:39], v[148:151], v[136:139], v[36:39]
buffer_load_dwordx4 v[112:115], v6, s[8:11], s58 offen offset:0
v_mfma_f32_16x16x32_bf16 v[56:59], v[148:151], v[140:143], v[56:59]
v_mfma_f32_16x16x32_bf16 v[76:79], v[148:151], v[144:147], v[76:79]
buffer_load_dwordx4 v[116:119], v6, s[8:11], s58 offen offset:1024
v_mfma_f32_16x16x32_bf16 v[20:23], v[152:155], v[132:135], v[20:23]
v_mfma_f32_16x16x32_bf16 v[40:43], v[152:155], v[136:139], v[40:43]
buffer_load_dwordx4 v[120:123], v6, s[8:11], s58 offen offset:2048
v_mfma_f32_16x16x32_bf16 v[60:63], v[152:155], v[140:143], v[60:63]
v_mfma_f32_16x16x32_bf16 v[80:83], v[152:155], v[144:147], v[80:83]
buffer_load_dwordx4 v[124:127], v6, s[8:11], s58 offen offset:3072
v_mfma_f32_16x16x32_bf16 v[24:27], v[156:159], v[132:135], v[24:27]
v_mfma_f32_16x16x32_bf16 v[44:47], v[156:159], v[136:139], v[44:47]
buffer_load_dwordx4 v[128:131], v7, s[8:11], s58 offen
v_mfma_f32_16x16x32_bf16 v[64:67], v[156:159], v[140:143], v[64:67]
v_mfma_f32_16x16x32_bf16 v[84:87], v[156:159], v[144:147], v[84:87]
v_mfma_f32_16x16x32_bf16 v[28:31], v[160:163], v[132:135], v[28:31]
v_mfma_f32_16x16x32_bf16 v[48:51], v[160:163], v[136:139], v[48:51]
v_mfma_f32_16x16x32_bf16 v[68:71], v[160:163], v[140:143], v[68:71]
v_mfma_f32_16x16x32_bf16 v[88:91], v[160:163], v[144:147], v[88:91]
v_mfma_f32_16x16x32_bf16 v[32:35], v[164:167], v[132:135], v[32:35]
v_mfma_f32_16x16x32_bf16 v[52:55], v[164:167], v[136:139], v[52:55]
v_mfma_f32_16x16x32_bf16 v[72:75], v[164:167], v[140:143], v[72:75]
v_mfma_f32_16x16x32_bf16 v[92:95], v[164:167], v[144:147], v[92:95]
s_add_u32 s57, s57, 16384
s_add_u32 s58, s58, 20480
s_add_u32 s60, s60, 1
s_cmp_eq_u32 s60, 12
s_cselect_b32 s53, 196608, 0
s_cselect_b32 s54, 245760, 0
s_sub_u32 s57, s57, s53
s_sub_u32 s58, s58, s54
s_waitcnt lgkmcnt(0)
v_lshlrev_b32 v246, 16, v242
v_and_b32 v247, 0xffff0000, v242
v_lshlrev_b32 v242, 16, v244
v_and_b32 v244, 0xffff0000, v244
v_add_f32 v246, v246, v242
v_add_f32 v247, v247, v244
v_lshlrev_b32 v248, 16, v243
v_and_b32 v249, 0xffff0000, v243
v_lshlrev_b32 v243, 16, v245
v_and_b32 v245, 0xffff0000, v245
v_add_f32 v248, v248, v243
v_add_f32 v249, v249, v245
v_pk_add_f32 v[16:17], v[16:17], v[246:247]
v_pk_add_f32 v[18:19], v[18:19], v[248:249]
s_waitcnt vmcnt(18)
ds_read_b64 v[242:243], v8 offset:32
ds_read_b64 v[244:245], v250 offset:2592
buffer_load_dwordx4 v[132:135], v2, s[8:11], s57 offen
buffer_load_dwordx4 v[136:139], v3, s[8:11], s57 offen
buffer_load_dwordx4 v[140:143], v4, s[8:11], s57 offen
buffer_load_dwordx4 v[144:147], v5, s[8:11], s57 offen
v_mfma_f32_16x16x32_bf16 v[16:19], v[184:187], v[168:171], v[16:19]
v_mfma_f32_16x16x32_bf16 v[36:39], v[184:187], v[172:175], v[36:39]
buffer_load_dwordx4 v[148:151], v6, s[8:11], s58 offen offset:0
v_mfma_f32_16x16x32_bf16 v[56:59], v[184:187], v[176:179], v[56:59]
v_mfma_f32_16x16x32_bf16 v[76:79], v[184:187], v[180:183], v[76:79]
buffer_load_dwordx4 v[152:155], v6, s[8:11], s58 offen offset:1024
v_mfma_f32_16x16x32_bf16 v[20:23], v[188:191], v[168:171], v[20:23]
v_mfma_f32_16x16x32_bf16 v[40:43], v[188:191], v[172:175], v[40:43]
buffer_load_dwordx4 v[156:159], v6, s[8:11], s58 offen offset:2048
v_mfma_f32_16x16x32_bf16 v[60:63], v[188:191], v[176:179], v[60:63]
v_mfma_f32_16x16x32_bf16 v[80:83], v[188:191], v[180:183], v[80:83]
buffer_load_dwordx4 v[160:163], v6, s[8:11], s58 offen offset:3072
v_mfma_f32_16x16x32_bf16 v[24:27], v[192:195], v[168:171], v[24:27]
v_mfma_f32_16x16x32_bf16 v[44:47], v[192:195], v[172:175], v[44:47]
buffer_load_dwordx4 v[164:167], v7, s[8:11], s58 offen
v_mfma_f32_16x16x32_bf16 v[64:67], v[192:195], v[176:179], v[64:67]
v_mfma_f32_16x16x32_bf16 v[84:87], v[192:195], v[180:183], v[84:87]
v_mfma_f32_16x16x32_bf16 v[28:31], v[196:199], v[168:171], v[28:31]
v_mfma_f32_16x16x32_bf16 v[48:51], v[196:199], v[172:175], v[48:51]
v_mfma_f32_16x16x32_bf16 v[68:71], v[196:199], v[176:179], v[68:71]
v_mfma_f32_16x16x32_bf16 v[88:91], v[196:199], v[180:183], v[88:91]
v_mfma_f32_16x16x32_bf16 v[32:35], v[200:203], v[168:171], v[32:35]
v_mfma_f32_16x16x32_bf16 v[52:55], v[200:203], v[172:175], v[52:55]
v_mfma_f32_16x16x32_bf16 v[72:75], v[200:203], v[176:179], v[72:75]
v_mfma_f32_16x16x32_bf16 v[92:95], v[200:203], v[180:183], v[92:95]
s_add_u32 s57, s57, 16384
s_add_u32 s58, s58, 20480
s_add_u32 s60, s60, 1
s_cmp_eq_u32 s60, 12
s_cselect_b32 s53, 196608, 0
s_cselect_b32 s54, 245760, 0
s_sub_u32 s57, s57, s53
s_sub_u32 s58, s58, s54
s_waitcnt lgkmcnt(0)
v_lshlrev_b32 v246, 16, v242
v_and_b32 v247, 0xffff0000, v242
v_lshlrev_b32 v242, 16, v244
v_and_b32 v244, 0xffff0000, v244
v_add_f32 v246, v246, v242
v_add_f32 v247, v247, v244
v_lshlrev_b32 v248, 16, v243
v_and_b32 v249, 0xffff0000, v243
v_lshlrev_b32 v243, 16, v245
v_and_b32 v245, 0xffff0000, v245
v_add_f32 v248, v248, v243
v_add_f32 v249, v249, v245
v_pk_add_f32 v[20:21], v[20:21], v[246:247]
v_pk_add_f32 v[22:23], v[22:23], v[248:249]
s_waitcnt vmcnt(18)
ds_read_b64 v[242:243], v8 offset:64
ds_read_b64 v[244:245], v250 offset:2624
buffer_load_dwordx4 v[168:171], v2, s[8:11], s57 offen
buffer_load_dwordx4 v[172:175], v3, s[8:11], s57 offen
buffer_load_dwordx4 v[176:179], v4, s[8:11], s57 offen
buffer_load_dwordx4 v[180:183], v5, s[8:11], s57 offen
v_mfma_f32_16x16x32_bf16 v[16:19], v[220:223], v[204:207], v[16:19]
v_mfma_f32_16x16x32_bf16 v[36:39], v[220:223], v[208:211], v[36:39]
buffer_load_dwordx4 v[184:187], v6, s[8:11], s58 offen offset:0
v_mfma_f32_16x16x32_bf16 v[56:59], v[220:223], v[212:215], v[56:59]
v_mfma_f32_16x16x32_bf16 v[76:79], v[220:223], v[216:219], v[76:79]
buffer_load_dwordx4 v[188:191], v6, s[8:11], s58 offen offset:1024
v_mfma_f32_16x16x32_bf16 v[20:23], v[224:227], v[204:207], v[20:23]
v_mfma_f32_16x16x32_bf16 v[40:43], v[224:227], v[208:211], v[40:43]
buffer_load_dwordx4 v[192:195], v6, s[8:11], s58 offen offset:2048
v_mfma_f32_16x16x32_bf16 v[60:63], v[224:227], v[212:215], v[60:63]
v_mfma_f32_16x16x32_bf16 v[80:83], v[224:227], v[216:219], v[80:83]
buffer_load_dwordx4 v[196:199], v6, s[8:11], s58 offen offset:3072
v_mfma_f32_16x16x32_bf16 v[24:27], v[228:231], v[204:207], v[24:27]
v_mfma_f32_16x16x32_bf16 v[44:47], v[228:231], v[208:211], v[44:47]
buffer_load_dwordx4 v[200:203], v7, s[8:11], s58 offen
v_mfma_f32_16x16x32_bf16 v[64:67], v[228:231], v[212:215], v[64:67]
v_mfma_f32_16x16x32_bf16 v[84:87], v[228:231], v[216:219], v[84:87]
v_mfma_f32_16x16x32_bf16 v[28:31], v[232:235], v[204:207], v[28:31]
v_mfma_f32_16x16x32_bf16 v[48:51], v[232:235], v[208:211], v[48:51]
v_mfma_f32_16x16x32_bf16 v[68:71], v[232:235], v[212:215], v[68:71]
v_mfma_f32_16x16x32_bf16 v[88:91], v[232:235], v[216:219], v[88:91]
v_mfma_f32_16x16x32_bf16 v[32:35], v[236:239], v[204:207], v[32:35]
v_mfma_f32_16x16x32_bf16 v[52:55], v[236:239], v[208:211], v[52:55]
v_mfma_f32_16x16x32_bf16 v[72:75], v[236:239], v[212:215], v[72:75]
v_mfma_f32_16x16x32_bf16 v[92:95], v[236:239], v[216:219], v[92:95]
s_add_u32 s57, s57, 16384
s_add_u32 s58, s58, 20480
s_add_u32 s60, s60, 1
s_cmp_eq_u32 s60, 12
s_cselect_b32 s53, 196608, 0
s_cselect_b32 s54, 245760, 0
s_sub_u32 s57, s57, s53
s_sub_u32 s58, s58, s54
s_waitcnt lgkmcnt(0)
v_lshlrev_b32 v246, 16, v242
v_and_b32 v247, 0xffff0000, v242
v_lshlrev_b32 v242, 16, v244
v_and_b32 v244, 0xffff0000, v244
v_add_f32 v246, v246, v242
v_add_f32 v247, v247, v244
v_lshlrev_b32 v248, 16, v243
v_and_b32 v249, 0xffff0000, v243
v_lshlrev_b32 v243, 16, v245
v_and_b32 v245, 0xffff0000, v245
v_add_f32 v248, v248, v243
v_add_f32 v249, v249, v245
v_pk_add_f32 v[24:25], v[24:25], v[246:247]
v_pk_add_f32 v[26:27], v[26:27], v[248:249]
s_waitcnt vmcnt(18)
ds_read_b64 v[242:243], v8 offset:96
ds_read_b64 v[244:245], v250 offset:2656
buffer_load_dwordx4 v[204:207], v2, s[8:11], s57 offen
buffer_load_dwordx4 v[208:211], v3, s[8:11], s57 offen
buffer_load_dwordx4 v[212:215], v4, s[8:11], s57 offen
buffer_load_dwordx4 v[216:219], v5, s[8:11], s57 offen
v_mfma_f32_16x16x32_bf16 v[16:19], v[112:115], v[96:99], v[16:19]
v_mfma_f32_16x16x32_bf16 v[36:39], v[112:115], v[100:103], v[36:39]
buffer_load_dwordx4 v[220:223], v6, s[8:11], s58 offen offset:0
v_mfma_f32_16x16x32_bf16 v[56:59], v[112:115], v[104:107], v[56:59]
v_mfma_f32_16x16x32_bf16 v[76:79], v[112:115], v[108:111], v[76:79]
buffer_load_dwordx4 v[224:227], v6, s[8:11], s58 offen offset:1024
v_mfma_f32_16x16x32_bf16 v[20:23], v[116:119], v[96:99], v[20:23]
v_mfma_f32_16x16x32_bf16 v[40:43], v[116:119], v[100:103], v[40:43]
buffer_load_dwordx4 v[228:231], v6, s[8:11], s58 offen offset:2048
v_mfma_f32_16x16x32_bf16 v[60:63], v[116:119], v[104:107], v[60:63]
v_mfma_f32_16x16x32_bf16 v[80:83], v[116:119], v[108:111], v[80:83]
buffer_load_dwordx4 v[232:235], v6, s[8:11], s58 offen offset:3072
v_mfma_f32_16x16x32_bf16 v[24:27], v[120:123], v[96:99], v[24:27]
v_mfma_f32_16x16x32_bf16 v[44:47], v[120:123], v[100:103], v[44:47]
buffer_load_dwordx4 v[236:239], v7, s[8:11], s58 offen
v_mfma_f32_16x16x32_bf16 v[64:67], v[120:123], v[104:107], v[64:67]
v_mfma_f32_16x16x32_bf16 v[84:87], v[120:123], v[108:111], v[84:87]
v_mfma_f32_16x16x32_bf16 v[28:31], v[124:127], v[96:99], v[28:31]
v_mfma_f32_16x16x32_bf16 v[48:51], v[124:127], v[100:103], v[48:51]
v_mfma_f32_16x16x32_bf16 v[68:71], v[124:127], v[104:107], v[68:71]
v_mfma_f32_16x16x32_bf16 v[88:91], v[124:127], v[108:111], v[88:91]
v_mfma_f32_16x16x32_bf16 v[32:35], v[128:131], v[96:99], v[32:35]
v_mfma_f32_16x16x32_bf16 v[52:55], v[128:131], v[100:103], v[52:55]
v_mfma_f32_16x16x32_bf16 v[72:75], v[128:131], v[104:107], v[72:75]
v_mfma_f32_16x16x32_bf16 v[92:95], v[128:131], v[108:111], v[92:95]
s_add_u32 s57, s57, 16384
s_add_u32 s58, s58, 20480
s_add_u32 s60, s60, 1
s_cmp_eq_u32 s60, 12
s_cselect_b32 s53, 196608, 0
s_cselect_b32 s54, 245760, 0
s_sub_u32 s57, s57, s53
s_sub_u32 s58, s58, s54
s_waitcnt lgkmcnt(0)
v_lshlrev_b32 v246, 16, v242
v_and_b32 v247, 0xffff0000, v242
v_lshlrev_b32 v242, 16, v244
v_and_b32 v244, 0xffff0000, v244
v_add_f32 v246, v246, v242
v_add_f32 v247, v247, v244
v_lshlrev_b32 v248, 16, v243
v_and_b32 v249, 0xffff0000, v243
v_lshlrev_b32 v243, 16, v245
v_and_b32 v245, 0xffff0000, v245
v_add_f32 v248, v248, v243
v_add_f32 v249, v249, v245
v_pk_add_f32 v[28:29], v[28:29], v[246:247]
v_pk_add_f32 v[30:31], v[30:31], v[248:249]
s_waitcnt vmcnt(18)
s_add_u32 s57, s61, 196608
s_add_u32 s58, s62, 245760
ds_read_b64 v[242:243], v8 offset:128
ds_read_b64 v[244:245], v250 offset:2688
buffer_load_dwordx4 v[112:115], v6, s[8:11], s58 offen offset:0
buffer_load_dwordx4 v[116:119], v6, s[8:11], s58 offen offset:1024
buffer_load_dwordx4 v[120:123], v6, s[8:11], s58 offen offset:2048
buffer_load_dwordx4 v[124:127], v6, s[8:11], s58 offen offset:3072
v_mfma_f32_16x16x32_bf16 v[16:19], v[148:151], v[132:135], v[16:19]
v_mfma_f32_16x16x32_bf16 v[36:39], v[148:151], v[136:139], v[36:39]
buffer_load_dwordx4 v[128:131], v7, s[8:11], s58 offen
v_mfma_f32_16x16x32_bf16 v[56:59], v[148:151], v[140:143], v[56:59]
v_mfma_f32_16x16x32_bf16 v[76:79], v[148:151], v[144:147], v[76:79]
buffer_load_dwordx4 v[96:99], v2, s[8:11], s57 offen sc1
v_mfma_f32_16x16x32_bf16 v[20:23], v[152:155], v[132:135], v[20:23]
v_mfma_f32_16x16x32_bf16 v[40:43], v[152:155], v[136:139], v[40:43]
buffer_load_dwordx4 v[100:103], v3, s[8:11], s57 offen sc1
v_mfma_f32_16x16x32_bf16 v[60:63], v[152:155], v[140:143], v[60:63]
v_mfma_f32_16x16x32_bf16 v[80:83], v[152:155], v[144:147], v[80:83]
buffer_load_dwordx4 v[104:107], v4, s[8:11], s57 offen sc1
v_mfma_f32_16x16x32_bf16 v[24:27], v[156:159], v[132:135], v[24:27]
v_mfma_f32_16x16x32_bf16 v[44:47], v[156:159], v[136:139], v[44:47]
buffer_load_dwordx4 v[108:111], v5, s[8:11], s57 offen sc1
v_mfma_f32_16x16x32_bf16 v[64:67], v[156:159], v[140:143], v[64:67]
v_mfma_f32_16x16x32_bf16 v[84:87], v[156:159], v[144:147], v[84:87]
v_mfma_f32_16x16x32_bf16 v[28:31], v[160:163], v[132:135], v[28:31]
v_mfma_f32_16x16x32_bf16 v[48:51], v[160:163], v[136:139], v[48:51]
v_mfma_f32_16x16x32_bf16 v[68:71], v[160:163], v[140:143], v[68:71]
v_mfma_f32_16x16x32_bf16 v[88:91], v[160:163], v[144:147], v[88:91]
v_mfma_f32_16x16x32_bf16 v[32:35], v[164:167], v[132:135], v[32:35]
v_mfma_f32_16x16x32_bf16 v[52:55], v[164:167], v[136:139], v[52:55]
v_mfma_f32_16x16x32_bf16 v[72:75], v[164:167], v[140:143], v[72:75]
v_mfma_f32_16x16x32_bf16 v[92:95], v[164:167], v[144:147], v[92:95]
s_add_u32 s57, s57, 16384
s_add_u32 s58, s58, 20480
s_waitcnt lgkmcnt(0)
v_lshlrev_b32 v246, 16, v242
v_and_b32 v247, 0xffff0000, v242
v_lshlrev_b32 v242, 16, v244
v_and_b32 v244, 0xffff0000, v244
v_add_f32 v246, v246, v242
v_add_f32 v247, v247, v244
v_lshlrev_b32 v248, 16, v243
v_and_b32 v249, 0xffff0000, v243
v_lshlrev_b32 v243, 16, v245
v_and_b32 v245, 0xffff0000, v245
v_add_f32 v248, v248, v243
v_add_f32 v249, v249, v245
v_pk_add_f32 v[32:33], v[32:33], v[246:247]
v_pk_add_f32 v[34:35], v[34:35], v[248:249]
s_waitcnt vmcnt(18)
buffer_load_dwordx4 v[148:151], v6, s[8:11], s58 offen offset:0
buffer_load_dwordx4 v[152:155], v6, s[8:11], s58 offen offset:1024
buffer_load_dwordx4 v[156:159], v6, s[8:11], s58 offen offset:2048
buffer_load_dwordx4 v[160:163], v6, s[8:11], s58 offen offset:3072
v_mfma_f32_16x16x32_bf16 v[16:19], v[184:187], v[168:171], v[16:19]
v_mfma_f32_16x16x32_bf16 v[36:39], v[184:187], v[172:175], v[36:39]
buffer_load_dwordx4 v[164:167], v7, s[8:11], s58 offen
v_mfma_f32_16x16x32_bf16 v[56:59], v[184:187], v[176:179], v[56:59]
v_mfma_f32_16x16x32_bf16 v[76:79], v[184:187], v[180:183], v[76:79]
buffer_load_dwordx4 v[132:135], v2, s[8:11], s57 offen sc1
v_mfma_f32_16x16x32_bf16 v[20:23], v[188:191], v[168:171], v[20:23]
v_mfma_f32_16x16x32_bf16 v[40:43], v[188:191], v[172:175], v[40:43]
buffer_load_dwordx4 v[136:139], v3, s[8:11], s57 offen sc1
v_mfma_f32_16x16x32_bf16 v[60:63], v[188:191], v[176:179], v[60:63]
v_mfma_f32_16x16x32_bf16 v[80:83], v[188:191], v[180:183], v[80:83]
buffer_load_dwordx4 v[140:143], v4, s[8:11], s57 offen sc1
v_mfma_f32_16x16x32_bf16 v[24:27], v[192:195], v[168:171], v[24:27]
v_mfma_f32_16x16x32_bf16 v[44:47], v[192:195], v[172:175], v[44:47]
buffer_load_dwordx4 v[144:147], v5, s[8:11], s57 offen sc1
v_mfma_f32_16x16x32_bf16 v[64:67], v[192:195], v[176:179], v[64:67]
v_mfma_f32_16x16x32_bf16 v[84:87], v[192:195], v[180:183], v[84:87]
v_mfma_f32_16x16x32_bf16 v[28:31], v[196:199], v[168:171], v[28:31]
v_mfma_f32_16x16x32_bf16 v[48:51], v[196:199], v[172:175], v[48:51]
v_mfma_f32_16x16x32_bf16 v[68:71], v[196:199], v[176:179], v[68:71]
v_mfma_f32_16x16x32_bf16 v[88:91], v[196:199], v[180:183], v[88:91]
v_mfma_f32_16x16x32_bf16 v[32:35], v[200:203], v[168:171], v[32:35]
v_mfma_f32_16x16x32_bf16 v[52:55], v[200:203], v[172:175], v[52:55]
v_mfma_f32_16x16x32_bf16 v[72:75], v[200:203], v[176:179], v[72:75]
v_mfma_f32_16x16x32_bf16 v[92:95], v[200:203], v[180:183], v[92:95]
s_add_u32 s57, s57, 16384
s_add_u32 s58, s58, 20480
s_waitcnt vmcnt(18)
buffer_load_dwordx4 v[184:187], v6, s[8:11], s58 offen offset:0
buffer_load_dwordx4 v[188:191], v6, s[8:11], s58 offen offset:1024
buffer_load_dwordx4 v[192:195], v6, s[8:11], s58 offen offset:2048
buffer_load_dwordx4 v[196:199], v6, s[8:11], s58 offen offset:3072
v_mfma_f32_16x16x32_bf16 v[16:19], v[220:223], v[204:207], v[16:19]
v_mfma_f32_16x16x32_bf16 v[36:39], v[220:223], v[208:211], v[36:39]
buffer_load_dwordx4 v[200:203], v7, s[8:11], s58 offen
v_mfma_f32_16x16x32_bf16 v[56:59], v[220:223], v[212:215], v[56:59]
v_mfma_f32_16x16x32_bf16 v[76:79], v[220:223], v[216:219], v[76:79]
buffer_load_dwordx4 v[168:171], v2, s[8:11], s57 offen sc1
v_mfma_f32_16x16x32_bf16 v[20:23], v[224:227], v[204:207], v[20:23]
v_mfma_f32_16x16x32_bf16 v[40:43], v[224:227], v[208:211], v[40:43]
buffer_load_dwordx4 v[172:175], v3, s[8:11], s57 offen sc1
v_mfma_f32_16x16x32_bf16 v[60:63], v[224:227], v[212:215], v[60:63]
v_mfma_f32_16x16x32_bf16 v[80:83], v[224:227], v[216:219], v[80:83]
buffer_load_dwordx4 v[176:179], v4, s[8:11], s57 offen sc1
v_mfma_f32_16x16x32_bf16 v[24:27], v[228:231], v[204:207], v[24:27]
v_mfma_f32_16x16x32_bf16 v[44:47], v[228:231], v[208:211], v[44:47]
buffer_load_dwordx4 v[180:183], v5, s[8:11], s57 offen sc1
v_mfma_f32_16x16x32_bf16 v[64:67], v[228:231], v[212:215], v[64:67]
v_mfma_f32_16x16x32_bf16 v[84:87], v[228:231], v[216:219], v[84:87]
v_mfma_f32_16x16x32_bf16 v[28:31], v[232:235], v[204:207], v[28:31]
v_mfma_f32_16x16x32_bf16 v[48:51], v[232:235], v[208:211], v[48:51]
v_mfma_f32_16x16x32_bf16 v[68:71], v[232:235], v[212:215], v[68:71]
v_mfma_f32_16x16x32_bf16 v[88:91], v[232:235], v[216:219], v[88:91]
v_mfma_f32_16x16x32_bf16 v[32:35], v[236:239], v[204:207], v[32:35]
v_mfma_f32_16x16x32_bf16 v[52:55], v[236:239], v[208:211], v[52:55]
v_mfma_f32_16x16x32_bf16 v[72:75], v[236:239], v[212:215], v[72:75]
v_mfma_f32_16x16x32_bf16 v[92:95], v[236:239], v[216:219], v[92:95]
s_add_u32 s57, s57, 16384
s_add_u32 s58, s58, 20480
s_waitcnt vmcnt(18)
L_k2_chk12:
v_max3_u32 v240, v96, v97, v98
v_max3_u32 v241, v104, v105, v106
v_max3_u32 v240, v240, v99, v100
v_max3_u32 v241, v241, v107, v108
v_max3_u32 v240, v240, v101, v102
v_max3_u32 v241, v241, v109, v110
v_max3_u32 v240, v240, v103, v111
v_max_u32 v240, v240, v241
v_cmp_eq_u32 vcc, -1, v240
s_nop 4
s_cbranch_vccz L_k2_ok12
s_add_u32 s64, s61, 196608
buffer_load_dwordx4 v[96:99], v2, s[8:11], s64 offen sc1
buffer_load_dwordx4 v[100:103], v3, s[8:11], s64 offen sc1
buffer_load_dwordx4 v[104:107], v4, s[8:11], s64 offen sc1
buffer_load_dwordx4 v[108:111], v5, s[8:11], s64 offen sc1
s_add_u32 s64, s61, 212992
buffer_load_dwordx4 v[132:135], v2, s[8:11], s64 offen sc1
buffer_load_dwordx4 v[136:139], v3, s[8:11], s64 offen sc1
buffer_load_dwordx4 v[140:143], v4, s[8:11], s64 offen sc1
buffer_load_dwordx4 v[144:147], v5, s[8:11], s64 offen sc1
s_add_u32 s64, s61, 229376
buffer_load_dwordx4 v[168:171], v2, s[8:11], s64 offen sc1
buffer_load_dwordx4 v[172:175], v3, s[8:11], s64 offen sc1
buffer_load_dwordx4 v[176:179], v4, s[8:11], s64 offen sc1
buffer_load_dwordx4 v[180:183], v5, s[8:11], s64 offen sc1
s_waitcnt vmcnt(0)
s_branch L_k2_chk12
L_k2_ok12:
buffer_load_dwordx4 v[220:223], v6, s[8:11], s58 offen offset:0
buffer_load_dwordx4 v[224:227], v6, s[8:11], s58 offen offset:1024
buffer_load_dwordx4 v[228:231], v6, s[8:11], s58 offen offset:2048
buffer_load_dwordx4 v[232:235], v6, s[8:11], s58 offen offset:3072
v_mfma_f32_16x16x32_bf16 v[16:19], v[112:115], v[96:99], v[16:19]
v_mfma_f32_16x16x32_bf16 v[36:39], v[112:115], v[100:103], v[36:39]
buffer_load_dwordx4 v[236:239], v7, s[8:11], s58 offen
v_mfma_f32_16x16x32_bf16 v[56:59], v[112:115], v[104:107], v[56:59]
v_mfma_f32_16x16x32_bf16 v[76:79], v[112:115], v[108:111], v[76:79]
buffer_load_dwordx4 v[204:207], v2, s[8:11], s57 offen sc1
v_mfma_f32_16x16x32_bf16 v[20:23], v[116:119], v[96:99], v[20:23]
v_mfma_f32_16x16x32_bf16 v[40:43], v[116:119], v[100:103], v[40:43]
buffer_load_dwordx4 v[208:211], v3, s[8:11], s57 offen sc1
v_mfma_f32_16x16x32_bf16 v[60:63], v[116:119], v[104:107], v[60:63]
v_mfma_f32_16x16x32_bf16 v[80:83], v[116:119], v[108:111], v[80:83]
buffer_load_dwordx4 v[212:215], v4, s[8:11], s57 offen sc1
v_mfma_f32_16x16x32_bf16 v[24:27], v[120:123], v[96:99], v[24:27]
v_mfma_f32_16x16x32_bf16 v[44:47], v[120:123], v[100:103], v[44:47]
buffer_load_dwordx4 v[216:219], v5, s[8:11], s57 offen sc1
v_mfma_f32_16x16x32_bf16 v[64:67], v[120:123], v[104:107], v[64:67]
v_mfma_f32_16x16x32_bf16 v[84:87], v[120:123], v[108:111], v[84:87]
v_mfma_f32_16x16x32_bf16 v[28:31], v[124:127], v[96:99], v[28:31]
v_mfma_f32_16x16x32_bf16 v[48:51], v[124:127], v[100:103], v[48:51]
v_mfma_f32_16x16x32_bf16 v[68:71], v[124:127], v[104:107], v[68:71]
v_mfma_f32_16x16x32_bf16 v[88:91], v[124:127], v[108:111], v[88:91]
v_mfma_f32_16x16x32_bf16 v[32:35], v[128:131], v[96:99], v[32:35]
v_mfma_f32_16x16x32_bf16 v[52:55], v[128:131], v[100:103], v[52:55]
v_mfma_f32_16x16x32_bf16 v[72:75], v[128:131], v[104:107], v[72:75]
v_mfma_f32_16x16x32_bf16 v[92:95], v[128:131], v[108:111], v[92:95]
s_add_u32 s57, s57, 16384
s_add_u32 s58, s58, 20480
s_waitcnt vmcnt(18)
L_k2_chk13:
v_max3_u32 v240, v132, v133, v134
v_max3_u32 v241, v140, v141, v142
v_max3_u32 v240, v240, v135, v136
v_max3_u32 v241, v241, v143, v144
v_max3_u32 v240, v240, v137, v138
v_max3_u32 v241, v241, v145, v146
v_max3_u32 v240, v240, v139, v147
v_max_u32 v240, v240, v241
v_cmp_eq_u32 vcc, -1, v240
s_nop 4
s_cbranch_vccz L_k2_ok13
s_add_u32 s64, s61, 212992
buffer_load_dwordx4 v[132:135], v2, s[8:11], s64 offen sc1
buffer_load_dwordx4 v[136:139], v3, s[8:11], s64 offen sc1
buffer_load_dwordx4 v[140:143], v4, s[8:11], s64 offen sc1
buffer_load_dwordx4 v[144:147], v5, s[8:11], s64 offen sc1
s_add_u32 s64, s61, 229376
buffer_load_dwordx4 v[168:171], v2, s[8:11], s64 offen sc1
buffer_load_dwordx4 v[172:175], v3, s[8:11], s64 offen sc1
buffer_load_dwordx4 v[176:179], v4, s[8:11], s64 offen sc1
buffer_load_dwordx4 v[180:183], v5, s[8:11], s64 offen sc1
s_add_u32 s64, s61, 245760
buffer_load_dwordx4 v[204:207], v2, s[8:11], s64 offen sc1
buffer_load_dwordx4 v[208:211], v3, s[8:11], s64 offen sc1
buffer_load_dwordx4 v[212:215], v4, s[8:11], s64 offen sc1
buffer_load_dwordx4 v[216:219], v5, s[8:11], s64 offen sc1
s_waitcnt vmcnt(0)
s_branch L_k2_chk13
L_k2_ok13:
buffer_load_dwordx4 v[112:115], v6, s[8:11], s58 offen offset:0
buffer_load_dwordx4 v[116:119], v6, s[8:11], s58 offen offset:1024
buffer_load_dwordx4 v[120:123], v6, s[8:11], s58 offen offset:2048
buffer_load_dwordx4 v[124:127], v6, s[8:11], s58 offen offset:3072
v_mfma_f32_16x16x32_bf16 v[16:19], v[148:151], v[132:135], v[16:19]
v_mfma_f32_16x16x32_bf16 v[36:39], v[148:151], v[136:139], v[36:39]
buffer_load_dwordx4 v[128:131], v7, s[8:11], s58 offen
v_mfma_f32_16x16x32_bf16 v[56:59], v[148:151], v[140:143], v[56:59]
v_mfma_f32_16x16x32_bf16 v[76:79], v[148:151], v[144:147], v[76:79]
buffer_load_dwordx4 v[96:99], v2, s[8:11], s57 offen sc1
v_mfma_f32_16x16x32_bf16 v[20:23], v[152:155], v[132:135], v[20:23]
v_mfma_f32_16x16x32_bf16 v[40:43], v[152:155], v[136:139], v[40:43]
buffer_load_dwordx4 v[100:103], v3, s[8:11], s57 offen sc1
v_mfma_f32_16x16x32_bf16 v[60:63], v[152:155], v[140:143], v[60:63]
v_mfma_f32_16x16x32_bf16 v[80:83], v[152:155], v[144:147], v[80:83]
buffer_load_dwordx4 v[104:107], v4, s[8:11], s57 offen sc1
v_mfma_f32_16x16x32_bf16 v[24:27], v[156:159], v[132:135], v[24:27]
v_mfma_f32_16x16x32_bf16 v[44:47], v[156:159], v[136:139], v[44:47]
buffer_load_dwordx4 v[108:111], v5, s[8:11], s57 offen sc1
v_mfma_f32_16x16x32_bf16 v[64:67], v[156:159], v[140:143], v[64:67]
v_mfma_f32_16x16x32_bf16 v[84:87], v[156:159], v[144:147], v[84:87]
v_mfma_f32_16x16x32_bf16 v[28:31], v[160:163], v[132:135], v[28:31]
v_mfma_f32_16x16x32_bf16 v[48:51], v[160:163], v[136:139], v[48:51]
v_mfma_f32_16x16x32_bf16 v[68:71], v[160:163], v[140:143], v[68:71]
v_mfma_f32_16x16x32_bf16 v[88:91], v[160:163], v[144:147], v[88:91]
v_mfma_f32_16x16x32_bf16 v[32:35], v[164:167], v[132:135], v[32:35]
v_mfma_f32_16x16x32_bf16 v[52:55], v[164:167], v[136:139], v[52:55]
v_mfma_f32_16x16x32_bf16 v[72:75], v[164:167], v[140:143], v[72:75]
v_mfma_f32_16x16x32_bf16 v[92:95], v[164:167], v[144:147], v[92:95]
s_add_u32 s57, s57, 16384
s_add_u32 s58, s58, 20480
s_waitcnt vmcnt(18)
L_k2_chk14:
v_max3_u32 v240, v168, v169, v170
v_max3_u32 v241, v176, v177, v178
v_max3_u32 v240, v240, v171, v172
v_max3_u32 v241, v241, v179, v180
v_max3_u32 v240, v240, v173, v174
v_max3_u32 v241, v241, v181, v182
v_max3_u32 v240, v240, v175, v183
v_max_u32 v240, v240, v241
v_cmp_eq_u32 vcc, -1, v240
s_nop 4
s_cbranch_vccz L_k2_ok14
s_add_u32 s64, s61, 229376
buffer_load_dwordx4 v[168:171], v2, s[8:11], s64 offen sc1
buffer_load_dwordx4 v[172:175], v3, s[8:11], s64 offen sc1
buffer_load_dwordx4 v[176:179], v4, s[8:11], s64 offen sc1
buffer_load_dwordx4 v[180:183], v5, s[8:11], s64 offen sc1
s_add_u32 s64, s61, 245760
buffer_load_dwordx4 v[204:207], v2, s[8:11], s64 offen sc1
buffer_load_dwordx4 v[208:211], v3, s[8:11], s64 offen sc1
buffer_load_dwordx4 v[212:215], v4, s[8:11], s64 offen sc1
buffer_load_dwordx4 v[216:219], v5, s[8:11], s64 offen sc1
s_add_u32 s64, s61, 262144
buffer_load_dwordx4 v[96:99], v2, s[8:11], s64 offen sc1
buffer_load_dwordx4 v[100:103], v3, s[8:11], s64 offen sc1
buffer_load_dwordx4 v[104:107], v4, s[8:11], s64 offen sc1
buffer_load_dwordx4 v[108:111], v5, s[8:11], s64 offen sc1
s_waitcnt vmcnt(0)
s_branch L_k2_chk14
L_k2_ok14:
v_mfma_f32_16x16x32_bf16 v[16:19], v[184:187], v[168:171], v[16:19]
v_mfma_f32_16x16x32_bf16 v[36:39], v[184:187], v[172:175], v[36:39]
v_mfma_f32_16x16x32_bf16 v[56:59], v[184:187], v[176:179], v[56:59]
v_mfma_f32_16x16x32_bf16 v[76:79], v[184:187], v[180:183], v[76:79]
v_mfma_f32_16x16x32_bf16 v[20:23], v[188:191], v[168:171], v[20:23]
v_mfma_f32_16x16x32_bf16 v[40:43], v[188:191], v[172:175], v[40:43]
v_mfma_f32_16x16x32_bf16 v[60:63], v[188:191], v[176:179], v[60:63]
v_mfma_f32_16x16x32_bf16 v[80:83], v[188:191], v[180:183], v[80:83]
v_mfma_f32_16x16x32_bf16 v[24:27], v[192:195], v[168:171], v[24:27]
v_mfma_f32_16x16x32_bf16 v[44:47], v[192:195], v[172:175], v[44:47]
v_mfma_f32_16x16x32_bf16 v[64:67], v[192:195], v[176:179], v[64:67]
v_mfma_f32_16x16x32_bf16 v[84:87], v[192:195], v[180:183], v[84:87]
v_mfma_f32_16x16x32_bf16 v[28:31], v[196:199], v[168:171], v[28:31]
v_mfma_f32_16x16x32_bf16 v[48:51], v[196:199], v[172:175], v[48:51]
v_mfma_f32_16x16x32_bf16 v[68:71], v[196:199], v[176:179], v[68:71]
v_mfma_f32_16x16x32_bf16 v[88:91], v[196:199], v[180:183], v[88:91]
v_mfma_f32_16x16x32_bf16 v[32:35], v[200:203], v[168:171], v[32:35]
v_mfma_f32_16x16x32_bf16 v[52:55], v[200:203], v[172:175], v[52:55]
v_mfma_f32_16x16x32_bf16 v[72:75], v[200:203], v[176:179], v[72:75]
v_mfma_f32_16x16x32_bf16 v[92:95], v[200:203], v[180:183], v[92:95]
s_waitcnt vmcnt(9)
L_k2_chk15:
v_max3_u32 v240, v204, v205, v206
v_max3_u32 v241, v212, v213, v214
v_max3_u32 v240, v240, v207, v208
v_max3_u32 v241, v241, v215, v216
v_max3_u32 v240, v240, v209, v210
v_max3_u32 v241, v241, v217, v218
v_max3_u32 v240, v240, v211, v219
v_max_u32 v240, v240, v241
v_cmp_eq_u32 vcc, -1, v240
s_nop 4
s_cbranch_vccz L_k2_ok15
s_add_u32 s64, s61, 245760
buffer_load_dwordx4 v[204:207], v2, s[8:11], s64 offen sc1
buffer_load_dwordx4 v[208:211], v3, s[8:11], s64 offen sc1
buffer_load_dwordx4 v[212:215], v4, s[8:11], s64 offen sc1
buffer_load_dwordx4 v[216:219], v5, s[8:11], s64 offen sc1
s_add_u32 s64, s61, 262144
buffer_load_dwordx4 v[96:99], v2, s[8:11], s64 offen sc1
buffer_load_dwordx4 v[100:103], v3, s[8:11], s64 offen sc1
buffer_load_dwordx4 v[104:107], v4, s[8:11], s64 offen sc1
buffer_load_dwordx4 v[108:111], v5, s[8:11], s64 offen sc1
s_waitcnt vmcnt(0)
s_branch L_k2_chk15
L_k2_ok15:
v_mfma_f32_16x16x32_bf16 v[16:19], v[220:223], v[204:207], v[16:19]
v_mfma_f32_16x16x32_bf16 v[36:39], v[220:223], v[208:211], v[36:39]
v_mfma_f32_16x16x32_bf16 v[56:59], v[220:223], v[212:215], v[56:59]
v_mfma_f32_16x16x32_bf16 v[76:79], v[220:223], v[216:219], v[76:79]
v_mfma_f32_16x16x32_bf16 v[20:23], v[224:227], v[204:207], v[20:23]
v_mfma_f32_16x16x32_bf16 v[40:43], v[224:227], v[208:211], v[40:43]
v_mfma_f32_16x16x32_bf16 v[60:63], v[224:227], v[212:215], v[60:63]
v_mfma_f32_16x16x32_bf16 v[80:83], v[224:227], v[216:219], v[80:83]
v_mfma_f32_16x16x32_bf16 v[24:27], v[228:231], v[204:207], v[24:27]
v_mfma_f32_16x16x32_bf16 v[44:47], v[228:231], v[208:211], v[44:47]
v_mfma_f32_16x16x32_bf16 v[64:67], v[228:231], v[212:215], v[64:67]
v_mfma_f32_16x16x32_bf16 v[84:87], v[228:231], v[216:219], v[84:87]
v_mfma_f32_16x16x32_bf16 v[28:31], v[232:235], v[204:207], v[28:31]
v_mfma_f32_16x16x32_bf16 v[48:51], v[232:235], v[208:211], v[48:51]
v_mfma_f32_16x16x32_bf16 v[68:71], v[232:235], v[212:215], v[68:71]
v_mfma_f32_16x16x32_bf16 v[88:91], v[232:235], v[216:219], v[88:91]
v_mfma_f32_16x16x32_bf16 v[32:35], v[236:239], v[204:207], v[32:35]
v_mfma_f32_16x16x32_bf16 v[52:55], v[236:239], v[208:211], v[52:55]
v_mfma_f32_16x16x32_bf16 v[72:75], v[236:239], v[212:215], v[72:75]
v_mfma_f32_16x16x32_bf16 v[92:95], v[236:239], v[216:219], v[92:95]
s_waitcnt vmcnt(0)
L_k2_chk16:
v_max3_u32 v240, v96, v97, v98
v_max3_u32 v241, v104, v105, v106
v_max3_u32 v240, v240, v99, v100
v_max3_u32 v241, v241, v107, v108
v_max3_u32 v240, v240, v101, v102
v_max3_u32 v241, v241, v109, v110
v_max3_u32 v240, v240, v103, v111
v_max_u32 v240, v240, v241
v_cmp_eq_u32 vcc, -1, v240
s_nop 4
s_cbranch_vccz L_k2_ok16
s_add_u32 s64, s61, 262144
buffer_load_dwordx4 v[96:99], v2, s[8:11], s64 offen sc1
buffer_load_dwordx4 v[100:103], v3, s[8:11], s64 offen sc1
buffer_load_dwordx4 v[104:107], v4, s[8:11], s64 offen sc1
buffer_load_dwordx4 v[108:111], v5, s[8:11], s64 offen sc1
s_waitcnt vmcnt(0)
s_branch L_k2_chk16
L_k2_ok16:
v_mfma_f32_16x16x32_bf16 v[36:39], v[112:115], v[100:103], v[36:39]
v_mfma_f32_16x16x32_bf16 v[40:43], v[116:119], v[100:103], v[40:43]
v_mfma_f32_16x16x32_bf16 v[44:47], v[120:123], v[100:103], v[44:47]
v_mfma_f32_16x16x32_bf16 v[48:51], v[124:127], v[100:103], v[48:51]
v_mfma_f32_16x16x32_bf16 v[52:55], v[128:131], v[100:103], v[52:55]
v_mfma_f32_16x16x32_bf16 v[56:59], v[112:115], v[104:107], v[56:59]
v_mfma_f32_16x16x32_bf16 v[60:63], v[116:119], v[104:107], v[60:63]
v_mfma_f32_16x16x32_bf16 v[64:67], v[120:123], v[104:107], v[64:67]
v_mfma_f32_16x16x32_bf16 v[68:71], v[124:127], v[104:107], v[68:71]
v_mfma_f32_16x16x32_bf16 v[72:75], v[128:131], v[104:107], v[72:75]
ds_write_b128 v9, v[36:39] offset:0
ds_write_b128 v9, v[40:43] offset:1024
ds_write_b128 v9, v[44:47] offset:2048
ds_write_b128 v9, v[48:51] offset:3072
ds_write_b128 v9, v[52:55] offset:4096
v_mfma_f32_16x16x32_bf16 v[76:79], v[112:115], v[108:111], v[76:79]
v_mfma_f32_16x16x32_bf16 v[80:83], v[116:119], v[108:111], v[80:83]
v_mfma_f32_16x16x32_bf16 v[84:87], v[120:123], v[108:111], v[84:87]
v_mfma_f32_16x16x32_bf16 v[88:91], v[124:127], v[108:111], v[88:91]
v_mfma_f32_16x16x32_bf16 v[92:95], v[128:131], v[108:111], v[92:95]
ds_write_b128 v10, v[56:59] offset:0
ds_write_b128 v10, v[60:63] offset:1024
ds_write_b128 v10, v[64:67] offset:2048
ds_write_b128 v10, v[68:71] offset:3072
ds_write_b128 v10, v[72:75] offset:4096
v_mfma_f32_16x16x32_bf16 v[16:19], v[112:115], v[96:99], v[16:19]
v_mfma_f32_16x16x32_bf16 v[20:23], v[116:119], v[96:99], v[20:23]
v_mfma_f32_16x16x32_bf16 v[24:27], v[120:123], v[96:99], v[24:27]
v_mfma_f32_16x16x32_bf16 v[28:31], v[124:127], v[96:99], v[28:31]
v_mfma_f32_16x16x32_bf16 v[32:35], v[128:131], v[96:99], v[32:35]
ds_write_b128 v11, v[76:79] offset:0
ds_write_b128 v11, v[80:83] offset:1024
ds_write_b128 v11, v[84:87] offset:2048
ds_write_b128 v11, v[88:91] offset:3072
ds_write_b128 v11, v[92:95] offset:4096
s_mul_i32 s54, s36, 15360
v_add_u32 v7, s54, v6
s_waitcnt lgkmcnt(0)
s_barrier
ds_read_b128 v[96:99], v7 offset:0
ds_read_b128 v[100:103], v7 offset:1024
ds_read_b128 v[104:107], v7 offset:2048
ds_read_b128 v[108:111], v7 offset:3072
ds_read_b128 v[112:115], v7 offset:4096
ds_read_b128 v[116:119], v7 offset:5120
ds_read_b128 v[120:123], v7 offset:6144
ds_read_b128 v[124:127], v7 offset:7168
ds_read_b128 v[128:131], v7 offset:8192
ds_read_b128 v[132:135], v7 offset:9216
ds_read_b128 v[136:139], v7 offset:10240
ds_read_b128 v[140:143], v7 offset:11264
ds_read_b128 v[144:147], v7 offset:12288
ds_read_b128 v[148:151], v7 offset:13312
ds_read_b128 v[152:155], v7 offset:14336
s_waitcnt lgkmcnt(10)
v_pk_add_f32 v[16:17], v[16:17], v[96:97]
v_pk_add_f32 v[18:19], v[18:19], v[98:99]
v_pk_add_f32 v[20:21], v[20:21], v[100:101]
v_pk_add_f32 v[22:23], v[22:23], v[102:103]
v_pk_add_f32 v[24:25], v[24:25], v[104:105]
v_pk_add_f32 v[26:27], v[26:27], v[106:107]
v_pk_add_f32 v[28:29], v[28:29], v[108:109]
v_pk_add_f32 v[30:31], v[30:31], v[110:111]
v_pk_add_f32 v[32:33], v[32:33], v[112:113]
v_pk_add_f32 v[34:35], v[34:35], v[114:115]
s_waitcnt lgkmcnt(5)
v_pk_add_f32 v[16:17], v[16:17], v[116:117]
v_pk_add_f32 v[18:19], v[18:19], v[118:119]
v_pk_add_f32 v[20:21], v[20:21], v[120:121]
v_pk_add_f32 v[22:23], v[22:23], v[122:123]
v_pk_add_f32 v[24:25], v[24:25], v[124:125]
v_pk_add_f32 v[26:27], v[26:27], v[126:127]
v_pk_add_f32 v[28:29], v[28:29], v[128:129]
v_pk_add_f32 v[30:31], v[30:31], v[130:131]
v_pk_add_f32 v[32:33], v[32:33], v[132:133]
v_pk_add_f32 v[34:35], v[34:35], v[134:135]
s_waitcnt lgkmcnt(0)
v_pk_add_f32 v[16:17], v[16:17], v[136:137]
v_pk_add_f32 v[18:19], v[18:19], v[138:139]
v_pk_add_f32 v[20:21], v[20:21], v[140:141]
v_pk_add_f32 v[22:23], v[22:23], v[142:143]
v_pk_add_f32 v[24:25], v[24:25], v[144:145]
v_pk_add_f32 v[26:27], v[26:27], v[146:147]
v_pk_add_f32 v[28:29], v[28:29], v[148:149]
v_pk_add_f32 v[30:31], v[30:31], v[150:151]
v_pk_add_f32 v[32:33], v[32:33], v[152:153]
v_pk_add_f32 v[34:35], v[34:35], v[154:155]
v_cvt_pk_bf16_f32 v160, v16, v17
v_cvt_pk_bf16_f32 v161, v18, v19
v_cvt_pk_bf16_f32 v162, v20, v21
v_cvt_pk_bf16_f32 v163, v22, v23
v_cvt_pk_bf16_f32 v164, v24, v25
v_cvt_pk_bf16_f32 v165, v26, v27
v_cvt_pk_bf16_f32 v166, v28, v29
v_cvt_pk_bf16_f32 v167, v30, v31
v_cvt_pk_bf16_f32 v168, v32, v33
v_cvt_pk_bf16_f32 v169, v34, v35
ds_write_b64 v8, v[160:161] offset:0
ds_write_b64 v8, v[162:163] offset:32
ds_write_b64 v8, v[164:165] offset:64
ds_write_b64 v8, v[166:167] offset:96
ds_write_b64 v8, v[168:169] offset:128
s_waitcnt lgkmcnt(0)
ds_read_b128 v[96:99], v15 offset:0
ds_read_b128 v[100:103], v15 offset:1024
ds_read_b128 v[104:107], v15 offset:2048
s_waitcnt lgkmcnt(2)
buffer_store_dwordx4 v[96:99], v12, s[48:51], s59 offen nt
s_waitcnt lgkmcnt(1)
buffer_store_dwordx4 v[100:103], v13, s[48:51], s59 offen nt
s_waitcnt lgkmcnt(0)
s_mov_b32 exec_hi, 0
buffer_store_dwordx4 v[104:107], v14, s[48:51], s59 offen nt
s_mov_b64 exec, -1
L_k2_done:
s_endpgm
L_code_end:
.section .rodata,"a"
.p2align 6
.amdhsa_kernel g1_kernel
  .amdhsa_next_free_vgpr 250
  .amdhsa_next_free_sgpr 96
  .amdhsa_accum_offset 252
  .amdhsa_group_segment_fixed_size 0
  .amdhsa_kernarg_size 88
  .amdhsa_user_sgpr_count 2
  .amdhsa_user_sgpr_kernarg_segment_ptr 1
  .amdhsa_system_sgpr_workgroup_id_x 1
  .amdhsa_float_denorm_mode_32 3
  .amdhsa_float_denorm_mode_16_64 3
.end_amdhsa_kernel
.section .rodata,"a"
.p2align 6
.amdhsa_kernel k2_kernel
  .amdhsa_next_free_vgpr 254
  .amdhsa_next_free_sgpr 96
  .amdhsa_accum_offset 256
  .amdhsa_group_segment_fixed_size 0
  .amdhsa_kernarg_size 88
  .amdhsa_user_sgpr_count 2
  .amdhsa_user_sgpr_kernarg_segment_ptr 1
  .amdhsa_system_sgpr_workgroup_id_x 1
  .amdhsa_float_denorm_mode_32 3
  .amdhsa_float_denorm_mode_16_64 3
.end_amdhsa_kernel
```
